```python
import torch

def _softmax(x, axis=-1):
    return torch.softmax(x, dim=axis)

def _gelu(x):
    return torch.nn.functional.gelu(x, approximate='tanh')

def _silu(x):
    return torch.nn.functional.silu(x)

def _sigmoid(x):
    return torch.sigmoid(x)

def _layernorm(x, axis=-1, eps=1e-05):
    m = x.mean(dim=axis, keepdim=True)
    v = x.var(dim=axis, keepdim=True, unbiased=False)
    return (x - m) / torch.sqrt(v + eps)

def _scatter_add(tgt, idx, src, axis=0):
    return tgt.clone().index_add_(axis, idx, src)

def _segment_sum(src, seg, n):
    out = torch.zeros((n,) + src.shape[1:], dtype=src.dtype)
    return out.index_add_(0, seg, src)

def _pad(x, pw):
    flat = tuple((v for pair in reversed(pw) for v in pair))
    return torch.nn.functional.pad(x, flat)
kernel_name = 'sequential_preLN__memory_aug_recurrent_mem_tr__dense_activation_relu__prompt'

def setup_inputs():

    _w = lambda a: (lambda t: t.to(torch.bfloat16) if t.is_floating_point() else t)(torch.as_tensor(a))

    def _A_setup():
        B, S, Dm = (1, 2048, 512)
        H, Dh = (32, 128)
        M, seg = (8, 32)
        seg = min(seg, S)
        S = S // seg * seg
        return {'x': _w((lambda *s: torch.randn(*s, dtype=torch.bfloat16) * 0.05)(B, S, Dm)), 'mem0': _w((lambda *s: torch.randn(*s, dtype=torch.bfloat16) * 0.2)(B, M, Dm)), 'Wq': _w((lambda *s: torch.randn(*s, dtype=torch.bfloat16) * 1.6)(Dm, H, Dh) * Dm ** (-0.5)), 'Wk': _w((lambda *s: torch.randn(*s, dtype=torch.bfloat16) * 1.6)(Dm, H, Dh) * Dm ** (-0.5)), 'Wv': _w((lambda *s: torch.randn(*s, dtype=torch.bfloat16) * 0.2)(Dm, H, Dh) * Dm ** (-0.5)), 'Wo': _w((lambda *s: torch.randn(*s, dtype=torch.bfloat16) * 0.2)(H, Dh, Dm) * (H * Dh) ** (-0.5)), 'seg_len': seg}
    _A_in = _A_setup()

    def _B_setup():
        B, S, D, Dff = (1, 2048, 512, 1792)
        return {'x': _w((lambda *s: torch.randn(*s, dtype=torch.bfloat16) * 0.05)(B, S, D)), 'w1': _w((lambda *s: torch.randn(*s, dtype=torch.bfloat16) * 0.05)(D, Dff)), 'w2': _w((lambda *s: torch.randn(*s, dtype=torch.bfloat16) * 0.05)(Dff, D))}
    _B_in = _B_setup()
    return {'A_x': _A_in['x'], 'A_mem0': _A_in['mem0'], 'A_Wq': _A_in['Wq'], 'A_Wk': _A_in['Wk'], 'A_Wv': _A_in['Wv'], 'A_Wo': _A_in['Wo'], 'A_seg_len': _A_in['seg_len'], 'B_x': _B_in['x'], 'B_w1': _B_in['w1'], 'B_w2': _B_in['w2']}

def reference(A_x, A_mem0, A_Wq, A_Wk, A_Wv, A_Wo, A_seg_len, B_x, B_w1, B_w2):

    def _A_ref(x, mem0, Wq, Wk, Wv, Wo, seg_len):
        B, S, Dm = x.shape
        H, Dh = (Wq.shape[1], Wq.shape[2])
        M = mem0.shape[1]
        scale = Dh ** (-0.5)
        n_seg = S // seg_len
        L = M + seg_len
        idx = torch.arange(L)
        mask = (idx[:, None] < M) | (idx[:, None] >= idx[None, :])
        mem = mem0
        outs = []
        for s in range(n_seg):
            xs = x[:, s * seg_len:(s + 1) * seg_len, :].clone()
            h = torch.concatenate([mem, xs], axis=1)
            q = torch.einsum('btd,dhe->bhte', h, Wq)
            k = torch.einsum('btd,dhe->bhte', h, Wk)
            v = torch.einsum('btd,dhe->bhte', h, Wv)
            scores = torch.einsum('bhqe,bhke->bhqk', q, k) * scale
            scores = torch.where(mask[None, None], scores, -1000000000.0)
            p = _softmax(scores, axis=-1)
            o = torch.einsum('bhqk,bhke->bhqe', p, v)
            o = torch.einsum('bhte,hed->btd', o, Wo)
            mem = o[:, :M, :].clone()
            outs.append(o[:, M:, :])
        return torch.concatenate(outs, axis=1)

    def _B_ref(x, w1, w2):
        h = torch.einsum('bsd,df->bsf', x, w1)
        zero = torch.zeros_like(h)
        h = torch.maximum(h, zero)
        return torch.einsum('bsf,fd->bsd', h, w2)
    x = A_x
    h = x + _A_ref(_layernorm(x, axis=-1), A_mem0, A_Wq, A_Wk, A_Wv, A_Wo, A_seg_len)
    h2 = h + _B_ref(_layernorm(h, axis=-1), B_w1, B_w2)
    return h2
```

```asm
; @launch grid=(256,1,1) block=(256,1,1) lds=163840
.amdgcn_target "amdgcn-amd-amdhsa--gfx950"
.text
.globl sequential_preLN__memory_aug_recurrent_mem_tr__dense_activation_relu__prompt_kernel
.p2align 8
.type sequential_preLN__memory_aug_recurrent_mem_tr__dense_activation_relu__prompt_kernel,@function
sequential_preLN__memory_aug_recurrent_mem_tr__dense_activation_relu__prompt_kernel:
    s_cmp_ge_u32 s2, 256
    s_cbranch_scc1 L_exit
    s_load_dwordx2 s[36:37], s[0:1], 88
    s_getreg_b32 s38, hwreg(HW_REG_XCC_ID, 0, 4)
    s_add_u32 s38, s38, 7
    s_and_b32 s38, s38, 7
    s_waitcnt lgkmcnt(0)
    v_mov_b32 v2, 1
    s_lshl_b32 s39, s38, 2
    v_mov_b32 v1, s39
    v_cmp_eq_u32 vcc, 0, v0
    s_and_saveexec_b64 s[30:31], vcc
    s_cbranch_execz L_noat
    global_atomic_add v4, v1, v2, s[36:37] sc0
    v_mov_b32 v1, 0
    s_waitcnt vmcnt(0)
    ds_write_b32 v1, v4
    s_waitcnt lgkmcnt(0)
L_noat:
    s_mov_b64 exec, s[30:31]
    s_barrier
    v_mov_b32 v1, 0
    ds_read_b32 v4, v1
    s_waitcnt lgkmcnt(0)
    s_nop 1
    v_readfirstlane_b32 s24, v4
    s_nop 3
    s_barrier
    s_cmp_ge_u32 s24, 32
    s_cbranch_scc1 L_exit
    s_cmp_eq_u32 s38, 0
    s_cbranch_scc1 L_chain
    s_sub_u32 s39, s38, 1
    s_lshl_b32 s39, s39, 5
    s_add_u32 s24, s24, s39
    s_branch L_worker
L_chain:
    s_load_dwordx2 s[4:5], s[0:1], 16
    s_load_dwordx2 s[8:9], s[0:1], 24
    s_load_dwordx2 s[12:13], s[0:1], 32
    s_load_dwordx2 s[16:17], s[0:1], 40
    s_load_dwordx2 s[20:21], s[0:1], 96
    v_lshrrev_b32 v1, 6, v0
    v_and_b32 v2, 63, v0
    v_readfirstlane_b32 s25, v1
    s_waitcnt lgkmcnt(0)
    s_mov_b32 s6, 0x400000
    s_mov_b32 s7, 0x00020000
    s_mov_b32 s10, 0x400000
    s_mov_b32 s11, 0x00020000
    s_mov_b32 s14, 0x400000
    s_mov_b32 s15, 0x00020000
    s_mov_b32 s18, 0x400000
    s_mov_b32 s19, 0x00020000
    s_mov_b32 s22, 0x10000000
    s_mov_b32 s23, 0x00020000
    s_mov_b32 s40, 0x3e0293ee
    s_mov_b32 s41, 0x3e0293ee
    s_mov_b32 s50, 0x00ff00ff
    s_mov_b32 s51, 0
    s_and_b32 s27, s25, 1
    s_cmp_eq_u32 s27, 0
    s_mov_b32 s28, 0xcccccccc
    s_cselect_b32 s48, 0x33333333, s28
    s_mov_b32 s49, s48
    v_and_b32 v3, 15, v2
    v_lshrrev_b32 v4, 4, v2
    v_bfe_u32 v5, v2, 2, 2
    v_and_b32 v6, 3, v2
    v_and_b32 v9, 1, v4
    v_lshrrev_b32 v10, 1, v4
    v_lshlrev_b32 v112, 4, v2
    v_mov_b32 v113, 0x44444444
    v_mov_b32 v7, 0xeeeeeeee
    v_and_b32 v8, 2, v2
    v_cmp_ne_u32 vcc, 0, v8
    s_nop 1
    v_cndmask_b32 v113, v113, v7, vcc
    s_lshl_b32 s27, s25, 5
    v_add_u32 v7, s27, v3
    v_lshlrev_b32 v7, 5, v7
    v_lshrrev_b32 v8, 1, v7
    v_and_b32 v8, 128, v8
    v_xor_b32 v7, v7, v8
    v_lshrrev_b32 v8, 2, v3
    v_xor_b32 v8, v8, v4
    v_lshl_add_u32 v7, v8, 3, v7
    v_add_u32 v114, 0x4000, v7
    v_lshlrev_b32 v7, 3, v4
    v_add_u32 v7, v7, v5
    v_lshlrev_b32 v7, 5, v7
    v_lshrrev_b32 v8, 1, v7
    v_and_b32 v8, 128, v8
    v_xor_b32 v7, v7, v8
    v_and_b32 v8, 1, v4
    v_lshlrev_b32 v8, 1, v8
    v_xor_b32 v8, v8, v6
    v_lshl_add_u32 v7, v8, 3, v7
    v_add_u32 v115, 0x4000, v7
    v_xor_b32 v7, v4, v3
    v_lshlrev_b32 v7, 4, v7
    v_lshl_add_u32 v7, v3, 8, v7
    v_add_u32 v117, 0x0, v7
    v_lshlrev_b32 v7, 2, v4
    v_add_u32 v7, v7, v5
    v_lshlrev_b32 v7, 6, v7
    v_lshl_add_u32 v7, v9, 5, v7
    v_lshl_add_u32 v7, v6, 3, v7
    s_lshl_b32 s27, s25, 11
    s_add_u32 s27, s27, 0x2000
    v_add_u32 v118, s27, v7
    s_lshl_b32 s27, s25, 15
    s_add_u32 s27, s27, 0x8000
    v_add_u32 v119, s27, v112
    v_lshrrev_b32 v7, 2, v3
    v_lshlrev_b32 v7, 13, v7
    v_lshl_add_u32 v7, v4, 11, v7
    v_lshl_add_u32 v120, v6, 4, v7
    v_bfe_u32 v7, v2, 2, 1
    v_lshl_add_u32 v7, v4, 1, v7
    s_lshl_b32 s27, s25, 2
    v_add_u32 v7, s27, v7
    v_lshlrev_b32 v7, 4, v7
    v_lshl_add_u32 v121, v6, 2, v7
    v_xor_b32 v7, v3, v4
    v_lshlrev_b32 v7, 4, v7
    v_lshl_add_u32 v7, v4, 8, v7
    s_lshl_b32 s27, s25, 1
    s_and_b32 s27, s27, 3
    s_lshl_b32 s27, s27, 6
    v_xor_b32 v122, s27, v7
    v_lshlrev_b32 v7, 1, v9
    v_xor_b32 v7, v7, v6
    v_lshlrev_b32 v7, 4, v7
    v_lshrrev_b32 v8, 2, v2
    v_lshl_add_u32 v123, v8, 8, v7
    v_mov_b32 v125, 0
    v_mov_b32 v126, 0
    v_lshrrev_b32 v7, 1, v3
    v_bfe_u32 v8, v2, 5, 1
    s_lshl_b32 s27, s25, 1
    v_or_b32 v8, s27, v8
    v_xor_b32 v7, v7, v8
    v_lshlrev_b32 v7, 5, v7
    v_lshl_add_u32 v7, v4, 13, v7
    v_and_b32 v12, 1, v2
    v_lshl_add_u32 v20, v12, 4, v7
    v_lshrrev_b32 v8, 1, v5
    v_and_b32 v11, 1, v5
    v_lshlrev_b32 v7, 5, v8
    v_lshl_add_u32 v7, v11, 4, v7
    v_lshl_add_u32 v7, v10, 2, v7
    v_lshl_add_u32 v7, v9, 1, v7
    v_lshlrev_b32 v7, 8, v7
    v_lshl_add_u32 v12, v5, 1, v9
    v_xor_b32 v12, s27, v12
    v_lshl_add_u32 v7, v12, 5, v7
    v_lshl_add_u32 v21, v6, 3, v7
    s_lshl_b32 s29, s25, 15
    s_add_u32 s29, s29, 0x8000
    v_lshrrev_b32 v7, 1, v3
    v_xor_b32 v7, v7, v9
    v_lshlrev_b32 v7, 5, v7
    v_lshl_add_u32 v7, v4, 10, v7
    v_and_b32 v12, 1, v2
    v_lshl_add_u32 v23, v12, 4, v7
    v_lshlrev_b32 v7, 5, v8
    v_lshl_add_u32 v7, v9, 4, v7
    v_lshl_add_u32 v7, v10, 2, v7
    v_add_u32 v7, v7, v11
    v_lshlrev_b32 v7, 8, v7
    v_lshl_add_u32 v12, v9, 1, v11
    v_lshl_add_u32 v12, v8, 2, v12
    v_lshl_add_u32 v7, v12, 5, v7
    v_lshl_add_u32 v7, v6, 3, v7
    v_add_u32 v25, s29, v7
    s_lshl_b32 s28, s24, 8
    s_lshl_b32 s33, s25, 17
    s_add_u32 s28, s28, s33
    s_lshl_b32 s30, s25, 12
    s_lshl_b32 s31, s24, 17
    s_lshl_b32 s32, s25, 8
    s_add_u32 s31, s31, s32
    s_cmp_eq_u32 s25, 1
    s_cbranch_scc1 L_wl_1
    s_cmp_eq_u32 s25, 2
    s_cbranch_scc1 L_wl_2
    s_cmp_eq_u32 s25, 3
    s_cbranch_scc1 L_wl_3
L_wl_0:
    s_add_u32 m0, s30, 0
    s_add_u32 s33, s28, 0
    buffer_load_dwordx4 v20, s[4:7], s33 offen lds
    s_add_u32 m0, s30, 1024
    s_add_u32 s33, s28, 32768
    buffer_load_dwordx4 v20, s[4:7], s33 offen lds
    s_add_u32 m0, s30, 2048
    s_add_u32 s33, s28, 65536
    buffer_load_dwordx4 v20, s[4:7], s33 offen lds
    s_add_u32 m0, s30, 3072
    s_add_u32 s33, s28, 98304
    buffer_load_dwordx4 v20, s[4:7], s33 offen lds
    s_add_u32 m0, s30, 16384
    s_add_u32 s33, s28, 524288
    buffer_load_dwordx4 v20, s[4:7], s33 offen lds
    s_add_u32 m0, s30, 17408
    s_add_u32 s33, s28, 557056
    buffer_load_dwordx4 v20, s[4:7], s33 offen lds
    s_add_u32 m0, s30, 18432
    s_add_u32 s33, s28, 589824
    buffer_load_dwordx4 v20, s[4:7], s33 offen lds
    s_add_u32 m0, s30, 19456
    s_add_u32 s33, s28, 622592
    buffer_load_dwordx4 v20, s[4:7], s33 offen lds
    s_add_u32 m0, s30, 49152
    s_add_u32 s33, s28, 1048576
    buffer_load_dwordx4 v20, s[4:7], s33 offen lds
    s_add_u32 m0, s30, 50176
    s_add_u32 s33, s28, 1081344
    buffer_load_dwordx4 v20, s[4:7], s33 offen lds
    s_add_u32 m0, s30, 51200
    s_add_u32 s33, s28, 1114112
    buffer_load_dwordx4 v20, s[4:7], s33 offen lds
    s_add_u32 m0, s30, 52224
    s_add_u32 s33, s28, 1146880
    buffer_load_dwordx4 v20, s[4:7], s33 offen lds
    s_add_u32 m0, s30, 81920
    s_add_u32 s33, s28, 1572864
    buffer_load_dwordx4 v20, s[4:7], s33 offen lds
    s_add_u32 m0, s30, 82944
    s_add_u32 s33, s28, 1605632
    buffer_load_dwordx4 v20, s[4:7], s33 offen lds
    s_add_u32 m0, s30, 83968
    s_add_u32 s33, s28, 1638400
    buffer_load_dwordx4 v20, s[4:7], s33 offen lds
    s_add_u32 m0, s30, 84992
    s_add_u32 s33, s28, 1671168
    buffer_load_dwordx4 v20, s[4:7], s33 offen lds
    s_add_u32 m0, s30, 114688
    s_add_u32 s33, s28, 2097152
    buffer_load_dwordx4 v20, s[4:7], s33 offen lds
    s_add_u32 m0, s30, 115712
    s_add_u32 s33, s28, 2129920
    buffer_load_dwordx4 v20, s[4:7], s33 offen lds
    s_add_u32 m0, s30, 116736
    s_add_u32 s33, s28, 2162688
    buffer_load_dwordx4 v20, s[4:7], s33 offen lds
    s_add_u32 m0, s30, 117760
    s_add_u32 s33, s28, 2195456
    buffer_load_dwordx4 v20, s[4:7], s33 offen lds
    s_add_u32 m0, s30, 147456
    s_add_u32 s33, s28, 2621440
    buffer_load_dwordx4 v20, s[4:7], s33 offen lds
    s_add_u32 m0, s30, 148480
    s_add_u32 s33, s28, 2654208
    buffer_load_dwordx4 v20, s[4:7], s33 offen lds
    s_add_u32 m0, s30, 149504
    s_add_u32 s33, s28, 2686976
    buffer_load_dwordx4 v20, s[4:7], s33 offen lds
    s_add_u32 m0, s30, 150528
    s_add_u32 s33, s28, 2719744
    buffer_load_dwordx4 v20, s[4:7], s33 offen lds
    s_waitcnt vmcnt(20)
    s_barrier
    v_xor_b32 v24, 0, v23
    s_add_u32 m0, s29, 0
    s_add_u32 s33, s31, 0
    buffer_load_dwordx4 v24, s[16:19], s33 offen lds
    s_add_u32 m0, s29, 1024
    s_add_u32 s33, s31, 4096
    buffer_load_dwordx4 v24, s[16:19], s33 offen lds
    s_add_u32 m0, s29, 2048
    s_add_u32 s33, s31, 8192
    buffer_load_dwordx4 v24, s[16:19], s33 offen lds
    s_add_u32 m0, s29, 3072
    s_add_u32 s33, s31, 12288
    buffer_load_dwordx4 v24, s[16:19], s33 offen lds
    v_add_u32 v22, 0, v21
    v_xor_b32 v26, 32, v22
    ds_read_b64_tr_b16 a[0:1], v22 offset:0
    ds_read_b64_tr_b16 a[2:3], v22 offset:256
    ds_read_b64_tr_b16 a[4:5], v22 offset:2048
    ds_read_b64_tr_b16 a[6:7], v22 offset:2304
    ds_read_b64_tr_b16 a[64:65], v26 offset:0
    ds_read_b64_tr_b16 a[66:67], v26 offset:256
    ds_read_b64_tr_b16 a[68:69], v26 offset:2048
    ds_read_b64_tr_b16 a[70:71], v26 offset:2304
    s_waitcnt lgkmcnt(0)
    s_waitcnt vmcnt(20)
    s_barrier
    s_add_u32 m0, s30, 0
    s_add_u32 s33, s28, 3145728
    buffer_load_dwordx4 v20, s[4:7], s33 offen lds
    s_add_u32 m0, s30, 1024
    s_add_u32 s33, s28, 3178496
    buffer_load_dwordx4 v20, s[4:7], s33 offen lds
    s_add_u32 m0, s30, 2048
    s_add_u32 s33, s28, 3211264
    buffer_load_dwordx4 v20, s[4:7], s33 offen lds
    s_add_u32 m0, s30, 3072
    s_add_u32 s33, s28, 3244032
    buffer_load_dwordx4 v20, s[4:7], s33 offen lds
    v_xor_b32 v24, 64, v23
    s_add_u32 m0, s29, 4096
    s_add_u32 s33, s31, 16384
    buffer_load_dwordx4 v24, s[16:19], s33 offen lds
    s_add_u32 m0, s29, 5120
    s_add_u32 s33, s31, 20480
    buffer_load_dwordx4 v24, s[16:19], s33 offen lds
    s_add_u32 m0, s29, 6144
    s_add_u32 s33, s31, 24576
    buffer_load_dwordx4 v24, s[16:19], s33 offen lds
    s_add_u32 m0, s29, 7168
    s_add_u32 s33, s31, 28672
    buffer_load_dwordx4 v24, s[16:19], s33 offen lds
    v_add_u32 v22, 16384, v21
    v_xor_b32 v26, 32, v22
    ds_read_b64_tr_b16 a[8:9], v22 offset:0
    ds_read_b64_tr_b16 a[10:11], v22 offset:256
    ds_read_b64_tr_b16 a[12:13], v22 offset:2048
    ds_read_b64_tr_b16 a[14:15], v22 offset:2304
    ds_read_b64_tr_b16 a[72:73], v26 offset:0
    ds_read_b64_tr_b16 a[74:75], v26 offset:256
    ds_read_b64_tr_b16 a[76:77], v26 offset:2048
    ds_read_b64_tr_b16 a[78:79], v26 offset:2304
    s_waitcnt lgkmcnt(0)
    s_waitcnt vmcnt(24)
    s_barrier
    s_add_u32 m0, s30, 16384
    s_add_u32 s33, s28, 3670016
    buffer_load_dwordx4 v20, s[4:7], s33 offen lds
    s_add_u32 m0, s30, 17408
    s_add_u32 s33, s28, 3702784
    buffer_load_dwordx4 v20, s[4:7], s33 offen lds
    s_add_u32 m0, s30, 18432
    s_add_u32 s33, s28, 3735552
    buffer_load_dwordx4 v20, s[4:7], s33 offen lds
    s_add_u32 m0, s30, 19456
    s_add_u32 s33, s28, 3768320
    buffer_load_dwordx4 v20, s[4:7], s33 offen lds
    v_xor_b32 v24, 128, v23
    s_add_u32 m0, s29, 8192
    s_add_u32 s33, s31, 32768
    buffer_load_dwordx4 v24, s[16:19], s33 offen lds
    s_add_u32 m0, s29, 9216
    s_add_u32 s33, s31, 36864
    buffer_load_dwordx4 v24, s[16:19], s33 offen lds
    s_add_u32 m0, s29, 10240
    s_add_u32 s33, s31, 40960
    buffer_load_dwordx4 v24, s[16:19], s33 offen lds
    s_add_u32 m0, s29, 11264
    s_add_u32 s33, s31, 45056
    buffer_load_dwordx4 v24, s[16:19], s33 offen lds
    v_add_u32 v22, 49152, v21
    v_xor_b32 v26, 32, v22
    ds_read_b64_tr_b16 a[16:17], v22 offset:0
    ds_read_b64_tr_b16 a[18:19], v22 offset:256
    ds_read_b64_tr_b16 a[20:21], v22 offset:2048
    ds_read_b64_tr_b16 a[22:23], v22 offset:2304
    ds_read_b64_tr_b16 a[80:81], v26 offset:0
    ds_read_b64_tr_b16 a[82:83], v26 offset:256
    ds_read_b64_tr_b16 a[84:85], v26 offset:2048
    ds_read_b64_tr_b16 a[86:87], v26 offset:2304
    s_waitcnt lgkmcnt(0)
    s_waitcnt vmcnt(28)
    s_barrier
    s_add_u32 m0, s30, 49152
    s_add_u32 s33, s28, 0
    buffer_load_dwordx4 v20, s[8:11], s33 offen lds
    s_add_u32 m0, s30, 50176
    s_add_u32 s33, s28, 32768
    buffer_load_dwordx4 v20, s[8:11], s33 offen lds
    s_add_u32 m0, s30, 51200
    s_add_u32 s33, s28, 65536
    buffer_load_dwordx4 v20, s[8:11], s33 offen lds
    s_add_u32 m0, s30, 52224
    s_add_u32 s33, s28, 98304
    buffer_load_dwordx4 v20, s[8:11], s33 offen lds
    v_xor_b32 v24, 192, v23
    s_add_u32 m0, s29, 12288
    s_add_u32 s33, s31, 49152
    buffer_load_dwordx4 v24, s[16:19], s33 offen lds
    s_add_u32 m0, s29, 13312
    s_add_u32 s33, s31, 53248
    buffer_load_dwordx4 v24, s[16:19], s33 offen lds
    s_add_u32 m0, s29, 14336
    s_add_u32 s33, s31, 57344
    buffer_load_dwordx4 v24, s[16:19], s33 offen lds
    s_add_u32 m0, s29, 15360
    s_add_u32 s33, s31, 61440
    buffer_load_dwordx4 v24, s[16:19], s33 offen lds
    v_add_u32 v22, 81920, v21
    v_xor_b32 v26, 32, v22
    ds_read_b64_tr_b16 a[24:25], v22 offset:0
    ds_read_b64_tr_b16 a[26:27], v22 offset:256
    ds_read_b64_tr_b16 a[28:29], v22 offset:2048
    ds_read_b64_tr_b16 a[30:31], v22 offset:2304
    ds_read_b64_tr_b16 a[88:89], v26 offset:0
    ds_read_b64_tr_b16 a[90:91], v26 offset:256
    ds_read_b64_tr_b16 a[92:93], v26 offset:2048
    ds_read_b64_tr_b16 a[94:95], v26 offset:2304
    s_waitcnt lgkmcnt(0)
    s_waitcnt vmcnt(32)
    s_barrier
    s_add_u32 m0, s30, 81920
    s_add_u32 s33, s28, 524288
    buffer_load_dwordx4 v20, s[8:11], s33 offen lds
    s_add_u32 m0, s30, 82944
    s_add_u32 s33, s28, 557056
    buffer_load_dwordx4 v20, s[8:11], s33 offen lds
    s_add_u32 m0, s30, 83968
    s_add_u32 s33, s28, 589824
    buffer_load_dwordx4 v20, s[8:11], s33 offen lds
    s_add_u32 m0, s30, 84992
    s_add_u32 s33, s28, 622592
    buffer_load_dwordx4 v20, s[8:11], s33 offen lds
    v_add_u32 v22, 114688, v21
    v_xor_b32 v26, 32, v22
    ds_read_b64_tr_b16 a[32:33], v22 offset:0
    ds_read_b64_tr_b16 a[34:35], v22 offset:256
    ds_read_b64_tr_b16 a[36:37], v22 offset:2048
    ds_read_b64_tr_b16 a[38:39], v22 offset:2304
    ds_read_b64_tr_b16 a[96:97], v26 offset:0
    ds_read_b64_tr_b16 a[98:99], v26 offset:256
    ds_read_b64_tr_b16 a[100:101], v26 offset:2048
    ds_read_b64_tr_b16 a[102:103], v26 offset:2304
    s_waitcnt lgkmcnt(0)
    s_waitcnt vmcnt(32)
    s_barrier
    s_add_u32 m0, s30, 114688
    s_add_u32 s33, s28, 1048576
    buffer_load_dwordx4 v20, s[8:11], s33 offen lds
    s_add_u32 m0, s30, 115712
    s_add_u32 s33, s28, 1081344
    buffer_load_dwordx4 v20, s[8:11], s33 offen lds
    s_add_u32 m0, s30, 116736
    s_add_u32 s33, s28, 1114112
    buffer_load_dwordx4 v20, s[8:11], s33 offen lds
    s_add_u32 m0, s30, 117760
    s_add_u32 s33, s28, 1146880
    buffer_load_dwordx4 v20, s[8:11], s33 offen lds
    v_add_u32 v22, 147456, v21
    v_xor_b32 v26, 32, v22
    ds_read_b64_tr_b16 a[40:41], v22 offset:0
    ds_read_b64_tr_b16 a[42:43], v22 offset:256
    ds_read_b64_tr_b16 a[44:45], v22 offset:2048
    ds_read_b64_tr_b16 a[46:47], v22 offset:2304
    ds_read_b64_tr_b16 a[104:105], v26 offset:0
    ds_read_b64_tr_b16 a[106:107], v26 offset:256
    ds_read_b64_tr_b16 a[108:109], v26 offset:2048
    ds_read_b64_tr_b16 a[110:111], v26 offset:2304
    s_waitcnt lgkmcnt(0)
    s_waitcnt vmcnt(28)
    s_barrier
    s_add_u32 m0, s30, 147456
    s_add_u32 s33, s28, 1572864
    buffer_load_dwordx4 v20, s[8:11], s33 offen lds
    s_add_u32 m0, s30, 148480
    s_add_u32 s33, s28, 1605632
    buffer_load_dwordx4 v20, s[8:11], s33 offen lds
    s_add_u32 m0, s30, 149504
    s_add_u32 s33, s28, 1638400
    buffer_load_dwordx4 v20, s[8:11], s33 offen lds
    s_add_u32 m0, s30, 150528
    s_add_u32 s33, s28, 1671168
    buffer_load_dwordx4 v20, s[8:11], s33 offen lds
    v_add_u32 v22, 0, v21
    v_xor_b32 v26, 32, v22
    ds_read_b64_tr_b16 a[48:49], v22 offset:0
    ds_read_b64_tr_b16 a[50:51], v22 offset:256
    ds_read_b64_tr_b16 a[52:53], v22 offset:2048
    ds_read_b64_tr_b16 a[54:55], v22 offset:2304
    ds_read_b64_tr_b16 a[112:113], v26 offset:0
    ds_read_b64_tr_b16 a[114:115], v26 offset:256
    ds_read_b64_tr_b16 a[116:117], v26 offset:2048
    ds_read_b64_tr_b16 a[118:119], v26 offset:2304
    s_waitcnt lgkmcnt(0)
    s_waitcnt vmcnt(24)
    s_barrier
    s_add_u32 m0, s30, 0
    s_add_u32 s33, s28, 2097152
    buffer_load_dwordx4 v20, s[8:11], s33 offen lds
    s_add_u32 m0, s30, 1024
    s_add_u32 s33, s28, 2129920
    buffer_load_dwordx4 v20, s[8:11], s33 offen lds
    s_add_u32 m0, s30, 2048
    s_add_u32 s33, s28, 2162688
    buffer_load_dwordx4 v20, s[8:11], s33 offen lds
    s_add_u32 m0, s30, 3072
    s_add_u32 s33, s28, 2195456
    buffer_load_dwordx4 v20, s[8:11], s33 offen lds
    v_add_u32 v22, 16384, v21
    v_xor_b32 v26, 32, v22
    ds_read_b64_tr_b16 a[56:57], v22 offset:0
    ds_read_b64_tr_b16 a[58:59], v22 offset:256
    ds_read_b64_tr_b16 a[60:61], v22 offset:2048
    ds_read_b64_tr_b16 a[62:63], v22 offset:2304
    ds_read_b64_tr_b16 a[120:121], v26 offset:0
    ds_read_b64_tr_b16 a[122:123], v26 offset:256
    ds_read_b64_tr_b16 a[124:125], v26 offset:2048
    ds_read_b64_tr_b16 a[126:127], v26 offset:2304
    s_waitcnt lgkmcnt(0)
    s_waitcnt vmcnt(20)
    s_barrier
    s_add_u32 m0, s30, 16384
    s_add_u32 s33, s28, 2621440
    buffer_load_dwordx4 v20, s[8:11], s33 offen lds
    s_add_u32 m0, s30, 17408
    s_add_u32 s33, s28, 2654208
    buffer_load_dwordx4 v20, s[8:11], s33 offen lds
    s_add_u32 m0, s30, 18432
    s_add_u32 s33, s28, 2686976
    buffer_load_dwordx4 v20, s[8:11], s33 offen lds
    s_add_u32 m0, s30, 19456
    s_add_u32 s33, s28, 2719744
    buffer_load_dwordx4 v20, s[8:11], s33 offen lds
    v_add_u32 v22, 49152, v21
    v_xor_b32 v26, 32, v22
    ds_read_b64_tr_b16 a[128:129], v22 offset:0
    ds_read_b64_tr_b16 a[130:131], v22 offset:256
    ds_read_b64_tr_b16 a[132:133], v22 offset:2048
    ds_read_b64_tr_b16 a[134:135], v22 offset:2304
    ds_read_b64_tr_b16 a[192:193], v26 offset:0
    ds_read_b64_tr_b16 a[194:195], v26 offset:256
    ds_read_b64_tr_b16 a[196:197], v26 offset:2048
    ds_read_b64_tr_b16 a[198:199], v26 offset:2304
    s_waitcnt lgkmcnt(0)
    s_waitcnt vmcnt(16)
    s_barrier
    s_add_u32 m0, s30, 49152
    s_add_u32 s33, s28, 3145728
    buffer_load_dwordx4 v20, s[8:11], s33 offen lds
    s_add_u32 m0, s30, 50176
    s_add_u32 s33, s28, 3178496
    buffer_load_dwordx4 v20, s[8:11], s33 offen lds
    s_add_u32 m0, s30, 51200
    s_add_u32 s33, s28, 3211264
    buffer_load_dwordx4 v20, s[8:11], s33 offen lds
    s_add_u32 m0, s30, 52224
    s_add_u32 s33, s28, 3244032
    buffer_load_dwordx4 v20, s[8:11], s33 offen lds
    v_add_u32 v22, 81920, v21
    v_xor_b32 v26, 32, v22
    ds_read_b64_tr_b16 a[136:137], v22 offset:0
    ds_read_b64_tr_b16 a[138:139], v22 offset:256
    ds_read_b64_tr_b16 a[140:141], v22 offset:2048
    ds_read_b64_tr_b16 a[142:143], v22 offset:2304
    ds_read_b64_tr_b16 a[200:201], v26 offset:0
    ds_read_b64_tr_b16 a[202:203], v26 offset:256
    ds_read_b64_tr_b16 a[204:205], v26 offset:2048
    ds_read_b64_tr_b16 a[206:207], v26 offset:2304
    s_waitcnt lgkmcnt(0)
    s_waitcnt vmcnt(16)
    s_barrier
    s_add_u32 m0, s30, 81920
    s_add_u32 s33, s28, 3670016
    buffer_load_dwordx4 v20, s[8:11], s33 offen lds
    s_add_u32 m0, s30, 82944
    s_add_u32 s33, s28, 3702784
    buffer_load_dwordx4 v20, s[8:11], s33 offen lds
    s_add_u32 m0, s30, 83968
    s_add_u32 s33, s28, 3735552
    buffer_load_dwordx4 v20, s[8:11], s33 offen lds
    s_add_u32 m0, s30, 84992
    s_add_u32 s33, s28, 3768320
    buffer_load_dwordx4 v20, s[8:11], s33 offen lds
    v_add_u32 v22, 114688, v21
    v_xor_b32 v26, 32, v22
    ds_read_b64_tr_b16 a[144:145], v22 offset:0
    ds_read_b64_tr_b16 a[146:147], v22 offset:256
    ds_read_b64_tr_b16 a[148:149], v22 offset:2048
    ds_read_b64_tr_b16 a[150:151], v22 offset:2304
    ds_read_b64_tr_b16 a[208:209], v26 offset:0
    ds_read_b64_tr_b16 a[210:211], v26 offset:256
    ds_read_b64_tr_b16 a[212:213], v26 offset:2048
    ds_read_b64_tr_b16 a[214:215], v26 offset:2304
    s_waitcnt lgkmcnt(0)
    ds_read_b64_tr_b16 v[32:33], v25 offset:0
    ds_read_b64_tr_b16 v[34:35], v25 offset:512
    ds_read_b64_tr_b16 v[36:37], v25 offset:2048
    ds_read_b64_tr_b16 v[38:39], v25 offset:2560
    v_xor_b32 v27, 32, v25
    ds_read_b64_tr_b16 v[40:41], v27 offset:0
    ds_read_b64_tr_b16 v[42:43], v27 offset:512
    ds_read_b64_tr_b16 v[44:45], v27 offset:2048
    ds_read_b64_tr_b16 v[46:47], v27 offset:2560
    s_waitcnt lgkmcnt(0)
    v_xor_b32 v27, 64, v25
    ds_read_b64_tr_b16 v[48:49], v27 offset:0
    ds_read_b64_tr_b16 v[50:51], v27 offset:512
    ds_read_b64_tr_b16 v[52:53], v27 offset:2048
    ds_read_b64_tr_b16 v[54:55], v27 offset:2560
    v_xor_b32 v27, 96, v25
    ds_read_b64_tr_b16 v[56:57], v27 offset:0
    ds_read_b64_tr_b16 v[58:59], v27 offset:512
    ds_read_b64_tr_b16 v[60:61], v27 offset:2048
    ds_read_b64_tr_b16 v[62:63], v27 offset:2560
    s_waitcnt lgkmcnt(0)
    v_xor_b32 v27, 128, v25
    ds_read_b64_tr_b16 v[64:65], v27 offset:0
    ds_read_b64_tr_b16 v[66:67], v27 offset:512
    ds_read_b64_tr_b16 v[68:69], v27 offset:2048
    ds_read_b64_tr_b16 v[70:71], v27 offset:2560
    v_xor_b32 v27, 160, v25
    ds_read_b64_tr_b16 v[72:73], v27 offset:0
    ds_read_b64_tr_b16 v[74:75], v27 offset:512
    ds_read_b64_tr_b16 v[76:77], v27 offset:2048
    ds_read_b64_tr_b16 v[78:79], v27 offset:2560
    s_waitcnt lgkmcnt(0)
    v_xor_b32 v27, 192, v25
    ds_read_b64_tr_b16 v[80:81], v27 offset:0
    ds_read_b64_tr_b16 v[82:83], v27 offset:512
    ds_read_b64_tr_b16 v[84:85], v27 offset:2048
    ds_read_b64_tr_b16 v[86:87], v27 offset:2560
    v_xor_b32 v27, 224, v25
    ds_read_b64_tr_b16 v[88:89], v27 offset:0
    ds_read_b64_tr_b16 v[90:91], v27 offset:512
    ds_read_b64_tr_b16 v[92:93], v27 offset:2048
    ds_read_b64_tr_b16 v[94:95], v27 offset:2560
    s_waitcnt lgkmcnt(0)
    ds_write_b128 v119, v[32:35] offset:0
    ds_write_b128 v119, v[36:39] offset:1024
    ds_write_b128 v119, v[40:43] offset:2048
    ds_write_b128 v119, v[44:47] offset:3072
    ds_write_b128 v119, v[48:51] offset:4096
    ds_write_b128 v119, v[52:55] offset:5120
    ds_write_b128 v119, v[56:59] offset:6144
    ds_write_b128 v119, v[60:63] offset:7168
    s_waitcnt lgkmcnt(0)
    ds_write_b128 v119, v[64:67] offset:8192
    ds_write_b128 v119, v[68:71] offset:9216
    ds_write_b128 v119, v[72:75] offset:10240
    ds_write_b128 v119, v[76:79] offset:11264
    ds_write_b128 v119, v[80:83] offset:12288
    ds_write_b128 v119, v[84:87] offset:13312
    ds_write_b128 v119, v[88:91] offset:14336
    ds_write_b128 v119, v[92:95] offset:15360
    s_waitcnt lgkmcnt(0)
    s_waitcnt vmcnt(16)
    s_barrier
    s_add_u32 m0, s30, 114688
    s_add_u32 s33, s28, 0
    buffer_load_dwordx4 v20, s[12:15], s33 offen lds
    s_add_u32 m0, s30, 115712
    s_add_u32 s33, s28, 32768
    buffer_load_dwordx4 v20, s[12:15], s33 offen lds
    s_add_u32 m0, s30, 116736
    s_add_u32 s33, s28, 65536
    buffer_load_dwordx4 v20, s[12:15], s33 offen lds
    s_add_u32 m0, s30, 117760
    s_add_u32 s33, s28, 98304
    buffer_load_dwordx4 v20, s[12:15], s33 offen lds
    v_add_u32 v22, 147456, v21
    v_xor_b32 v26, 32, v22
    ds_read_b64_tr_b16 a[152:153], v22 offset:0
    ds_read_b64_tr_b16 a[154:155], v22 offset:256
    ds_read_b64_tr_b16 a[156:157], v22 offset:2048
    ds_read_b64_tr_b16 a[158:159], v22 offset:2304
    ds_read_b64_tr_b16 a[216:217], v26 offset:0
    ds_read_b64_tr_b16 a[218:219], v26 offset:256
    ds_read_b64_tr_b16 a[220:221], v26 offset:2048
    ds_read_b64_tr_b16 a[222:223], v26 offset:2304
    s_waitcnt lgkmcnt(0)
    s_waitcnt vmcnt(16)
    s_barrier
    s_add_u32 m0, s30, 147456
    s_add_u32 s33, s28, 524288
    buffer_load_dwordx4 v20, s[12:15], s33 offen lds
    s_add_u32 m0, s30, 148480
    s_add_u32 s33, s28, 557056
    buffer_load_dwordx4 v20, s[12:15], s33 offen lds
    s_add_u32 m0, s30, 149504
    s_add_u32 s33, s28, 589824
    buffer_load_dwordx4 v20, s[12:15], s33 offen lds
    s_add_u32 m0, s30, 150528
    s_add_u32 s33, s28, 622592
    buffer_load_dwordx4 v20, s[12:15], s33 offen lds
    v_add_u32 v22, 0, v21
    v_xor_b32 v26, 32, v22
    ds_read_b64_tr_b16 a[160:161], v22 offset:0
    ds_read_b64_tr_b16 a[162:163], v22 offset:256
    ds_read_b64_tr_b16 a[164:165], v22 offset:2048
    ds_read_b64_tr_b16 a[166:167], v22 offset:2304
    ds_read_b64_tr_b16 a[224:225], v26 offset:0
    ds_read_b64_tr_b16 a[226:227], v26 offset:256
    ds_read_b64_tr_b16 a[228:229], v26 offset:2048
    ds_read_b64_tr_b16 a[230:231], v26 offset:2304
    s_waitcnt lgkmcnt(0)
    s_waitcnt vmcnt(16)
    s_barrier
    s_add_u32 m0, s30, 0
    s_add_u32 s33, s28, 1048576
    buffer_load_dwordx4 v20, s[12:15], s33 offen lds
    s_add_u32 m0, s30, 1024
    s_add_u32 s33, s28, 1081344
    buffer_load_dwordx4 v20, s[12:15], s33 offen lds
    s_add_u32 m0, s30, 2048
    s_add_u32 s33, s28, 1114112
    buffer_load_dwordx4 v20, s[12:15], s33 offen lds
    s_add_u32 m0, s30, 3072
    s_add_u32 s33, s28, 1146880
    buffer_load_dwordx4 v20, s[12:15], s33 offen lds
    v_add_u32 v22, 16384, v21
    v_xor_b32 v26, 32, v22
    ds_read_b64_tr_b16 a[168:169], v22 offset:0
    ds_read_b64_tr_b16 a[170:171], v22 offset:256
    ds_read_b64_tr_b16 a[172:173], v22 offset:2048
    ds_read_b64_tr_b16 a[174:175], v22 offset:2304
    ds_read_b64_tr_b16 a[232:233], v26 offset:0
    ds_read_b64_tr_b16 a[234:235], v26 offset:256
    ds_read_b64_tr_b16 a[236:237], v26 offset:2048
    ds_read_b64_tr_b16 a[238:239], v26 offset:2304
    s_waitcnt lgkmcnt(0)
    s_waitcnt vmcnt(16)
    s_barrier
    s_add_u32 m0, s30, 16384
    s_add_u32 s33, s28, 1572864
    buffer_load_dwordx4 v20, s[12:15], s33 offen lds
    s_add_u32 m0, s30, 17408
    s_add_u32 s33, s28, 1605632
    buffer_load_dwordx4 v20, s[12:15], s33 offen lds
    s_add_u32 m0, s30, 18432
    s_add_u32 s33, s28, 1638400
    buffer_load_dwordx4 v20, s[12:15], s33 offen lds
    s_add_u32 m0, s30, 19456
    s_add_u32 s33, s28, 1671168
    buffer_load_dwordx4 v20, s[12:15], s33 offen lds
    v_add_u32 v22, 49152, v21
    v_xor_b32 v26, 32, v22
    ds_read_b64_tr_b16 a[176:177], v22 offset:0
    ds_read_b64_tr_b16 a[178:179], v22 offset:256
    ds_read_b64_tr_b16 a[180:181], v22 offset:2048
    ds_read_b64_tr_b16 a[182:183], v22 offset:2304
    ds_read_b64_tr_b16 a[240:241], v26 offset:0
    ds_read_b64_tr_b16 a[242:243], v26 offset:256
    ds_read_b64_tr_b16 a[244:245], v26 offset:2048
    ds_read_b64_tr_b16 a[246:247], v26 offset:2304
    s_waitcnt lgkmcnt(0)
    s_waitcnt vmcnt(16)
    s_barrier
    v_add_u32 v22, 81920, v21
    v_xor_b32 v26, 32, v22
    ds_read_b64_tr_b16 a[184:185], v22 offset:0
    ds_read_b64_tr_b16 a[186:187], v22 offset:256
    ds_read_b64_tr_b16 a[188:189], v22 offset:2048
    ds_read_b64_tr_b16 a[190:191], v22 offset:2304
    ds_read_b64_tr_b16 a[248:249], v26 offset:0
    ds_read_b64_tr_b16 a[250:251], v26 offset:256
    ds_read_b64_tr_b16 a[252:253], v26 offset:2048
    ds_read_b64_tr_b16 a[254:255], v26 offset:2304
    s_waitcnt lgkmcnt(0)
    s_waitcnt vmcnt(12)
    s_barrier
    v_add_u32 v22, 114688, v21
    v_xor_b32 v26, 32, v22
    ds_read_b64_tr_b16 v[128:129], v22 offset:0
    ds_read_b64_tr_b16 v[130:131], v22 offset:256
    ds_read_b64_tr_b16 v[132:133], v22 offset:2048
    ds_read_b64_tr_b16 v[134:135], v22 offset:2304
    ds_read_b64_tr_b16 v[192:193], v26 offset:0
    ds_read_b64_tr_b16 v[194:195], v26 offset:256
    ds_read_b64_tr_b16 v[196:197], v26 offset:2048
    ds_read_b64_tr_b16 v[198:199], v26 offset:2304
    s_waitcnt lgkmcnt(0)
    s_waitcnt vmcnt(8)
    s_barrier
    v_add_u32 v22, 147456, v21
    v_xor_b32 v26, 32, v22
    ds_read_b64_tr_b16 v[136:137], v22 offset:0
    ds_read_b64_tr_b16 v[138:139], v22 offset:256
    ds_read_b64_tr_b16 v[140:141], v22 offset:2048
    ds_read_b64_tr_b16 v[142:143], v22 offset:2304
    ds_read_b64_tr_b16 v[200:201], v26 offset:0
    ds_read_b64_tr_b16 v[202:203], v26 offset:256
    ds_read_b64_tr_b16 v[204:205], v26 offset:2048
    ds_read_b64_tr_b16 v[206:207], v26 offset:2304
    s_waitcnt lgkmcnt(0)
    s_waitcnt vmcnt(4)
    s_barrier
    v_xor_b32 v24, 0, v23
    s_add_u32 m0, s29, 16384
    s_add_u32 s33, s31, 65536
    buffer_load_dwordx4 v24, s[16:19], s33 offen lds
    s_add_u32 m0, s29, 17408
    s_add_u32 s33, s31, 69632
    buffer_load_dwordx4 v24, s[16:19], s33 offen lds
    s_add_u32 m0, s29, 18432
    s_add_u32 s33, s31, 73728
    buffer_load_dwordx4 v24, s[16:19], s33 offen lds
    s_add_u32 m0, s29, 19456
    s_add_u32 s33, s31, 77824
    buffer_load_dwordx4 v24, s[16:19], s33 offen lds
    v_xor_b32 v24, 64, v23
    s_add_u32 m0, s29, 20480
    s_add_u32 s33, s31, 81920
    buffer_load_dwordx4 v24, s[16:19], s33 offen lds
    s_add_u32 m0, s29, 21504
    s_add_u32 s33, s31, 86016
    buffer_load_dwordx4 v24, s[16:19], s33 offen lds
    s_add_u32 m0, s29, 22528
    s_add_u32 s33, s31, 90112
    buffer_load_dwordx4 v24, s[16:19], s33 offen lds
    s_add_u32 m0, s29, 23552
    s_add_u32 s33, s31, 94208
    buffer_load_dwordx4 v24, s[16:19], s33 offen lds
    v_xor_b32 v24, 128, v23
    s_add_u32 m0, s29, 24576
    s_add_u32 s33, s31, 98304
    buffer_load_dwordx4 v24, s[16:19], s33 offen lds
    s_add_u32 m0, s29, 25600
    s_add_u32 s33, s31, 102400
    buffer_load_dwordx4 v24, s[16:19], s33 offen lds
    s_add_u32 m0, s29, 26624
    s_add_u32 s33, s31, 106496
    buffer_load_dwordx4 v24, s[16:19], s33 offen lds
    s_add_u32 m0, s29, 27648
    s_add_u32 s33, s31, 110592
    buffer_load_dwordx4 v24, s[16:19], s33 offen lds
    v_xor_b32 v24, 192, v23
    s_add_u32 m0, s29, 28672
    s_add_u32 s33, s31, 114688
    buffer_load_dwordx4 v24, s[16:19], s33 offen lds
    s_add_u32 m0, s29, 29696
    s_add_u32 s33, s31, 118784
    buffer_load_dwordx4 v24, s[16:19], s33 offen lds
    s_add_u32 m0, s29, 30720
    s_add_u32 s33, s31, 122880
    buffer_load_dwordx4 v24, s[16:19], s33 offen lds
    s_add_u32 m0, s29, 31744
    s_add_u32 s33, s31, 126976
    buffer_load_dwordx4 v24, s[16:19], s33 offen lds
    v_add_u32 v22, 0, v21
    v_xor_b32 v26, 32, v22
    ds_read_b64_tr_b16 v[144:145], v22 offset:0
    ds_read_b64_tr_b16 v[146:147], v22 offset:256
    ds_read_b64_tr_b16 v[148:149], v22 offset:2048
    ds_read_b64_tr_b16 v[150:151], v22 offset:2304
    ds_read_b64_tr_b16 v[208:209], v26 offset:0
    ds_read_b64_tr_b16 v[210:211], v26 offset:256
    ds_read_b64_tr_b16 v[212:213], v26 offset:2048
    ds_read_b64_tr_b16 v[214:215], v26 offset:2304
    s_waitcnt lgkmcnt(0)
    s_waitcnt vmcnt(16)
    s_barrier
    s_add_u32 m0, s30, 0
    s_add_u32 s33, s28, 2097152
    buffer_load_dwordx4 v20, s[12:15], s33 offen lds
    s_add_u32 m0, s30, 1024
    s_add_u32 s33, s28, 2129920
    buffer_load_dwordx4 v20, s[12:15], s33 offen lds
    s_add_u32 m0, s30, 2048
    s_add_u32 s33, s28, 2162688
    buffer_load_dwordx4 v20, s[12:15], s33 offen lds
    s_add_u32 m0, s30, 3072
    s_add_u32 s33, s28, 2195456
    buffer_load_dwordx4 v20, s[12:15], s33 offen lds
    v_add_u32 v22, 16384, v21
    v_xor_b32 v26, 32, v22
    ds_read_b64_tr_b16 v[152:153], v22 offset:0
    ds_read_b64_tr_b16 v[154:155], v22 offset:256
    ds_read_b64_tr_b16 v[156:157], v22 offset:2048
    ds_read_b64_tr_b16 v[158:159], v22 offset:2304
    ds_read_b64_tr_b16 v[216:217], v26 offset:0
    ds_read_b64_tr_b16 v[218:219], v26 offset:256
    ds_read_b64_tr_b16 v[220:221], v26 offset:2048
    ds_read_b64_tr_b16 v[222:223], v26 offset:2304
    s_waitcnt lgkmcnt(0)
    s_waitcnt vmcnt(0)
    s_barrier
    s_add_u32 m0, s30, 16384
    s_add_u32 s33, s28, 2621440
    buffer_load_dwordx4 v20, s[12:15], s33 offen lds
    s_add_u32 m0, s30, 17408
    s_add_u32 s33, s28, 2654208
    buffer_load_dwordx4 v20, s[12:15], s33 offen lds
    s_add_u32 m0, s30, 18432
    s_add_u32 s33, s28, 2686976
    buffer_load_dwordx4 v20, s[12:15], s33 offen lds
    s_add_u32 m0, s30, 19456
    s_add_u32 s33, s28, 2719744
    buffer_load_dwordx4 v20, s[12:15], s33 offen lds
    v_add_u32 v22, 0, v21
    v_xor_b32 v26, 32, v22
    ds_read_b64_tr_b16 v[160:161], v22 offset:0
    ds_read_b64_tr_b16 v[162:163], v22 offset:256
    ds_read_b64_tr_b16 v[164:165], v22 offset:2048
    ds_read_b64_tr_b16 v[166:167], v22 offset:2304
    ds_read_b64_tr_b16 v[224:225], v26 offset:0
    ds_read_b64_tr_b16 v[226:227], v26 offset:256
    ds_read_b64_tr_b16 v[228:229], v26 offset:2048
    ds_read_b64_tr_b16 v[230:231], v26 offset:2304
    s_waitcnt lgkmcnt(0)
    s_waitcnt vmcnt(0)
    s_barrier
    s_add_u32 m0, s30, 0
    s_add_u32 s33, s28, 3145728
    buffer_load_dwordx4 v20, s[12:15], s33 offen lds
    s_add_u32 m0, s30, 1024
    s_add_u32 s33, s28, 3178496
    buffer_load_dwordx4 v20, s[12:15], s33 offen lds
    s_add_u32 m0, s30, 2048
    s_add_u32 s33, s28, 3211264
    buffer_load_dwordx4 v20, s[12:15], s33 offen lds
    s_add_u32 m0, s30, 3072
    s_add_u32 s33, s28, 3244032
    buffer_load_dwordx4 v20, s[12:15], s33 offen lds
    v_add_u32 v22, 16384, v21
    v_xor_b32 v26, 32, v22
    ds_read_b64_tr_b16 v[168:169], v22 offset:0
    ds_read_b64_tr_b16 v[170:171], v22 offset:256
    ds_read_b64_tr_b16 v[172:173], v22 offset:2048
    ds_read_b64_tr_b16 v[174:175], v22 offset:2304
    ds_read_b64_tr_b16 v[232:233], v26 offset:0
    ds_read_b64_tr_b16 v[234:235], v26 offset:256
    ds_read_b64_tr_b16 v[236:237], v26 offset:2048
    ds_read_b64_tr_b16 v[238:239], v26 offset:2304
    s_waitcnt lgkmcnt(0)
    ds_read_b64_tr_b16 v[32:33], v25 offset:16384
    ds_read_b64_tr_b16 v[34:35], v25 offset:16896
    ds_read_b64_tr_b16 v[36:37], v25 offset:18432
    ds_read_b64_tr_b16 v[38:39], v25 offset:18944
    v_xor_b32 v27, 32, v25
    ds_read_b64_tr_b16 v[40:41], v27 offset:16384
    ds_read_b64_tr_b16 v[42:43], v27 offset:16896
    ds_read_b64_tr_b16 v[44:45], v27 offset:18432
    ds_read_b64_tr_b16 v[46:47], v27 offset:18944
    s_waitcnt lgkmcnt(0)
    v_xor_b32 v27, 64, v25
    ds_read_b64_tr_b16 v[48:49], v27 offset:16384
    ds_read_b64_tr_b16 v[50:51], v27 offset:16896
    ds_read_b64_tr_b16 v[52:53], v27 offset:18432
    ds_read_b64_tr_b16 v[54:55], v27 offset:18944
    v_xor_b32 v27, 96, v25
    ds_read_b64_tr_b16 v[56:57], v27 offset:16384
    ds_read_b64_tr_b16 v[58:59], v27 offset:16896
    ds_read_b64_tr_b16 v[60:61], v27 offset:18432
    ds_read_b64_tr_b16 v[62:63], v27 offset:18944
    s_waitcnt lgkmcnt(0)
    v_xor_b32 v27, 128, v25
    ds_read_b64_tr_b16 v[64:65], v27 offset:16384
    ds_read_b64_tr_b16 v[66:67], v27 offset:16896
    ds_read_b64_tr_b16 v[68:69], v27 offset:18432
    ds_read_b64_tr_b16 v[70:71], v27 offset:18944
    v_xor_b32 v27, 160, v25
    ds_read_b64_tr_b16 v[72:73], v27 offset:16384
    ds_read_b64_tr_b16 v[74:75], v27 offset:16896
    ds_read_b64_tr_b16 v[76:77], v27 offset:18432
    ds_read_b64_tr_b16 v[78:79], v27 offset:18944
    s_waitcnt lgkmcnt(0)
    v_xor_b32 v27, 192, v25
    ds_read_b64_tr_b16 v[80:81], v27 offset:16384
    ds_read_b64_tr_b16 v[82:83], v27 offset:16896
    ds_read_b64_tr_b16 v[84:85], v27 offset:18432
    ds_read_b64_tr_b16 v[86:87], v27 offset:18944
    v_xor_b32 v27, 224, v25
    ds_read_b64_tr_b16 v[88:89], v27 offset:16384
    ds_read_b64_tr_b16 v[90:91], v27 offset:16896
    ds_read_b64_tr_b16 v[92:93], v27 offset:18432
    ds_read_b64_tr_b16 v[94:95], v27 offset:18944
    s_waitcnt lgkmcnt(0)
    ds_write_b128 v119, v[32:35] offset:16384
    ds_write_b128 v119, v[36:39] offset:17408
    ds_write_b128 v119, v[40:43] offset:18432
    ds_write_b128 v119, v[44:47] offset:19456
    ds_write_b128 v119, v[48:51] offset:20480
    ds_write_b128 v119, v[52:55] offset:21504
    ds_write_b128 v119, v[56:59] offset:22528
    ds_write_b128 v119, v[60:63] offset:23552
    s_waitcnt lgkmcnt(0)
    ds_write_b128 v119, v[64:67] offset:24576
    ds_write_b128 v119, v[68:71] offset:25600
    ds_write_b128 v119, v[72:75] offset:26624
    ds_write_b128 v119, v[76:79] offset:27648
    ds_write_b128 v119, v[80:83] offset:28672
    ds_write_b128 v119, v[84:87] offset:29696
    ds_write_b128 v119, v[88:91] offset:30720
    ds_write_b128 v119, v[92:95] offset:31744
    s_waitcnt lgkmcnt(0)
    s_waitcnt vmcnt(0)
    s_barrier
    s_add_u32 m0, s30, 16384
    s_add_u32 s33, s28, 3670016
    buffer_load_dwordx4 v20, s[12:15], s33 offen lds
    s_add_u32 m0, s30, 17408
    s_add_u32 s33, s28, 3702784
    buffer_load_dwordx4 v20, s[12:15], s33 offen lds
    s_add_u32 m0, s30, 18432
    s_add_u32 s33, s28, 3735552
    buffer_load_dwordx4 v20, s[12:15], s33 offen lds
    s_add_u32 m0, s30, 19456
    s_add_u32 s33, s28, 3768320
    buffer_load_dwordx4 v20, s[12:15], s33 offen lds
    v_add_u32 v22, 0, v21
    v_xor_b32 v26, 32, v22
    ds_read_b64_tr_b16 v[176:177], v22 offset:0
    ds_read_b64_tr_b16 v[178:179], v22 offset:256
    ds_read_b64_tr_b16 v[180:181], v22 offset:2048
    ds_read_b64_tr_b16 v[182:183], v22 offset:2304
    ds_read_b64_tr_b16 v[240:241], v26 offset:0
    ds_read_b64_tr_b16 v[242:243], v26 offset:256
    ds_read_b64_tr_b16 v[244:245], v26 offset:2048
    ds_read_b64_tr_b16 v[246:247], v26 offset:2304
    s_waitcnt lgkmcnt(0)
    s_waitcnt vmcnt(0)
    s_barrier
    v_add_u32 v22, 16384, v21
    v_xor_b32 v26, 32, v22
    ds_read_b64_tr_b16 v[184:185], v22 offset:0
    ds_read_b64_tr_b16 v[186:187], v22 offset:256
    ds_read_b64_tr_b16 v[188:189], v22 offset:2048
    ds_read_b64_tr_b16 v[190:191], v22 offset:2304
    ds_read_b64_tr_b16 v[248:249], v26 offset:0
    ds_read_b64_tr_b16 v[250:251], v26 offset:256
    ds_read_b64_tr_b16 v[252:253], v26 offset:2048
    ds_read_b64_tr_b16 v[254:255], v26 offset:2304
    s_waitcnt lgkmcnt(0)
    s_branch L_wl_done
L_wl_1:
    s_add_u32 m0, s30, 0
    s_add_u32 s33, s28, 0
    buffer_load_dwordx4 v20, s[4:7], s33 offen lds
    s_add_u32 m0, s30, 1024
    s_add_u32 s33, s28, 32768
    buffer_load_dwordx4 v20, s[4:7], s33 offen lds
    s_add_u32 m0, s30, 2048
    s_add_u32 s33, s28, 65536
    buffer_load_dwordx4 v20, s[4:7], s33 offen lds
    s_add_u32 m0, s30, 3072
    s_add_u32 s33, s28, 98304
    buffer_load_dwordx4 v20, s[4:7], s33 offen lds
    s_add_u32 m0, s30, 16384
    s_add_u32 s33, s28, 524288
    buffer_load_dwordx4 v20, s[4:7], s33 offen lds
    s_add_u32 m0, s30, 17408
    s_add_u32 s33, s28, 557056
    buffer_load_dwordx4 v20, s[4:7], s33 offen lds
    s_add_u32 m0, s30, 18432
    s_add_u32 s33, s28, 589824
    buffer_load_dwordx4 v20, s[4:7], s33 offen lds
    s_add_u32 m0, s30, 19456
    s_add_u32 s33, s28, 622592
    buffer_load_dwordx4 v20, s[4:7], s33 offen lds
    s_add_u32 m0, s30, 49152
    s_add_u32 s33, s28, 1048576
    buffer_load_dwordx4 v20, s[4:7], s33 offen lds
    s_add_u32 m0, s30, 50176
    s_add_u32 s33, s28, 1081344
    buffer_load_dwordx4 v20, s[4:7], s33 offen lds
    s_add_u32 m0, s30, 51200
    s_add_u32 s33, s28, 1114112
    buffer_load_dwordx4 v20, s[4:7], s33 offen lds
    s_add_u32 m0, s30, 52224
    s_add_u32 s33, s28, 1146880
    buffer_load_dwordx4 v20, s[4:7], s33 offen lds
    s_add_u32 m0, s30, 81920
    s_add_u32 s33, s28, 1572864
    buffer_load_dwordx4 v20, s[4:7], s33 offen lds
    s_add_u32 m0, s30, 82944
    s_add_u32 s33, s28, 1605632
    buffer_load_dwordx4 v20, s[4:7], s33 offen lds
    s_add_u32 m0, s30, 83968
    s_add_u32 s33, s28, 1638400
    buffer_load_dwordx4 v20, s[4:7], s33 offen lds
    s_add_u32 m0, s30, 84992
    s_add_u32 s33, s28, 1671168
    buffer_load_dwordx4 v20, s[4:7], s33 offen lds
    s_add_u32 m0, s30, 114688
    s_add_u32 s33, s28, 2097152
    buffer_load_dwordx4 v20, s[4:7], s33 offen lds
    s_add_u32 m0, s30, 115712
    s_add_u32 s33, s28, 2129920
    buffer_load_dwordx4 v20, s[4:7], s33 offen lds
    s_add_u32 m0, s30, 116736
    s_add_u32 s33, s28, 2162688
    buffer_load_dwordx4 v20, s[4:7], s33 offen lds
    s_add_u32 m0, s30, 117760
    s_add_u32 s33, s28, 2195456
    buffer_load_dwordx4 v20, s[4:7], s33 offen lds
    s_add_u32 m0, s30, 147456
    s_add_u32 s33, s28, 2621440
    buffer_load_dwordx4 v20, s[4:7], s33 offen lds
    s_add_u32 m0, s30, 148480
    s_add_u32 s33, s28, 2654208
    buffer_load_dwordx4 v20, s[4:7], s33 offen lds
    s_add_u32 m0, s30, 149504
    s_add_u32 s33, s28, 2686976
    buffer_load_dwordx4 v20, s[4:7], s33 offen lds
    s_add_u32 m0, s30, 150528
    s_add_u32 s33, s28, 2719744
    buffer_load_dwordx4 v20, s[4:7], s33 offen lds
    s_waitcnt vmcnt(20)
    s_barrier
    v_xor_b32 v24, 0, v23
    s_add_u32 m0, s29, 0
    s_add_u32 s33, s31, 0
    buffer_load_dwordx4 v24, s[16:19], s33 offen lds
    s_add_u32 m0, s29, 1024
    s_add_u32 s33, s31, 4096
    buffer_load_dwordx4 v24, s[16:19], s33 offen lds
    s_add_u32 m0, s29, 2048
    s_add_u32 s33, s31, 8192
    buffer_load_dwordx4 v24, s[16:19], s33 offen lds
    s_add_u32 m0, s29, 3072
    s_add_u32 s33, s31, 12288
    buffer_load_dwordx4 v24, s[16:19], s33 offen lds
    v_add_u32 v22, 0, v21
    v_xor_b32 v26, 32, v22
    ds_read_b64_tr_b16 a[48:49], v22 offset:0
    ds_read_b64_tr_b16 a[50:51], v22 offset:256
    ds_read_b64_tr_b16 a[52:53], v22 offset:2048
    ds_read_b64_tr_b16 a[54:55], v22 offset:2304
    ds_read_b64_tr_b16 a[112:113], v26 offset:0
    ds_read_b64_tr_b16 a[114:115], v26 offset:256
    ds_read_b64_tr_b16 a[116:117], v26 offset:2048
    ds_read_b64_tr_b16 a[118:119], v26 offset:2304
    s_waitcnt lgkmcnt(0)
    s_waitcnt vmcnt(20)
    s_barrier
    s_add_u32 m0, s30, 0
    s_add_u32 s33, s28, 3145728
    buffer_load_dwordx4 v20, s[4:7], s33 offen lds
    s_add_u32 m0, s30, 1024
    s_add_u32 s33, s28, 3178496
    buffer_load_dwordx4 v20, s[4:7], s33 offen lds
    s_add_u32 m0, s30, 2048
    s_add_u32 s33, s28, 3211264
    buffer_load_dwordx4 v20, s[4:7], s33 offen lds
    s_add_u32 m0, s30, 3072
    s_add_u32 s33, s28, 3244032
    buffer_load_dwordx4 v20, s[4:7], s33 offen lds
    v_xor_b32 v24, 64, v23
    s_add_u32 m0, s29, 4096
    s_add_u32 s33, s31, 16384
    buffer_load_dwordx4 v24, s[16:19], s33 offen lds
    s_add_u32 m0, s29, 5120
    s_add_u32 s33, s31, 20480
    buffer_load_dwordx4 v24, s[16:19], s33 offen lds
    s_add_u32 m0, s29, 6144
    s_add_u32 s33, s31, 24576
    buffer_load_dwordx4 v24, s[16:19], s33 offen lds
    s_add_u32 m0, s29, 7168
    s_add_u32 s33, s31, 28672
    buffer_load_dwordx4 v24, s[16:19], s33 offen lds
    v_add_u32 v22, 16384, v21
    v_xor_b32 v26, 32, v22
    ds_read_b64_tr_b16 a[56:57], v22 offset:0
    ds_read_b64_tr_b16 a[58:59], v22 offset:256
    ds_read_b64_tr_b16 a[60:61], v22 offset:2048
    ds_read_b64_tr_b16 a[62:63], v22 offset:2304
    ds_read_b64_tr_b16 a[120:121], v26 offset:0
    ds_read_b64_tr_b16 a[122:123], v26 offset:256
    ds_read_b64_tr_b16 a[124:125], v26 offset:2048
    ds_read_b64_tr_b16 a[126:127], v26 offset:2304
    s_waitcnt lgkmcnt(0)
    s_waitcnt vmcnt(24)
    s_barrier
    s_add_u32 m0, s30, 16384
    s_add_u32 s33, s28, 3670016
    buffer_load_dwordx4 v20, s[4:7], s33 offen lds
    s_add_u32 m0, s30, 17408
    s_add_u32 s33, s28, 3702784
    buffer_load_dwordx4 v20, s[4:7], s33 offen lds
    s_add_u32 m0, s30, 18432
    s_add_u32 s33, s28, 3735552
    buffer_load_dwordx4 v20, s[4:7], s33 offen lds
    s_add_u32 m0, s30, 19456
    s_add_u32 s33, s28, 3768320
    buffer_load_dwordx4 v20, s[4:7], s33 offen lds
    v_xor_b32 v24, 128, v23
    s_add_u32 m0, s29, 8192
    s_add_u32 s33, s31, 32768
    buffer_load_dwordx4 v24, s[16:19], s33 offen lds
    s_add_u32 m0, s29, 9216
    s_add_u32 s33, s31, 36864
    buffer_load_dwordx4 v24, s[16:19], s33 offen lds
    s_add_u32 m0, s29, 10240
    s_add_u32 s33, s31, 40960
    buffer_load_dwordx4 v24, s[16:19], s33 offen lds
    s_add_u32 m0, s29, 11264
    s_add_u32 s33, s31, 45056
    buffer_load_dwordx4 v24, s[16:19], s33 offen lds
    v_add_u32 v22, 49152, v21
    v_xor_b32 v26, 32, v22
    ds_read_b64_tr_b16 a[0:1], v22 offset:0
    ds_read_b64_tr_b16 a[2:3], v22 offset:256
    ds_read_b64_tr_b16 a[4:5], v22 offset:2048
    ds_read_b64_tr_b16 a[6:7], v22 offset:2304
    ds_read_b64_tr_b16 a[64:65], v26 offset:0
    ds_read_b64_tr_b16 a[66:67], v26 offset:256
    ds_read_b64_tr_b16 a[68:69], v26 offset:2048
    ds_read_b64_tr_b16 a[70:71], v26 offset:2304
    s_waitcnt lgkmcnt(0)
    s_waitcnt vmcnt(28)
    s_barrier
    s_add_u32 m0, s30, 49152
    s_add_u32 s33, s28, 0
    buffer_load_dwordx4 v20, s[8:11], s33 offen lds
    s_add_u32 m0, s30, 50176
    s_add_u32 s33, s28, 32768
    buffer_load_dwordx4 v20, s[8:11], s33 offen lds
    s_add_u32 m0, s30, 51200
    s_add_u32 s33, s28, 65536
    buffer_load_dwordx4 v20, s[8:11], s33 offen lds
    s_add_u32 m0, s30, 52224
    s_add_u32 s33, s28, 98304
    buffer_load_dwordx4 v20, s[8:11], s33 offen lds
    v_xor_b32 v24, 192, v23
    s_add_u32 m0, s29, 12288
    s_add_u32 s33, s31, 49152
    buffer_load_dwordx4 v24, s[16:19], s33 offen lds
    s_add_u32 m0, s29, 13312
    s_add_u32 s33, s31, 53248
    buffer_load_dwordx4 v24, s[16:19], s33 offen lds
    s_add_u32 m0, s29, 14336
    s_add_u32 s33, s31, 57344
    buffer_load_dwordx4 v24, s[16:19], s33 offen lds
    s_add_u32 m0, s29, 15360
    s_add_u32 s33, s31, 61440
    buffer_load_dwordx4 v24, s[16:19], s33 offen lds
    v_add_u32 v22, 81920, v21
    v_xor_b32 v26, 32, v22
    ds_read_b64_tr_b16 a[8:9], v22 offset:0
    ds_read_b64_tr_b16 a[10:11], v22 offset:256
    ds_read_b64_tr_b16 a[12:13], v22 offset:2048
    ds_read_b64_tr_b16 a[14:15], v22 offset:2304
    ds_read_b64_tr_b16 a[72:73], v26 offset:0
    ds_read_b64_tr_b16 a[74:75], v26 offset:256
    ds_read_b64_tr_b16 a[76:77], v26 offset:2048
    ds_read_b64_tr_b16 a[78:79], v26 offset:2304
    s_waitcnt lgkmcnt(0)
    s_waitcnt vmcnt(32)
    s_barrier
    s_add_u32 m0, s30, 81920
    s_add_u32 s33, s28, 524288
    buffer_load_dwordx4 v20, s[8:11], s33 offen lds
    s_add_u32 m0, s30, 82944
    s_add_u32 s33, s28, 557056
    buffer_load_dwordx4 v20, s[8:11], s33 offen lds
    s_add_u32 m0, s30, 83968
    s_add_u32 s33, s28, 589824
    buffer_load_dwordx4 v20, s[8:11], s33 offen lds
    s_add_u32 m0, s30, 84992
    s_add_u32 s33, s28, 622592
    buffer_load_dwordx4 v20, s[8:11], s33 offen lds
    v_add_u32 v22, 114688, v21
    v_xor_b32 v26, 32, v22
    ds_read_b64_tr_b16 a[16:17], v22 offset:0
    ds_read_b64_tr_b16 a[18:19], v22 offset:256
    ds_read_b64_tr_b16 a[20:21], v22 offset:2048
    ds_read_b64_tr_b16 a[22:23], v22 offset:2304
    ds_read_b64_tr_b16 a[80:81], v26 offset:0
    ds_read_b64_tr_b16 a[82:83], v26 offset:256
    ds_read_b64_tr_b16 a[84:85], v26 offset:2048
    ds_read_b64_tr_b16 a[86:87], v26 offset:2304
    s_waitcnt lgkmcnt(0)
    s_waitcnt vmcnt(32)
    s_barrier
    s_add_u32 m0, s30, 114688
    s_add_u32 s33, s28, 1048576
    buffer_load_dwordx4 v20, s[8:11], s33 offen lds
    s_add_u32 m0, s30, 115712
    s_add_u32 s33, s28, 1081344
    buffer_load_dwordx4 v20, s[8:11], s33 offen lds
    s_add_u32 m0, s30, 116736
    s_add_u32 s33, s28, 1114112
    buffer_load_dwordx4 v20, s[8:11], s33 offen lds
    s_add_u32 m0, s30, 117760
    s_add_u32 s33, s28, 1146880
    buffer_load_dwordx4 v20, s[8:11], s33 offen lds
    v_add_u32 v22, 147456, v21
    v_xor_b32 v26, 32, v22
    ds_read_b64_tr_b16 a[24:25], v22 offset:0
    ds_read_b64_tr_b16 a[26:27], v22 offset:256
    ds_read_b64_tr_b16 a[28:29], v22 offset:2048
    ds_read_b64_tr_b16 a[30:31], v22 offset:2304
    ds_read_b64_tr_b16 a[88:89], v26 offset:0
    ds_read_b64_tr_b16 a[90:91], v26 offset:256
    ds_read_b64_tr_b16 a[92:93], v26 offset:2048
    ds_read_b64_tr_b16 a[94:95], v26 offset:2304
    s_waitcnt lgkmcnt(0)
    s_waitcnt vmcnt(28)
    s_barrier
    s_add_u32 m0, s30, 147456
    s_add_u32 s33, s28, 1572864
    buffer_load_dwordx4 v20, s[8:11], s33 offen lds
    s_add_u32 m0, s30, 148480
    s_add_u32 s33, s28, 1605632
    buffer_load_dwordx4 v20, s[8:11], s33 offen lds
    s_add_u32 m0, s30, 149504
    s_add_u32 s33, s28, 1638400
    buffer_load_dwordx4 v20, s[8:11], s33 offen lds
    s_add_u32 m0, s30, 150528
    s_add_u32 s33, s28, 1671168
    buffer_load_dwordx4 v20, s[8:11], s33 offen lds
    v_add_u32 v22, 0, v21
    v_xor_b32 v26, 32, v22
    ds_read_b64_tr_b16 a[32:33], v22 offset:0
    ds_read_b64_tr_b16 a[34:35], v22 offset:256
    ds_read_b64_tr_b16 a[36:37], v22 offset:2048
    ds_read_b64_tr_b16 a[38:39], v22 offset:2304
    ds_read_b64_tr_b16 a[96:97], v26 offset:0
    ds_read_b64_tr_b16 a[98:99], v26 offset:256
    ds_read_b64_tr_b16 a[100:101], v26 offset:2048
    ds_read_b64_tr_b16 a[102:103], v26 offset:2304
    s_waitcnt lgkmcnt(0)
    s_waitcnt vmcnt(24)
    s_barrier
    s_add_u32 m0, s30, 0
    s_add_u32 s33, s28, 2097152
    buffer_load_dwordx4 v20, s[8:11], s33 offen lds
    s_add_u32 m0, s30, 1024
    s_add_u32 s33, s28, 2129920
    buffer_load_dwordx4 v20, s[8:11], s33 offen lds
    s_add_u32 m0, s30, 2048
    s_add_u32 s33, s28, 2162688
    buffer_load_dwordx4 v20, s[8:11], s33 offen lds
    s_add_u32 m0, s30, 3072
    s_add_u32 s33, s28, 2195456
    buffer_load_dwordx4 v20, s[8:11], s33 offen lds
    v_add_u32 v22, 16384, v21
    v_xor_b32 v26, 32, v22
    ds_read_b64_tr_b16 a[40:41], v22 offset:0
    ds_read_b64_tr_b16 a[42:43], v22 offset:256
    ds_read_b64_tr_b16 a[44:45], v22 offset:2048
    ds_read_b64_tr_b16 a[46:47], v22 offset:2304
    ds_read_b64_tr_b16 a[104:105], v26 offset:0
    ds_read_b64_tr_b16 a[106:107], v26 offset:256
    ds_read_b64_tr_b16 a[108:109], v26 offset:2048
    ds_read_b64_tr_b16 a[110:111], v26 offset:2304
    s_waitcnt lgkmcnt(0)
    s_waitcnt vmcnt(20)
    s_barrier
    s_add_u32 m0, s30, 16384
    s_add_u32 s33, s28, 2621440
    buffer_load_dwordx4 v20, s[8:11], s33 offen lds
    s_add_u32 m0, s30, 17408
    s_add_u32 s33, s28, 2654208
    buffer_load_dwordx4 v20, s[8:11], s33 offen lds
    s_add_u32 m0, s30, 18432
    s_add_u32 s33, s28, 2686976
    buffer_load_dwordx4 v20, s[8:11], s33 offen lds
    s_add_u32 m0, s30, 19456
    s_add_u32 s33, s28, 2719744
    buffer_load_dwordx4 v20, s[8:11], s33 offen lds
    v_add_u32 v22, 49152, v21
    v_xor_b32 v26, 32, v22
    ds_read_b64_tr_b16 a[176:177], v22 offset:0
    ds_read_b64_tr_b16 a[178:179], v22 offset:256
    ds_read_b64_tr_b16 a[180:181], v22 offset:2048
    ds_read_b64_tr_b16 a[182:183], v22 offset:2304
    ds_read_b64_tr_b16 a[240:241], v26 offset:0
    ds_read_b64_tr_b16 a[242:243], v26 offset:256
    ds_read_b64_tr_b16 a[244:245], v26 offset:2048
    ds_read_b64_tr_b16 a[246:247], v26 offset:2304
    s_waitcnt lgkmcnt(0)
    s_waitcnt vmcnt(16)
    s_barrier
    s_add_u32 m0, s30, 49152
    s_add_u32 s33, s28, 3145728
    buffer_load_dwordx4 v20, s[8:11], s33 offen lds
    s_add_u32 m0, s30, 50176
    s_add_u32 s33, s28, 3178496
    buffer_load_dwordx4 v20, s[8:11], s33 offen lds
    s_add_u32 m0, s30, 51200
    s_add_u32 s33, s28, 3211264
    buffer_load_dwordx4 v20, s[8:11], s33 offen lds
    s_add_u32 m0, s30, 52224
    s_add_u32 s33, s28, 3244032
    buffer_load_dwordx4 v20, s[8:11], s33 offen lds
    v_add_u32 v22, 81920, v21
    v_xor_b32 v26, 32, v22
    ds_read_b64_tr_b16 a[184:185], v22 offset:0
    ds_read_b64_tr_b16 a[186:187], v22 offset:256
    ds_read_b64_tr_b16 a[188:189], v22 offset:2048
    ds_read_b64_tr_b16 a[190:191], v22 offset:2304
    ds_read_b64_tr_b16 a[248:249], v26 offset:0
    ds_read_b64_tr_b16 a[250:251], v26 offset:256
    ds_read_b64_tr_b16 a[252:253], v26 offset:2048
    ds_read_b64_tr_b16 a[254:255], v26 offset:2304
    s_waitcnt lgkmcnt(0)
    s_waitcnt vmcnt(16)
    s_barrier
    s_add_u32 m0, s30, 81920
    s_add_u32 s33, s28, 3670016
    buffer_load_dwordx4 v20, s[8:11], s33 offen lds
    s_add_u32 m0, s30, 82944
    s_add_u32 s33, s28, 3702784
    buffer_load_dwordx4 v20, s[8:11], s33 offen lds
    s_add_u32 m0, s30, 83968
    s_add_u32 s33, s28, 3735552
    buffer_load_dwordx4 v20, s[8:11], s33 offen lds
    s_add_u32 m0, s30, 84992
    s_add_u32 s33, s28, 3768320
    buffer_load_dwordx4 v20, s[8:11], s33 offen lds
    v_add_u32 v22, 114688, v21
    v_xor_b32 v26, 32, v22
    ds_read_b64_tr_b16 a[128:129], v22 offset:0
    ds_read_b64_tr_b16 a[130:131], v22 offset:256
    ds_read_b64_tr_b16 a[132:133], v22 offset:2048
    ds_read_b64_tr_b16 a[134:135], v22 offset:2304
    ds_read_b64_tr_b16 a[192:193], v26 offset:0
    ds_read_b64_tr_b16 a[194:195], v26 offset:256
    ds_read_b64_tr_b16 a[196:197], v26 offset:2048
    ds_read_b64_tr_b16 a[198:199], v26 offset:2304
    s_waitcnt lgkmcnt(0)
    ds_read_b64_tr_b16 v[32:33], v25 offset:0
    ds_read_b64_tr_b16 v[34:35], v25 offset:512
    ds_read_b64_tr_b16 v[36:37], v25 offset:2048
    ds_read_b64_tr_b16 v[38:39], v25 offset:2560
    v_xor_b32 v27, 32, v25
    ds_read_b64_tr_b16 v[40:41], v27 offset:0
    ds_read_b64_tr_b16 v[42:43], v27 offset:512
    ds_read_b64_tr_b16 v[44:45], v27 offset:2048
    ds_read_b64_tr_b16 v[46:47], v27 offset:2560
    s_waitcnt lgkmcnt(0)
    v_xor_b32 v27, 64, v25
    ds_read_b64_tr_b16 v[48:49], v27 offset:0
    ds_read_b64_tr_b16 v[50:51], v27 offset:512
    ds_read_b64_tr_b16 v[52:53], v27 offset:2048
    ds_read_b64_tr_b16 v[54:55], v27 offset:2560
    v_xor_b32 v27, 96, v25
    ds_read_b64_tr_b16 v[56:57], v27 offset:0
    ds_read_b64_tr_b16 v[58:59], v27 offset:512
    ds_read_b64_tr_b16 v[60:61], v27 offset:2048
    ds_read_b64_tr_b16 v[62:63], v27 offset:2560
    s_waitcnt lgkmcnt(0)
    v_xor_b32 v27, 128, v25
    ds_read_b64_tr_b16 v[64:65], v27 offset:0
    ds_read_b64_tr_b16 v[66:67], v27 offset:512
    ds_read_b64_tr_b16 v[68:69], v27 offset:2048
    ds_read_b64_tr_b16 v[70:71], v27 offset:2560
    v_xor_b32 v27, 160, v25
    ds_read_b64_tr_b16 v[72:73], v27 offset:0
    ds_read_b64_tr_b16 v[74:75], v27 offset:512
    ds_read_b64_tr_b16 v[76:77], v27 offset:2048
    ds_read_b64_tr_b16 v[78:79], v27 offset:2560
    s_waitcnt lgkmcnt(0)
    v_xor_b32 v27, 192, v25
    ds_read_b64_tr_b16 v[80:81], v27 offset:0
    ds_read_b64_tr_b16 v[82:83], v27 offset:512
    ds_read_b64_tr_b16 v[84:85], v27 offset:2048
    ds_read_b64_tr_b16 v[86:87], v27 offset:2560
    v_xor_b32 v27, 224, v25
    ds_read_b64_tr_b16 v[88:89], v27 offset:0
    ds_read_b64_tr_b16 v[90:91], v27 offset:512
    ds_read_b64_tr_b16 v[92:93], v27 offset:2048
    ds_read_b64_tr_b16 v[94:95], v27 offset:2560
    s_waitcnt lgkmcnt(0)
    ds_write_b128 v119, v[32:35] offset:0
    ds_write_b128 v119, v[36:39] offset:1024
    ds_write_b128 v119, v[40:43] offset:2048
    ds_write_b128 v119, v[44:47] offset:3072
    ds_write_b128 v119, v[48:51] offset:4096
    ds_write_b128 v119, v[52:55] offset:5120
    ds_write_b128 v119, v[56:59] offset:6144
    ds_write_b128 v119, v[60:63] offset:7168
    s_waitcnt lgkmcnt(0)
    ds_write_b128 v119, v[64:67] offset:8192
    ds_write_b128 v119, v[68:71] offset:9216
    ds_write_b128 v119, v[72:75] offset:10240
    ds_write_b128 v119, v[76:79] offset:11264
    ds_write_b128 v119, v[80:83] offset:12288
    ds_write_b128 v119, v[84:87] offset:13312
    ds_write_b128 v119, v[88:91] offset:14336
    ds_write_b128 v119, v[92:95] offset:15360
    s_waitcnt lgkmcnt(0)
    s_waitcnt vmcnt(16)
    s_barrier
    s_add_u32 m0, s30, 114688
    s_add_u32 s33, s28, 0
    buffer_load_dwordx4 v20, s[12:15], s33 offen lds
    s_add_u32 m0, s30, 115712
    s_add_u32 s33, s28, 32768
    buffer_load_dwordx4 v20, s[12:15], s33 offen lds
    s_add_u32 m0, s30, 116736
    s_add_u32 s33, s28, 65536
    buffer_load_dwordx4 v20, s[12:15], s33 offen lds
    s_add_u32 m0, s30, 117760
    s_add_u32 s33, s28, 98304
    buffer_load_dwordx4 v20, s[12:15], s33 offen lds
    v_add_u32 v22, 147456, v21
    v_xor_b32 v26, 32, v22
    ds_read_b64_tr_b16 a[136:137], v22 offset:0
    ds_read_b64_tr_b16 a[138:139], v22 offset:256
    ds_read_b64_tr_b16 a[140:141], v22 offset:2048
    ds_read_b64_tr_b16 a[142:143], v22 offset:2304
    ds_read_b64_tr_b16 a[200:201], v26 offset:0
    ds_read_b64_tr_b16 a[202:203], v26 offset:256
    ds_read_b64_tr_b16 a[204:205], v26 offset:2048
    ds_read_b64_tr_b16 a[206:207], v26 offset:2304
    s_waitcnt lgkmcnt(0)
    s_waitcnt vmcnt(16)
    s_barrier
    s_add_u32 m0, s30, 147456
    s_add_u32 s33, s28, 524288
    buffer_load_dwordx4 v20, s[12:15], s33 offen lds
    s_add_u32 m0, s30, 148480
    s_add_u32 s33, s28, 557056
    buffer_load_dwordx4 v20, s[12:15], s33 offen lds
    s_add_u32 m0, s30, 149504
    s_add_u32 s33, s28, 589824
    buffer_load_dwordx4 v20, s[12:15], s33 offen lds
    s_add_u32 m0, s30, 150528
    s_add_u32 s33, s28, 622592
    buffer_load_dwordx4 v20, s[12:15], s33 offen lds
    v_add_u32 v22, 0, v21
    v_xor_b32 v26, 32, v22
    ds_read_b64_tr_b16 a[144:145], v22 offset:0
    ds_read_b64_tr_b16 a[146:147], v22 offset:256
    ds_read_b64_tr_b16 a[148:149], v22 offset:2048
    ds_read_b64_tr_b16 a[150:151], v22 offset:2304
    ds_read_b64_tr_b16 a[208:209], v26 offset:0
    ds_read_b64_tr_b16 a[210:211], v26 offset:256
    ds_read_b64_tr_b16 a[212:213], v26 offset:2048
    ds_read_b64_tr_b16 a[214:215], v26 offset:2304
    s_waitcnt lgkmcnt(0)
    s_waitcnt vmcnt(16)
    s_barrier
    s_add_u32 m0, s30, 0
    s_add_u32 s33, s28, 1048576
    buffer_load_dwordx4 v20, s[12:15], s33 offen lds
    s_add_u32 m0, s30, 1024
    s_add_u32 s33, s28, 1081344
    buffer_load_dwordx4 v20, s[12:15], s33 offen lds
    s_add_u32 m0, s30, 2048
    s_add_u32 s33, s28, 1114112
    buffer_load_dwordx4 v20, s[12:15], s33 offen lds
    s_add_u32 m0, s30, 3072
    s_add_u32 s33, s28, 1146880
    buffer_load_dwordx4 v20, s[12:15], s33 offen lds
    v_add_u32 v22, 16384, v21
    v_xor_b32 v26, 32, v22
    ds_read_b64_tr_b16 a[152:153], v22 offset:0
    ds_read_b64_tr_b16 a[154:155], v22 offset:256
    ds_read_b64_tr_b16 a[156:157], v22 offset:2048
    ds_read_b64_tr_b16 a[158:159], v22 offset:2304
    ds_read_b64_tr_b16 a[216:217], v26 offset:0
    ds_read_b64_tr_b16 a[218:219], v26 offset:256
    ds_read_b64_tr_b16 a[220:221], v26 offset:2048
    ds_read_b64_tr_b16 a[222:223], v26 offset:2304
    s_waitcnt lgkmcnt(0)
    s_waitcnt vmcnt(16)
    s_barrier
    s_add_u32 m0, s30, 16384
    s_add_u32 s33, s28, 1572864
    buffer_load_dwordx4 v20, s[12:15], s33 offen lds
    s_add_u32 m0, s30, 17408
    s_add_u32 s33, s28, 1605632
    buffer_load_dwordx4 v20, s[12:15], s33 offen lds
    s_add_u32 m0, s30, 18432
    s_add_u32 s33, s28, 1638400
    buffer_load_dwordx4 v20, s[12:15], s33 offen lds
    s_add_u32 m0, s30, 19456
    s_add_u32 s33, s28, 1671168
    buffer_load_dwordx4 v20, s[12:15], s33 offen lds
    v_add_u32 v22, 49152, v21
    v_xor_b32 v26, 32, v22
    ds_read_b64_tr_b16 a[160:161], v22 offset:0
    ds_read_b64_tr_b16 a[162:163], v22 offset:256
    ds_read_b64_tr_b16 a[164:165], v22 offset:2048
    ds_read_b64_tr_b16 a[166:167], v22 offset:2304
    ds_read_b64_tr_b16 a[224:225], v26 offset:0
    ds_read_b64_tr_b16 a[226:227], v26 offset:256
    ds_read_b64_tr_b16 a[228:229], v26 offset:2048
    ds_read_b64_tr_b16 a[230:231], v26 offset:2304
    s_waitcnt lgkmcnt(0)
    s_waitcnt vmcnt(16)
    s_barrier
    v_add_u32 v22, 81920, v21
    v_xor_b32 v26, 32, v22
    ds_read_b64_tr_b16 a[168:169], v22 offset:0
    ds_read_b64_tr_b16 a[170:171], v22 offset:256
    ds_read_b64_tr_b16 a[172:173], v22 offset:2048
    ds_read_b64_tr_b16 a[174:175], v22 offset:2304
    ds_read_b64_tr_b16 a[232:233], v26 offset:0
    ds_read_b64_tr_b16 a[234:235], v26 offset:256
    ds_read_b64_tr_b16 a[236:237], v26 offset:2048
    ds_read_b64_tr_b16 a[238:239], v26 offset:2304
    s_waitcnt lgkmcnt(0)
    s_waitcnt vmcnt(12)
    s_barrier
    v_add_u32 v22, 114688, v21
    v_xor_b32 v26, 32, v22
    ds_read_b64_tr_b16 v[176:177], v22 offset:0
    ds_read_b64_tr_b16 v[178:179], v22 offset:256
    ds_read_b64_tr_b16 v[180:181], v22 offset:2048
    ds_read_b64_tr_b16 v[182:183], v22 offset:2304
    ds_read_b64_tr_b16 v[240:241], v26 offset:0
    ds_read_b64_tr_b16 v[242:243], v26 offset:256
    ds_read_b64_tr_b16 v[244:245], v26 offset:2048
    ds_read_b64_tr_b16 v[246:247], v26 offset:2304
    s_waitcnt lgkmcnt(0)
    s_waitcnt vmcnt(8)
    s_barrier
    v_add_u32 v22, 147456, v21
    v_xor_b32 v26, 32, v22
    ds_read_b64_tr_b16 v[184:185], v22 offset:0
    ds_read_b64_tr_b16 v[186:187], v22 offset:256
    ds_read_b64_tr_b16 v[188:189], v22 offset:2048
    ds_read_b64_tr_b16 v[190:191], v22 offset:2304
    ds_read_b64_tr_b16 v[248:249], v26 offset:0
    ds_read_b64_tr_b16 v[250:251], v26 offset:256
    ds_read_b64_tr_b16 v[252:253], v26 offset:2048
    ds_read_b64_tr_b16 v[254:255], v26 offset:2304
    s_waitcnt lgkmcnt(0)
    s_waitcnt vmcnt(4)
    s_barrier
    v_xor_b32 v24, 0, v23
    s_add_u32 m0, s29, 16384
    s_add_u32 s33, s31, 65536
    buffer_load_dwordx4 v24, s[16:19], s33 offen lds
    s_add_u32 m0, s29, 17408
    s_add_u32 s33, s31, 69632
    buffer_load_dwordx4 v24, s[16:19], s33 offen lds
    s_add_u32 m0, s29, 18432
    s_add_u32 s33, s31, 73728
    buffer_load_dwordx4 v24, s[16:19], s33 offen lds
    s_add_u32 m0, s29, 19456
    s_add_u32 s33, s31, 77824
    buffer_load_dwordx4 v24, s[16:19], s33 offen lds
    v_xor_b32 v24, 64, v23
    s_add_u32 m0, s29, 20480
    s_add_u32 s33, s31, 81920
    buffer_load_dwordx4 v24, s[16:19], s33 offen lds
    s_add_u32 m0, s29, 21504
    s_add_u32 s33, s31, 86016
    buffer_load_dwordx4 v24, s[16:19], s33 offen lds
    s_add_u32 m0, s29, 22528
    s_add_u32 s33, s31, 90112
    buffer_load_dwordx4 v24, s[16:19], s33 offen lds
    s_add_u32 m0, s29, 23552
    s_add_u32 s33, s31, 94208
    buffer_load_dwordx4 v24, s[16:19], s33 offen lds
    v_xor_b32 v24, 128, v23
    s_add_u32 m0, s29, 24576
    s_add_u32 s33, s31, 98304
    buffer_load_dwordx4 v24, s[16:19], s33 offen lds
    s_add_u32 m0, s29, 25600
    s_add_u32 s33, s31, 102400
    buffer_load_dwordx4 v24, s[16:19], s33 offen lds
    s_add_u32 m0, s29, 26624
    s_add_u32 s33, s31, 106496
    buffer_load_dwordx4 v24, s[16:19], s33 offen lds
    s_add_u32 m0, s29, 27648
    s_add_u32 s33, s31, 110592
    buffer_load_dwordx4 v24, s[16:19], s33 offen lds
    v_xor_b32 v24, 192, v23
    s_add_u32 m0, s29, 28672
    s_add_u32 s33, s31, 114688
    buffer_load_dwordx4 v24, s[16:19], s33 offen lds
    s_add_u32 m0, s29, 29696
    s_add_u32 s33, s31, 118784
    buffer_load_dwordx4 v24, s[16:19], s33 offen lds
    s_add_u32 m0, s29, 30720
    s_add_u32 s33, s31, 122880
    buffer_load_dwordx4 v24, s[16:19], s33 offen lds
    s_add_u32 m0, s29, 31744
    s_add_u32 s33, s31, 126976
    buffer_load_dwordx4 v24, s[16:19], s33 offen lds
    v_add_u32 v22, 0, v21
    v_xor_b32 v26, 32, v22
    ds_read_b64_tr_b16 v[128:129], v22 offset:0
    ds_read_b64_tr_b16 v[130:131], v22 offset:256
    ds_read_b64_tr_b16 v[132:133], v22 offset:2048
    ds_read_b64_tr_b16 v[134:135], v22 offset:2304
    ds_read_b64_tr_b16 v[192:193], v26 offset:0
    ds_read_b64_tr_b16 v[194:195], v26 offset:256
    ds_read_b64_tr_b16 v[196:197], v26 offset:2048
    ds_read_b64_tr_b16 v[198:199], v26 offset:2304
    s_waitcnt lgkmcnt(0)
    s_waitcnt vmcnt(16)
    s_barrier
    s_add_u32 m0, s30, 0
    s_add_u32 s33, s28, 2097152
    buffer_load_dwordx4 v20, s[12:15], s33 offen lds
    s_add_u32 m0, s30, 1024
    s_add_u32 s33, s28, 2129920
    buffer_load_dwordx4 v20, s[12:15], s33 offen lds
    s_add_u32 m0, s30, 2048
    s_add_u32 s33, s28, 2162688
    buffer_load_dwordx4 v20, s[12:15], s33 offen lds
    s_add_u32 m0, s30, 3072
    s_add_u32 s33, s28, 2195456
    buffer_load_dwordx4 v20, s[12:15], s33 offen lds
    v_add_u32 v22, 16384, v21
    v_xor_b32 v26, 32, v22
    ds_read_b64_tr_b16 v[136:137], v22 offset:0
    ds_read_b64_tr_b16 v[138:139], v22 offset:256
    ds_read_b64_tr_b16 v[140:141], v22 offset:2048
    ds_read_b64_tr_b16 v[142:143], v22 offset:2304
    ds_read_b64_tr_b16 v[200:201], v26 offset:0
    ds_read_b64_tr_b16 v[202:203], v26 offset:256
    ds_read_b64_tr_b16 v[204:205], v26 offset:2048
    ds_read_b64_tr_b16 v[206:207], v26 offset:2304
    s_waitcnt lgkmcnt(0)
    s_waitcnt vmcnt(0)
    s_barrier
    s_add_u32 m0, s30, 16384
    s_add_u32 s33, s28, 2621440
    buffer_load_dwordx4 v20, s[12:15], s33 offen lds
    s_add_u32 m0, s30, 17408
    s_add_u32 s33, s28, 2654208
    buffer_load_dwordx4 v20, s[12:15], s33 offen lds
    s_add_u32 m0, s30, 18432
    s_add_u32 s33, s28, 2686976
    buffer_load_dwordx4 v20, s[12:15], s33 offen lds
    s_add_u32 m0, s30, 19456
    s_add_u32 s33, s28, 2719744
    buffer_load_dwordx4 v20, s[12:15], s33 offen lds
    v_add_u32 v22, 0, v21
    v_xor_b32 v26, 32, v22
    ds_read_b64_tr_b16 v[144:145], v22 offset:0
    ds_read_b64_tr_b16 v[146:147], v22 offset:256
    ds_read_b64_tr_b16 v[148:149], v22 offset:2048
    ds_read_b64_tr_b16 v[150:151], v22 offset:2304
    ds_read_b64_tr_b16 v[208:209], v26 offset:0
    ds_read_b64_tr_b16 v[210:211], v26 offset:256
    ds_read_b64_tr_b16 v[212:213], v26 offset:2048
    ds_read_b64_tr_b16 v[214:215], v26 offset:2304
    s_waitcnt lgkmcnt(0)
    s_waitcnt vmcnt(0)
    s_barrier
    s_add_u32 m0, s30, 0
    s_add_u32 s33, s28, 3145728
    buffer_load_dwordx4 v20, s[12:15], s33 offen lds
    s_add_u32 m0, s30, 1024
    s_add_u32 s33, s28, 3178496
    buffer_load_dwordx4 v20, s[12:15], s33 offen lds
    s_add_u32 m0, s30, 2048
    s_add_u32 s33, s28, 3211264
    buffer_load_dwordx4 v20, s[12:15], s33 offen lds
    s_add_u32 m0, s30, 3072
    s_add_u32 s33, s28, 3244032
    buffer_load_dwordx4 v20, s[12:15], s33 offen lds
    v_add_u32 v22, 16384, v21
    v_xor_b32 v26, 32, v22
    ds_read_b64_tr_b16 v[152:153], v22 offset:0
    ds_read_b64_tr_b16 v[154:155], v22 offset:256
    ds_read_b64_tr_b16 v[156:157], v22 offset:2048
    ds_read_b64_tr_b16 v[158:159], v22 offset:2304
    ds_read_b64_tr_b16 v[216:217], v26 offset:0
    ds_read_b64_tr_b16 v[218:219], v26 offset:256
    ds_read_b64_tr_b16 v[220:221], v26 offset:2048
    ds_read_b64_tr_b16 v[222:223], v26 offset:2304
    s_waitcnt lgkmcnt(0)
    ds_read_b64_tr_b16 v[32:33], v25 offset:16384
    ds_read_b64_tr_b16 v[34:35], v25 offset:16896
    ds_read_b64_tr_b16 v[36:37], v25 offset:18432
    ds_read_b64_tr_b16 v[38:39], v25 offset:18944
    v_xor_b32 v27, 32, v25
    ds_read_b64_tr_b16 v[40:41], v27 offset:16384
    ds_read_b64_tr_b16 v[42:43], v27 offset:16896
    ds_read_b64_tr_b16 v[44:45], v27 offset:18432
    ds_read_b64_tr_b16 v[46:47], v27 offset:18944
    s_waitcnt lgkmcnt(0)
    v_xor_b32 v27, 64, v25
    ds_read_b64_tr_b16 v[48:49], v27 offset:16384
    ds_read_b64_tr_b16 v[50:51], v27 offset:16896
    ds_read_b64_tr_b16 v[52:53], v27 offset:18432
    ds_read_b64_tr_b16 v[54:55], v27 offset:18944
    v_xor_b32 v27, 96, v25
    ds_read_b64_tr_b16 v[56:57], v27 offset:16384
    ds_read_b64_tr_b16 v[58:59], v27 offset:16896
    ds_read_b64_tr_b16 v[60:61], v27 offset:18432
    ds_read_b64_tr_b16 v[62:63], v27 offset:18944
    s_waitcnt lgkmcnt(0)
    v_xor_b32 v27, 128, v25
    ds_read_b64_tr_b16 v[64:65], v27 offset:16384
    ds_read_b64_tr_b16 v[66:67], v27 offset:16896
    ds_read_b64_tr_b16 v[68:69], v27 offset:18432
    ds_read_b64_tr_b16 v[70:71], v27 offset:18944
    v_xor_b32 v27, 160, v25
    ds_read_b64_tr_b16 v[72:73], v27 offset:16384
    ds_read_b64_tr_b16 v[74:75], v27 offset:16896
    ds_read_b64_tr_b16 v[76:77], v27 offset:18432
    ds_read_b64_tr_b16 v[78:79], v27 offset:18944
    s_waitcnt lgkmcnt(0)
    v_xor_b32 v27, 192, v25
    ds_read_b64_tr_b16 v[80:81], v27 offset:16384
    ds_read_b64_tr_b16 v[82:83], v27 offset:16896
    ds_read_b64_tr_b16 v[84:85], v27 offset:18432
    ds_read_b64_tr_b16 v[86:87], v27 offset:18944
    v_xor_b32 v27, 224, v25
    ds_read_b64_tr_b16 v[88:89], v27 offset:16384
    ds_read_b64_tr_b16 v[90:91], v27 offset:16896
    ds_read_b64_tr_b16 v[92:93], v27 offset:18432
    ds_read_b64_tr_b16 v[94:95], v27 offset:18944
    s_waitcnt lgkmcnt(0)
    ds_write_b128 v119, v[32:35] offset:16384
    ds_write_b128 v119, v[36:39] offset:17408
    ds_write_b128 v119, v[40:43] offset:18432
    ds_write_b128 v119, v[44:47] offset:19456
    ds_write_b128 v119, v[48:51] offset:20480
    ds_write_b128 v119, v[52:55] offset:21504
    ds_write_b128 v119, v[56:59] offset:22528
    ds_write_b128 v119, v[60:63] offset:23552
    s_waitcnt lgkmcnt(0)
    ds_write_b128 v119, v[64:67] offset:24576
    ds_write_b128 v119, v[68:71] offset:25600
    ds_write_b128 v119, v[72:75] offset:26624
    ds_write_b128 v119, v[76:79] offset:27648
    ds_write_b128 v119, v[80:83] offset:28672
    ds_write_b128 v119, v[84:87] offset:29696
    ds_write_b128 v119, v[88:91] offset:30720
    ds_write_b128 v119, v[92:95] offset:31744
    s_waitcnt lgkmcnt(0)
    s_waitcnt vmcnt(0)
    s_barrier
    s_add_u32 m0, s30, 16384
    s_add_u32 s33, s28, 3670016
    buffer_load_dwordx4 v20, s[12:15], s33 offen lds
    s_add_u32 m0, s30, 17408
    s_add_u32 s33, s28, 3702784
    buffer_load_dwordx4 v20, s[12:15], s33 offen lds
    s_add_u32 m0, s30, 18432
    s_add_u32 s33, s28, 3735552
    buffer_load_dwordx4 v20, s[12:15], s33 offen lds
    s_add_u32 m0, s30, 19456
    s_add_u32 s33, s28, 3768320
    buffer_load_dwordx4 v20, s[12:15], s33 offen lds
    v_add_u32 v22, 0, v21
    v_xor_b32 v26, 32, v22
    ds_read_b64_tr_b16 v[160:161], v22 offset:0
    ds_read_b64_tr_b16 v[162:163], v22 offset:256
    ds_read_b64_tr_b16 v[164:165], v22 offset:2048
    ds_read_b64_tr_b16 v[166:167], v22 offset:2304
    ds_read_b64_tr_b16 v[224:225], v26 offset:0
    ds_read_b64_tr_b16 v[226:227], v26 offset:256
    ds_read_b64_tr_b16 v[228:229], v26 offset:2048
    ds_read_b64_tr_b16 v[230:231], v26 offset:2304
    s_waitcnt lgkmcnt(0)
    s_waitcnt vmcnt(0)
    s_barrier
    v_add_u32 v22, 16384, v21
    v_xor_b32 v26, 32, v22
    ds_read_b64_tr_b16 v[168:169], v22 offset:0
    ds_read_b64_tr_b16 v[170:171], v22 offset:256
    ds_read_b64_tr_b16 v[172:173], v22 offset:2048
    ds_read_b64_tr_b16 v[174:175], v22 offset:2304
    ds_read_b64_tr_b16 v[232:233], v26 offset:0
    ds_read_b64_tr_b16 v[234:235], v26 offset:256
    ds_read_b64_tr_b16 v[236:237], v26 offset:2048
    ds_read_b64_tr_b16 v[238:239], v26 offset:2304
    s_waitcnt lgkmcnt(0)
    s_branch L_wl_done
L_wl_2:
    s_add_u32 m0, s30, 0
    s_add_u32 s33, s28, 0
    buffer_load_dwordx4 v20, s[4:7], s33 offen lds
    s_add_u32 m0, s30, 1024
    s_add_u32 s33, s28, 32768
    buffer_load_dwordx4 v20, s[4:7], s33 offen lds
    s_add_u32 m0, s30, 2048
    s_add_u32 s33, s28, 65536
    buffer_load_dwordx4 v20, s[4:7], s33 offen lds
    s_add_u32 m0, s30, 3072
    s_add_u32 s33, s28, 98304
    buffer_load_dwordx4 v20, s[4:7], s33 offen lds
    s_add_u32 m0, s30, 16384
    s_add_u32 s33, s28, 524288
    buffer_load_dwordx4 v20, s[4:7], s33 offen lds
    s_add_u32 m0, s30, 17408
    s_add_u32 s33, s28, 557056
    buffer_load_dwordx4 v20, s[4:7], s33 offen lds
    s_add_u32 m0, s30, 18432
    s_add_u32 s33, s28, 589824
    buffer_load_dwordx4 v20, s[4:7], s33 offen lds
    s_add_u32 m0, s30, 19456
    s_add_u32 s33, s28, 622592
    buffer_load_dwordx4 v20, s[4:7], s33 offen lds
    s_add_u32 m0, s30, 49152
    s_add_u32 s33, s28, 1048576
    buffer_load_dwordx4 v20, s[4:7], s33 offen lds
    s_add_u32 m0, s30, 50176
    s_add_u32 s33, s28, 1081344
    buffer_load_dwordx4 v20, s[4:7], s33 offen lds
    s_add_u32 m0, s30, 51200
    s_add_u32 s33, s28, 1114112
    buffer_load_dwordx4 v20, s[4:7], s33 offen lds
    s_add_u32 m0, s30, 52224
    s_add_u32 s33, s28, 1146880
    buffer_load_dwordx4 v20, s[4:7], s33 offen lds
    s_add_u32 m0, s30, 81920
    s_add_u32 s33, s28, 1572864
    buffer_load_dwordx4 v20, s[4:7], s33 offen lds
    s_add_u32 m0, s30, 82944
    s_add_u32 s33, s28, 1605632
    buffer_load_dwordx4 v20, s[4:7], s33 offen lds
    s_add_u32 m0, s30, 83968
    s_add_u32 s33, s28, 1638400
    buffer_load_dwordx4 v20, s[4:7], s33 offen lds
    s_add_u32 m0, s30, 84992
    s_add_u32 s33, s28, 1671168
    buffer_load_dwordx4 v20, s[4:7], s33 offen lds
    s_add_u32 m0, s30, 114688
    s_add_u32 s33, s28, 2097152
    buffer_load_dwordx4 v20, s[4:7], s33 offen lds
    s_add_u32 m0, s30, 115712
    s_add_u32 s33, s28, 2129920
    buffer_load_dwordx4 v20, s[4:7], s33 offen lds
    s_add_u32 m0, s30, 116736
    s_add_u32 s33, s28, 2162688
    buffer_load_dwordx4 v20, s[4:7], s33 offen lds
    s_add_u32 m0, s30, 117760
    s_add_u32 s33, s28, 2195456
    buffer_load_dwordx4 v20, s[4:7], s33 offen lds
    s_add_u32 m0, s30, 147456
    s_add_u32 s33, s28, 2621440
    buffer_load_dwordx4 v20, s[4:7], s33 offen lds
    s_add_u32 m0, s30, 148480
    s_add_u32 s33, s28, 2654208
    buffer_load_dwordx4 v20, s[4:7], s33 offen lds
    s_add_u32 m0, s30, 149504
    s_add_u32 s33, s28, 2686976
    buffer_load_dwordx4 v20, s[4:7], s33 offen lds
    s_add_u32 m0, s30, 150528
    s_add_u32 s33, s28, 2719744
    buffer_load_dwordx4 v20, s[4:7], s33 offen lds
    s_waitcnt vmcnt(20)
    s_barrier
    v_xor_b32 v24, 0, v23
    s_add_u32 m0, s29, 0
    s_add_u32 s33, s31, 0
    buffer_load_dwordx4 v24, s[16:19], s33 offen lds
    s_add_u32 m0, s29, 1024
    s_add_u32 s33, s31, 4096
    buffer_load_dwordx4 v24, s[16:19], s33 offen lds
    s_add_u32 m0, s29, 2048
    s_add_u32 s33, s31, 8192
    buffer_load_dwordx4 v24, s[16:19], s33 offen lds
    s_add_u32 m0, s29, 3072
    s_add_u32 s33, s31, 12288
    buffer_load_dwordx4 v24, s[16:19], s33 offen lds
    v_add_u32 v22, 0, v21
    v_xor_b32 v26, 32, v22
    ds_read_b64_tr_b16 a[32:33], v22 offset:0
    ds_read_b64_tr_b16 a[34:35], v22 offset:256
    ds_read_b64_tr_b16 a[36:37], v22 offset:2048
    ds_read_b64_tr_b16 a[38:39], v22 offset:2304
    ds_read_b64_tr_b16 a[96:97], v26 offset:0
    ds_read_b64_tr_b16 a[98:99], v26 offset:256
    ds_read_b64_tr_b16 a[100:101], v26 offset:2048
    ds_read_b64_tr_b16 a[102:103], v26 offset:2304
    s_waitcnt lgkmcnt(0)
    s_waitcnt vmcnt(20)
    s_barrier
    s_add_u32 m0, s30, 0
    s_add_u32 s33, s28, 3145728
    buffer_load_dwordx4 v20, s[4:7], s33 offen lds
    s_add_u32 m0, s30, 1024
    s_add_u32 s33, s28, 3178496
    buffer_load_dwordx4 v20, s[4:7], s33 offen lds
    s_add_u32 m0, s30, 2048
    s_add_u32 s33, s28, 3211264
    buffer_load_dwordx4 v20, s[4:7], s33 offen lds
    s_add_u32 m0, s30, 3072
    s_add_u32 s33, s28, 3244032
    buffer_load_dwordx4 v20, s[4:7], s33 offen lds
    v_xor_b32 v24, 64, v23
    s_add_u32 m0, s29, 4096
    s_add_u32 s33, s31, 16384
    buffer_load_dwordx4 v24, s[16:19], s33 offen lds
    s_add_u32 m0, s29, 5120
    s_add_u32 s33, s31, 20480
    buffer_load_dwordx4 v24, s[16:19], s33 offen lds
    s_add_u32 m0, s29, 6144
    s_add_u32 s33, s31, 24576
    buffer_load_dwordx4 v24, s[16:19], s33 offen lds
    s_add_u32 m0, s29, 7168
    s_add_u32 s33, s31, 28672
    buffer_load_dwordx4 v24, s[16:19], s33 offen lds
    v_add_u32 v22, 16384, v21
    v_xor_b32 v26, 32, v22
    ds_read_b64_tr_b16 a[40:41], v22 offset:0
    ds_read_b64_tr_b16 a[42:43], v22 offset:256
    ds_read_b64_tr_b16 a[44:45], v22 offset:2048
    ds_read_b64_tr_b16 a[46:47], v22 offset:2304
    ds_read_b64_tr_b16 a[104:105], v26 offset:0
    ds_read_b64_tr_b16 a[106:107], v26 offset:256
    ds_read_b64_tr_b16 a[108:109], v26 offset:2048
    ds_read_b64_tr_b16 a[110:111], v26 offset:2304
    s_waitcnt lgkmcnt(0)
    s_waitcnt vmcnt(24)
    s_barrier
    s_add_u32 m0, s30, 16384
    s_add_u32 s33, s28, 3670016
    buffer_load_dwordx4 v20, s[4:7], s33 offen lds
    s_add_u32 m0, s30, 17408
    s_add_u32 s33, s28, 3702784
    buffer_load_dwordx4 v20, s[4:7], s33 offen lds
    s_add_u32 m0, s30, 18432
    s_add_u32 s33, s28, 3735552
    buffer_load_dwordx4 v20, s[4:7], s33 offen lds
    s_add_u32 m0, s30, 19456
    s_add_u32 s33, s28, 3768320
    buffer_load_dwordx4 v20, s[4:7], s33 offen lds
    v_xor_b32 v24, 128, v23
    s_add_u32 m0, s29, 8192
    s_add_u32 s33, s31, 32768
    buffer_load_dwordx4 v24, s[16:19], s33 offen lds
    s_add_u32 m0, s29, 9216
    s_add_u32 s33, s31, 36864
    buffer_load_dwordx4 v24, s[16:19], s33 offen lds
    s_add_u32 m0, s29, 10240
    s_add_u32 s33, s31, 40960
    buffer_load_dwordx4 v24, s[16:19], s33 offen lds
    s_add_u32 m0, s29, 11264
    s_add_u32 s33, s31, 45056
    buffer_load_dwordx4 v24, s[16:19], s33 offen lds
    v_add_u32 v22, 49152, v21
    v_xor_b32 v26, 32, v22
    ds_read_b64_tr_b16 a[48:49], v22 offset:0
    ds_read_b64_tr_b16 a[50:51], v22 offset:256
    ds_read_b64_tr_b16 a[52:53], v22 offset:2048
    ds_read_b64_tr_b16 a[54:55], v22 offset:2304
    ds_read_b64_tr_b16 a[112:113], v26 offset:0
    ds_read_b64_tr_b16 a[114:115], v26 offset:256
    ds_read_b64_tr_b16 a[116:117], v26 offset:2048
    ds_read_b64_tr_b16 a[118:119], v26 offset:2304
    s_waitcnt lgkmcnt(0)
    s_waitcnt vmcnt(28)
    s_barrier
    s_add_u32 m0, s30, 49152
    s_add_u32 s33, s28, 0
    buffer_load_dwordx4 v20, s[8:11], s33 offen lds
    s_add_u32 m0, s30, 50176
    s_add_u32 s33, s28, 32768
    buffer_load_dwordx4 v20, s[8:11], s33 offen lds
    s_add_u32 m0, s30, 51200
    s_add_u32 s33, s28, 65536
    buffer_load_dwordx4 v20, s[8:11], s33 offen lds
    s_add_u32 m0, s30, 52224
    s_add_u32 s33, s28, 98304
    buffer_load_dwordx4 v20, s[8:11], s33 offen lds
    v_xor_b32 v24, 192, v23
    s_add_u32 m0, s29, 12288
    s_add_u32 s33, s31, 49152
    buffer_load_dwordx4 v24, s[16:19], s33 offen lds
    s_add_u32 m0, s29, 13312
    s_add_u32 s33, s31, 53248
    buffer_load_dwordx4 v24, s[16:19], s33 offen lds
    s_add_u32 m0, s29, 14336
    s_add_u32 s33, s31, 57344
    buffer_load_dwordx4 v24, s[16:19], s33 offen lds
    s_add_u32 m0, s29, 15360
    s_add_u32 s33, s31, 61440
    buffer_load_dwordx4 v24, s[16:19], s33 offen lds
    v_add_u32 v22, 81920, v21
    v_xor_b32 v26, 32, v22
    ds_read_b64_tr_b16 a[56:57], v22 offset:0
    ds_read_b64_tr_b16 a[58:59], v22 offset:256
    ds_read_b64_tr_b16 a[60:61], v22 offset:2048
    ds_read_b64_tr_b16 a[62:63], v22 offset:2304
    ds_read_b64_tr_b16 a[120:121], v26 offset:0
    ds_read_b64_tr_b16 a[122:123], v26 offset:256
    ds_read_b64_tr_b16 a[124:125], v26 offset:2048
    ds_read_b64_tr_b16 a[126:127], v26 offset:2304
    s_waitcnt lgkmcnt(0)
    s_waitcnt vmcnt(32)
    s_barrier
    s_add_u32 m0, s30, 81920
    s_add_u32 s33, s28, 524288
    buffer_load_dwordx4 v20, s[8:11], s33 offen lds
    s_add_u32 m0, s30, 82944
    s_add_u32 s33, s28, 557056
    buffer_load_dwordx4 v20, s[8:11], s33 offen lds
    s_add_u32 m0, s30, 83968
    s_add_u32 s33, s28, 589824
    buffer_load_dwordx4 v20, s[8:11], s33 offen lds
    s_add_u32 m0, s30, 84992
    s_add_u32 s33, s28, 622592
    buffer_load_dwordx4 v20, s[8:11], s33 offen lds
    v_add_u32 v22, 114688, v21
    v_xor_b32 v26, 32, v22
    ds_read_b64_tr_b16 a[0:1], v22 offset:0
    ds_read_b64_tr_b16 a[2:3], v22 offset:256
    ds_read_b64_tr_b16 a[4:5], v22 offset:2048
    ds_read_b64_tr_b16 a[6:7], v22 offset:2304
    ds_read_b64_tr_b16 a[64:65], v26 offset:0
    ds_read_b64_tr_b16 a[66:67], v26 offset:256
    ds_read_b64_tr_b16 a[68:69], v26 offset:2048
    ds_read_b64_tr_b16 a[70:71], v26 offset:2304
    s_waitcnt lgkmcnt(0)
    s_waitcnt vmcnt(32)
    s_barrier
    s_add_u32 m0, s30, 114688
    s_add_u32 s33, s28, 1048576
    buffer_load_dwordx4 v20, s[8:11], s33 offen lds
    s_add_u32 m0, s30, 115712
    s_add_u32 s33, s28, 1081344
    buffer_load_dwordx4 v20, s[8:11], s33 offen lds
    s_add_u32 m0, s30, 116736
    s_add_u32 s33, s28, 1114112
    buffer_load_dwordx4 v20, s[8:11], s33 offen lds
    s_add_u32 m0, s30, 117760
    s_add_u32 s33, s28, 1146880
    buffer_load_dwordx4 v20, s[8:11], s33 offen lds
    v_add_u32 v22, 147456, v21
    v_xor_b32 v26, 32, v22
    ds_read_b64_tr_b16 a[8:9], v22 offset:0
    ds_read_b64_tr_b16 a[10:11], v22 offset:256
    ds_read_b64_tr_b16 a[12:13], v22 offset:2048
    ds_read_b64_tr_b16 a[14:15], v22 offset:2304
    ds_read_b64_tr_b16 a[72:73], v26 offset:0
    ds_read_b64_tr_b16 a[74:75], v26 offset:256
    ds_read_b64_tr_b16 a[76:77], v26 offset:2048
    ds_read_b64_tr_b16 a[78:79], v26 offset:2304
    s_waitcnt lgkmcnt(0)
    s_waitcnt vmcnt(28)
    s_barrier
    s_add_u32 m0, s30, 147456
    s_add_u32 s33, s28, 1572864
    buffer_load_dwordx4 v20, s[8:11], s33 offen lds
    s_add_u32 m0, s30, 148480
    s_add_u32 s33, s28, 1605632
    buffer_load_dwordx4 v20, s[8:11], s33 offen lds
    s_add_u32 m0, s30, 149504
    s_add_u32 s33, s28, 1638400
    buffer_load_dwordx4 v20, s[8:11], s33 offen lds
    s_add_u32 m0, s30, 150528
    s_add_u32 s33, s28, 1671168
    buffer_load_dwordx4 v20, s[8:11], s33 offen lds
    v_add_u32 v22, 0, v21
    v_xor_b32 v26, 32, v22
    ds_read_b64_tr_b16 a[16:17], v22 offset:0
    ds_read_b64_tr_b16 a[18:19], v22 offset:256
    ds_read_b64_tr_b16 a[20:21], v22 offset:2048
    ds_read_b64_tr_b16 a[22:23], v22 offset:2304
    ds_read_b64_tr_b16 a[80:81], v26 offset:0
    ds_read_b64_tr_b16 a[82:83], v26 offset:256
    ds_read_b64_tr_b16 a[84:85], v26 offset:2048
    ds_read_b64_tr_b16 a[86:87], v26 offset:2304
    s_waitcnt lgkmcnt(0)
    s_waitcnt vmcnt(24)
    s_barrier
    s_add_u32 m0, s30, 0
    s_add_u32 s33, s28, 2097152
    buffer_load_dwordx4 v20, s[8:11], s33 offen lds
    s_add_u32 m0, s30, 1024
    s_add_u32 s33, s28, 2129920
    buffer_load_dwordx4 v20, s[8:11], s33 offen lds
    s_add_u32 m0, s30, 2048
    s_add_u32 s33, s28, 2162688
    buffer_load_dwordx4 v20, s[8:11], s33 offen lds
    s_add_u32 m0, s30, 3072
    s_add_u32 s33, s28, 2195456
    buffer_load_dwordx4 v20, s[8:11], s33 offen lds
    v_add_u32 v22, 16384, v21
    v_xor_b32 v26, 32, v22
    ds_read_b64_tr_b16 a[24:25], v22 offset:0
    ds_read_b64_tr_b16 a[26:27], v22 offset:256
    ds_read_b64_tr_b16 a[28:29], v22 offset:2048
    ds_read_b64_tr_b16 a[30:31], v22 offset:2304
    ds_read_b64_tr_b16 a[88:89], v26 offset:0
    ds_read_b64_tr_b16 a[90:91], v26 offset:256
    ds_read_b64_tr_b16 a[92:93], v26 offset:2048
    ds_read_b64_tr_b16 a[94:95], v26 offset:2304
    s_waitcnt lgkmcnt(0)
    s_waitcnt vmcnt(20)
    s_barrier
    s_add_u32 m0, s30, 16384
    s_add_u32 s33, s28, 2621440
    buffer_load_dwordx4 v20, s[8:11], s33 offen lds
    s_add_u32 m0, s30, 17408
    s_add_u32 s33, s28, 2654208
    buffer_load_dwordx4 v20, s[8:11], s33 offen lds
    s_add_u32 m0, s30, 18432
    s_add_u32 s33, s28, 2686976
    buffer_load_dwordx4 v20, s[8:11], s33 offen lds
    s_add_u32 m0, s30, 19456
    s_add_u32 s33, s28, 2719744
    buffer_load_dwordx4 v20, s[8:11], s33 offen lds
    v_add_u32 v22, 49152, v21
    v_xor_b32 v26, 32, v22
    ds_read_b64_tr_b16 a[160:161], v22 offset:0
    ds_read_b64_tr_b16 a[162:163], v22 offset:256
    ds_read_b64_tr_b16 a[164:165], v22 offset:2048
    ds_read_b64_tr_b16 a[166:167], v22 offset:2304
    ds_read_b64_tr_b16 a[224:225], v26 offset:0
    ds_read_b64_tr_b16 a[226:227], v26 offset:256
    ds_read_b64_tr_b16 a[228:229], v26 offset:2048
    ds_read_b64_tr_b16 a[230:231], v26 offset:2304
    s_waitcnt lgkmcnt(0)
    s_waitcnt vmcnt(16)
    s_barrier
    s_add_u32 m0, s30, 49152
    s_add_u32 s33, s28, 3145728
    buffer_load_dwordx4 v20, s[8:11], s33 offen lds
    s_add_u32 m0, s30, 50176
    s_add_u32 s33, s28, 3178496
    buffer_load_dwordx4 v20, s[8:11], s33 offen lds
    s_add_u32 m0, s30, 51200
    s_add_u32 s33, s28, 3211264
    buffer_load_dwordx4 v20, s[8:11], s33 offen lds
    s_add_u32 m0, s30, 52224
    s_add_u32 s33, s28, 3244032
    buffer_load_dwordx4 v20, s[8:11], s33 offen lds
    v_add_u32 v22, 81920, v21
    v_xor_b32 v26, 32, v22
    ds_read_b64_tr_b16 a[168:169], v22 offset:0
    ds_read_b64_tr_b16 a[170:171], v22 offset:256
    ds_read_b64_tr_b16 a[172:173], v22 offset:2048
    ds_read_b64_tr_b16 a[174:175], v22 offset:2304
    ds_read_b64_tr_b16 a[232:233], v26 offset:0
    ds_read_b64_tr_b16 a[234:235], v26 offset:256
    ds_read_b64_tr_b16 a[236:237], v26 offset:2048
    ds_read_b64_tr_b16 a[238:239], v26 offset:2304
    s_waitcnt lgkmcnt(0)
    s_waitcnt vmcnt(16)
    s_barrier
    s_add_u32 m0, s30, 81920
    s_add_u32 s33, s28, 3670016
    buffer_load_dwordx4 v20, s[8:11], s33 offen lds
    s_add_u32 m0, s30, 82944
    s_add_u32 s33, s28, 3702784
    buffer_load_dwordx4 v20, s[8:11], s33 offen lds
    s_add_u32 m0, s30, 83968
    s_add_u32 s33, s28, 3735552
    buffer_load_dwordx4 v20, s[8:11], s33 offen lds
    s_add_u32 m0, s30, 84992
    s_add_u32 s33, s28, 3768320
    buffer_load_dwordx4 v20, s[8:11], s33 offen lds
    v_add_u32 v22, 114688, v21
    v_xor_b32 v26, 32, v22
    ds_read_b64_tr_b16 a[176:177], v22 offset:0
    ds_read_b64_tr_b16 a[178:179], v22 offset:256
    ds_read_b64_tr_b16 a[180:181], v22 offset:2048
    ds_read_b64_tr_b16 a[182:183], v22 offset:2304
    ds_read_b64_tr_b16 a[240:241], v26 offset:0
    ds_read_b64_tr_b16 a[242:243], v26 offset:256
    ds_read_b64_tr_b16 a[244:245], v26 offset:2048
    ds_read_b64_tr_b16 a[246:247], v26 offset:2304
    s_waitcnt lgkmcnt(0)
    ds_read_b64_tr_b16 v[32:33], v25 offset:0
    ds_read_b64_tr_b16 v[34:35], v25 offset:512
    ds_read_b64_tr_b16 v[36:37], v25 offset:2048
    ds_read_b64_tr_b16 v[38:39], v25 offset:2560
    v_xor_b32 v27, 32, v25
    ds_read_b64_tr_b16 v[40:41], v27 offset:0
    ds_read_b64_tr_b16 v[42:43], v27 offset:512
    ds_read_b64_tr_b16 v[44:45], v27 offset:2048
    ds_read_b64_tr_b16 v[46:47], v27 offset:2560
    s_waitcnt lgkmcnt(0)
    v_xor_b32 v27, 64, v25
    ds_read_b64_tr_b16 v[48:49], v27 offset:0
    ds_read_b64_tr_b16 v[50:51], v27 offset:512
    ds_read_b64_tr_b16 v[52:53], v27 offset:2048
    ds_read_b64_tr_b16 v[54:55], v27 offset:2560
    v_xor_b32 v27, 96, v25
    ds_read_b64_tr_b16 v[56:57], v27 offset:0
    ds_read_b64_tr_b16 v[58:59], v27 offset:512
    ds_read_b64_tr_b16 v[60:61], v27 offset:2048
    ds_read_b64_tr_b16 v[62:63], v27 offset:2560
    s_waitcnt lgkmcnt(0)
    v_xor_b32 v27, 128, v25
    ds_read_b64_tr_b16 v[64:65], v27 offset:0
    ds_read_b64_tr_b16 v[66:67], v27 offset:512
    ds_read_b64_tr_b16 v[68:69], v27 offset:2048
    ds_read_b64_tr_b16 v[70:71], v27 offset:2560
    v_xor_b32 v27, 160, v25
    ds_read_b64_tr_b16 v[72:73], v27 offset:0
    ds_read_b64_tr_b16 v[74:75], v27 offset:512
    ds_read_b64_tr_b16 v[76:77], v27 offset:2048
    ds_read_b64_tr_b16 v[78:79], v27 offset:2560
    s_waitcnt lgkmcnt(0)
    v_xor_b32 v27, 192, v25
    ds_read_b64_tr_b16 v[80:81], v27 offset:0
    ds_read_b64_tr_b16 v[82:83], v27 offset:512
    ds_read_b64_tr_b16 v[84:85], v27 offset:2048
    ds_read_b64_tr_b16 v[86:87], v27 offset:2560
    v_xor_b32 v27, 224, v25
    ds_read_b64_tr_b16 v[88:89], v27 offset:0
    ds_read_b64_tr_b16 v[90:91], v27 offset:512
    ds_read_b64_tr_b16 v[92:93], v27 offset:2048
    ds_read_b64_tr_b16 v[94:95], v27 offset:2560
    s_waitcnt lgkmcnt(0)
    ds_write_b128 v119, v[32:35] offset:0
    ds_write_b128 v119, v[36:39] offset:1024
    ds_write_b128 v119, v[40:43] offset:2048
    ds_write_b128 v119, v[44:47] offset:3072
    ds_write_b128 v119, v[48:51] offset:4096
    ds_write_b128 v119, v[52:55] offset:5120
    ds_write_b128 v119, v[56:59] offset:6144
    ds_write_b128 v119, v[60:63] offset:7168
    s_waitcnt lgkmcnt(0)
    ds_write_b128 v119, v[64:67] offset:8192
    ds_write_b128 v119, v[68:71] offset:9216
    ds_write_b128 v119, v[72:75] offset:10240
    ds_write_b128 v119, v[76:79] offset:11264
    ds_write_b128 v119, v[80:83] offset:12288
    ds_write_b128 v119, v[84:87] offset:13312
    ds_write_b128 v119, v[88:91] offset:14336
    ds_write_b128 v119, v[92:95] offset:15360
    s_waitcnt lgkmcnt(0)
    s_waitcnt vmcnt(16)
    s_barrier
    s_add_u32 m0, s30, 114688
    s_add_u32 s33, s28, 0
    buffer_load_dwordx4 v20, s[12:15], s33 offen lds
    s_add_u32 m0, s30, 115712
    s_add_u32 s33, s28, 32768
    buffer_load_dwordx4 v20, s[12:15], s33 offen lds
    s_add_u32 m0, s30, 116736
    s_add_u32 s33, s28, 65536
    buffer_load_dwordx4 v20, s[12:15], s33 offen lds
    s_add_u32 m0, s30, 117760
    s_add_u32 s33, s28, 98304
    buffer_load_dwordx4 v20, s[12:15], s33 offen lds
    v_add_u32 v22, 147456, v21
    v_xor_b32 v26, 32, v22
    ds_read_b64_tr_b16 a[184:185], v22 offset:0
    ds_read_b64_tr_b16 a[186:187], v22 offset:256
    ds_read_b64_tr_b16 a[188:189], v22 offset:2048
    ds_read_b64_tr_b16 a[190:191], v22 offset:2304
    ds_read_b64_tr_b16 a[248:249], v26 offset:0
    ds_read_b64_tr_b16 a[250:251], v26 offset:256
    ds_read_b64_tr_b16 a[252:253], v26 offset:2048
    ds_read_b64_tr_b16 a[254:255], v26 offset:2304
    s_waitcnt lgkmcnt(0)
    s_waitcnt vmcnt(16)
    s_barrier
    s_add_u32 m0, s30, 147456
    s_add_u32 s33, s28, 524288
    buffer_load_dwordx4 v20, s[12:15], s33 offen lds
    s_add_u32 m0, s30, 148480
    s_add_u32 s33, s28, 557056
    buffer_load_dwordx4 v20, s[12:15], s33 offen lds
    s_add_u32 m0, s30, 149504
    s_add_u32 s33, s28, 589824
    buffer_load_dwordx4 v20, s[12:15], s33 offen lds
    s_add_u32 m0, s30, 150528
    s_add_u32 s33, s28, 622592
    buffer_load_dwordx4 v20, s[12:15], s33 offen lds
    v_add_u32 v22, 0, v21
    v_xor_b32 v26, 32, v22
    ds_read_b64_tr_b16 a[128:129], v22 offset:0
    ds_read_b64_tr_b16 a[130:131], v22 offset:256
    ds_read_b64_tr_b16 a[132:133], v22 offset:2048
    ds_read_b64_tr_b16 a[134:135], v22 offset:2304
    ds_read_b64_tr_b16 a[192:193], v26 offset:0
    ds_read_b64_tr_b16 a[194:195], v26 offset:256
    ds_read_b64_tr_b16 a[196:197], v26 offset:2048
    ds_read_b64_tr_b16 a[198:199], v26 offset:2304
    s_waitcnt lgkmcnt(0)
    s_waitcnt vmcnt(16)
    s_barrier
    s_add_u32 m0, s30, 0
    s_add_u32 s33, s28, 1048576
    buffer_load_dwordx4 v20, s[12:15], s33 offen lds
    s_add_u32 m0, s30, 1024
    s_add_u32 s33, s28, 1081344
    buffer_load_dwordx4 v20, s[12:15], s33 offen lds
    s_add_u32 m0, s30, 2048
    s_add_u32 s33, s28, 1114112
    buffer_load_dwordx4 v20, s[12:15], s33 offen lds
    s_add_u32 m0, s30, 3072
    s_add_u32 s33, s28, 1146880
    buffer_load_dwordx4 v20, s[12:15], s33 offen lds
    v_add_u32 v22, 16384, v21
    v_xor_b32 v26, 32, v22
    ds_read_b64_tr_b16 a[136:137], v22 offset:0
    ds_read_b64_tr_b16 a[138:139], v22 offset:256
    ds_read_b64_tr_b16 a[140:141], v22 offset:2048
    ds_read_b64_tr_b16 a[142:143], v22 offset:2304
    ds_read_b64_tr_b16 a[200:201], v26 offset:0
    ds_read_b64_tr_b16 a[202:203], v26 offset:256
    ds_read_b64_tr_b16 a[204:205], v26 offset:2048
    ds_read_b64_tr_b16 a[206:207], v26 offset:2304
    s_waitcnt lgkmcnt(0)
    s_waitcnt vmcnt(16)
    s_barrier
    s_add_u32 m0, s30, 16384
    s_add_u32 s33, s28, 1572864
    buffer_load_dwordx4 v20, s[12:15], s33 offen lds
    s_add_u32 m0, s30, 17408
    s_add_u32 s33, s28, 1605632
    buffer_load_dwordx4 v20, s[12:15], s33 offen lds
    s_add_u32 m0, s30, 18432
    s_add_u32 s33, s28, 1638400
    buffer_load_dwordx4 v20, s[12:15], s33 offen lds
    s_add_u32 m0, s30, 19456
    s_add_u32 s33, s28, 1671168
    buffer_load_dwordx4 v20, s[12:15], s33 offen lds
    v_add_u32 v22, 49152, v21
    v_xor_b32 v26, 32, v22
    ds_read_b64_tr_b16 a[144:145], v22 offset:0
    ds_read_b64_tr_b16 a[146:147], v22 offset:256
    ds_read_b64_tr_b16 a[148:149], v22 offset:2048
    ds_read_b64_tr_b16 a[150:151], v22 offset:2304
    ds_read_b64_tr_b16 a[208:209], v26 offset:0
    ds_read_b64_tr_b16 a[210:211], v26 offset:256
    ds_read_b64_tr_b16 a[212:213], v26 offset:2048
    ds_read_b64_tr_b16 a[214:215], v26 offset:2304
    s_waitcnt lgkmcnt(0)
    s_waitcnt vmcnt(16)
    s_barrier
    v_add_u32 v22, 81920, v21
    v_xor_b32 v26, 32, v22
    ds_read_b64_tr_b16 a[152:153], v22 offset:0
    ds_read_b64_tr_b16 a[154:155], v22 offset:256
    ds_read_b64_tr_b16 a[156:157], v22 offset:2048
    ds_read_b64_tr_b16 a[158:159], v22 offset:2304
    ds_read_b64_tr_b16 a[216:217], v26 offset:0
    ds_read_b64_tr_b16 a[218:219], v26 offset:256
    ds_read_b64_tr_b16 a[220:221], v26 offset:2048
    ds_read_b64_tr_b16 a[222:223], v26 offset:2304
    s_waitcnt lgkmcnt(0)
    s_waitcnt vmcnt(12)
    s_barrier
    v_add_u32 v22, 114688, v21
    v_xor_b32 v26, 32, v22
    ds_read_b64_tr_b16 v[160:161], v22 offset:0
    ds_read_b64_tr_b16 v[162:163], v22 offset:256
    ds_read_b64_tr_b16 v[164:165], v22 offset:2048
    ds_read_b64_tr_b16 v[166:167], v22 offset:2304
    ds_read_b64_tr_b16 v[224:225], v26 offset:0
    ds_read_b64_tr_b16 v[226:227], v26 offset:256
    ds_read_b64_tr_b16 v[228:229], v26 offset:2048
    ds_read_b64_tr_b16 v[230:231], v26 offset:2304
    s_waitcnt lgkmcnt(0)
    s_waitcnt vmcnt(8)
    s_barrier
    v_add_u32 v22, 147456, v21
    v_xor_b32 v26, 32, v22
    ds_read_b64_tr_b16 v[168:169], v22 offset:0
    ds_read_b64_tr_b16 v[170:171], v22 offset:256
    ds_read_b64_tr_b16 v[172:173], v22 offset:2048
    ds_read_b64_tr_b16 v[174:175], v22 offset:2304
    ds_read_b64_tr_b16 v[232:233], v26 offset:0
    ds_read_b64_tr_b16 v[234:235], v26 offset:256
    ds_read_b64_tr_b16 v[236:237], v26 offset:2048
    ds_read_b64_tr_b16 v[238:239], v26 offset:2304
    s_waitcnt lgkmcnt(0)
    s_waitcnt vmcnt(4)
    s_barrier
    v_xor_b32 v24, 0, v23
    s_add_u32 m0, s29, 16384
    s_add_u32 s33, s31, 65536
    buffer_load_dwordx4 v24, s[16:19], s33 offen lds
    s_add_u32 m0, s29, 17408
    s_add_u32 s33, s31, 69632
    buffer_load_dwordx4 v24, s[16:19], s33 offen lds
    s_add_u32 m0, s29, 18432
    s_add_u32 s33, s31, 73728
    buffer_load_dwordx4 v24, s[16:19], s33 offen lds
    s_add_u32 m0, s29, 19456
    s_add_u32 s33, s31, 77824
    buffer_load_dwordx4 v24, s[16:19], s33 offen lds
    v_xor_b32 v24, 64, v23
    s_add_u32 m0, s29, 20480
    s_add_u32 s33, s31, 81920
    buffer_load_dwordx4 v24, s[16:19], s33 offen lds
    s_add_u32 m0, s29, 21504
    s_add_u32 s33, s31, 86016
    buffer_load_dwordx4 v24, s[16:19], s33 offen lds
    s_add_u32 m0, s29, 22528
    s_add_u32 s33, s31, 90112
    buffer_load_dwordx4 v24, s[16:19], s33 offen lds
    s_add_u32 m0, s29, 23552
    s_add_u32 s33, s31, 94208
    buffer_load_dwordx4 v24, s[16:19], s33 offen lds
    v_xor_b32 v24, 128, v23
    s_add_u32 m0, s29, 24576
    s_add_u32 s33, s31, 98304
    buffer_load_dwordx4 v24, s[16:19], s33 offen lds
    s_add_u32 m0, s29, 25600
    s_add_u32 s33, s31, 102400
    buffer_load_dwordx4 v24, s[16:19], s33 offen lds
    s_add_u32 m0, s29, 26624
    s_add_u32 s33, s31, 106496
    buffer_load_dwordx4 v24, s[16:19], s33 offen lds
    s_add_u32 m0, s29, 27648
    s_add_u32 s33, s31, 110592
    buffer_load_dwordx4 v24, s[16:19], s33 offen lds
    v_xor_b32 v24, 192, v23
    s_add_u32 m0, s29, 28672
    s_add_u32 s33, s31, 114688
    buffer_load_dwordx4 v24, s[16:19], s33 offen lds
    s_add_u32 m0, s29, 29696
    s_add_u32 s33, s31, 118784
    buffer_load_dwordx4 v24, s[16:19], s33 offen lds
    s_add_u32 m0, s29, 30720
    s_add_u32 s33, s31, 122880
    buffer_load_dwordx4 v24, s[16:19], s33 offen lds
    s_add_u32 m0, s29, 31744
    s_add_u32 s33, s31, 126976
    buffer_load_dwordx4 v24, s[16:19], s33 offen lds
    v_add_u32 v22, 0, v21
    v_xor_b32 v26, 32, v22
    ds_read_b64_tr_b16 v[176:177], v22 offset:0
    ds_read_b64_tr_b16 v[178:179], v22 offset:256
    ds_read_b64_tr_b16 v[180:181], v22 offset:2048
    ds_read_b64_tr_b16 v[182:183], v22 offset:2304
    ds_read_b64_tr_b16 v[240:241], v26 offset:0
    ds_read_b64_tr_b16 v[242:243], v26 offset:256
    ds_read_b64_tr_b16 v[244:245], v26 offset:2048
    ds_read_b64_tr_b16 v[246:247], v26 offset:2304
    s_waitcnt lgkmcnt(0)
    s_waitcnt vmcnt(16)
    s_barrier
    s_add_u32 m0, s30, 0
    s_add_u32 s33, s28, 2097152
    buffer_load_dwordx4 v20, s[12:15], s33 offen lds
    s_add_u32 m0, s30, 1024
    s_add_u32 s33, s28, 2129920
    buffer_load_dwordx4 v20, s[12:15], s33 offen lds
    s_add_u32 m0, s30, 2048
    s_add_u32 s33, s28, 2162688
    buffer_load_dwordx4 v20, s[12:15], s33 offen lds
    s_add_u32 m0, s30, 3072
    s_add_u32 s33, s28, 2195456
    buffer_load_dwordx4 v20, s[12:15], s33 offen lds
    v_add_u32 v22, 16384, v21
    v_xor_b32 v26, 32, v22
    ds_read_b64_tr_b16 v[184:185], v22 offset:0
    ds_read_b64_tr_b16 v[186:187], v22 offset:256
    ds_read_b64_tr_b16 v[188:189], v22 offset:2048
    ds_read_b64_tr_b16 v[190:191], v22 offset:2304
    ds_read_b64_tr_b16 v[248:249], v26 offset:0
    ds_read_b64_tr_b16 v[250:251], v26 offset:256
    ds_read_b64_tr_b16 v[252:253], v26 offset:2048
    ds_read_b64_tr_b16 v[254:255], v26 offset:2304
    s_waitcnt lgkmcnt(0)
    s_waitcnt vmcnt(0)
    s_barrier
    s_add_u32 m0, s30, 16384
    s_add_u32 s33, s28, 2621440
    buffer_load_dwordx4 v20, s[12:15], s33 offen lds
    s_add_u32 m0, s30, 17408
    s_add_u32 s33, s28, 2654208
    buffer_load_dwordx4 v20, s[12:15], s33 offen lds
    s_add_u32 m0, s30, 18432
    s_add_u32 s33, s28, 2686976
    buffer_load_dwordx4 v20, s[12:15], s33 offen lds
    s_add_u32 m0, s30, 19456
    s_add_u32 s33, s28, 2719744
    buffer_load_dwordx4 v20, s[12:15], s33 offen lds
    v_add_u32 v22, 0, v21
    v_xor_b32 v26, 32, v22
    ds_read_b64_tr_b16 v[128:129], v22 offset:0
    ds_read_b64_tr_b16 v[130:131], v22 offset:256
    ds_read_b64_tr_b16 v[132:133], v22 offset:2048
    ds_read_b64_tr_b16 v[134:135], v22 offset:2304
    ds_read_b64_tr_b16 v[192:193], v26 offset:0
    ds_read_b64_tr_b16 v[194:195], v26 offset:256
    ds_read_b64_tr_b16 v[196:197], v26 offset:2048
    ds_read_b64_tr_b16 v[198:199], v26 offset:2304
    s_waitcnt lgkmcnt(0)
    s_waitcnt vmcnt(0)
    s_barrier
    s_add_u32 m0, s30, 0
    s_add_u32 s33, s28, 3145728
    buffer_load_dwordx4 v20, s[12:15], s33 offen lds
    s_add_u32 m0, s30, 1024
    s_add_u32 s33, s28, 3178496
    buffer_load_dwordx4 v20, s[12:15], s33 offen lds
    s_add_u32 m0, s30, 2048
    s_add_u32 s33, s28, 3211264
    buffer_load_dwordx4 v20, s[12:15], s33 offen lds
    s_add_u32 m0, s30, 3072
    s_add_u32 s33, s28, 3244032
    buffer_load_dwordx4 v20, s[12:15], s33 offen lds
    v_add_u32 v22, 16384, v21
    v_xor_b32 v26, 32, v22
    ds_read_b64_tr_b16 v[136:137], v22 offset:0
    ds_read_b64_tr_b16 v[138:139], v22 offset:256
    ds_read_b64_tr_b16 v[140:141], v22 offset:2048
    ds_read_b64_tr_b16 v[142:143], v22 offset:2304
    ds_read_b64_tr_b16 v[200:201], v26 offset:0
    ds_read_b64_tr_b16 v[202:203], v26 offset:256
    ds_read_b64_tr_b16 v[204:205], v26 offset:2048
    ds_read_b64_tr_b16 v[206:207], v26 offset:2304
    s_waitcnt lgkmcnt(0)
    ds_read_b64_tr_b16 v[32:33], v25 offset:16384
    ds_read_b64_tr_b16 v[34:35], v25 offset:16896
    ds_read_b64_tr_b16 v[36:37], v25 offset:18432
    ds_read_b64_tr_b16 v[38:39], v25 offset:18944
    v_xor_b32 v27, 32, v25
    ds_read_b64_tr_b16 v[40:41], v27 offset:16384
    ds_read_b64_tr_b16 v[42:43], v27 offset:16896
    ds_read_b64_tr_b16 v[44:45], v27 offset:18432
    ds_read_b64_tr_b16 v[46:47], v27 offset:18944
    s_waitcnt lgkmcnt(0)
    v_xor_b32 v27, 64, v25
    ds_read_b64_tr_b16 v[48:49], v27 offset:16384
    ds_read_b64_tr_b16 v[50:51], v27 offset:16896
    ds_read_b64_tr_b16 v[52:53], v27 offset:18432
    ds_read_b64_tr_b16 v[54:55], v27 offset:18944
    v_xor_b32 v27, 96, v25
    ds_read_b64_tr_b16 v[56:57], v27 offset:16384
    ds_read_b64_tr_b16 v[58:59], v27 offset:16896
    ds_read_b64_tr_b16 v[60:61], v27 offset:18432
    ds_read_b64_tr_b16 v[62:63], v27 offset:18944
    s_waitcnt lgkmcnt(0)
    v_xor_b32 v27, 128, v25
    ds_read_b64_tr_b16 v[64:65], v27 offset:16384
    ds_read_b64_tr_b16 v[66:67], v27 offset:16896
    ds_read_b64_tr_b16 v[68:69], v27 offset:18432
    ds_read_b64_tr_b16 v[70:71], v27 offset:18944
    v_xor_b32 v27, 160, v25
    ds_read_b64_tr_b16 v[72:73], v27 offset:16384
    ds_read_b64_tr_b16 v[74:75], v27 offset:16896
    ds_read_b64_tr_b16 v[76:77], v27 offset:18432
    ds_read_b64_tr_b16 v[78:79], v27 offset:18944
    s_waitcnt lgkmcnt(0)
    v_xor_b32 v27, 192, v25
    ds_read_b64_tr_b16 v[80:81], v27 offset:16384
    ds_read_b64_tr_b16 v[82:83], v27 offset:16896
    ds_read_b64_tr_b16 v[84:85], v27 offset:18432
    ds_read_b64_tr_b16 v[86:87], v27 offset:18944
    v_xor_b32 v27, 224, v25
    ds_read_b64_tr_b16 v[88:89], v27 offset:16384
    ds_read_b64_tr_b16 v[90:91], v27 offset:16896
    ds_read_b64_tr_b16 v[92:93], v27 offset:18432
    ds_read_b64_tr_b16 v[94:95], v27 offset:18944
    s_waitcnt lgkmcnt(0)
    ds_write_b128 v119, v[32:35] offset:16384
    ds_write_b128 v119, v[36:39] offset:17408
    ds_write_b128 v119, v[40:43] offset:18432
    ds_write_b128 v119, v[44:47] offset:19456
    ds_write_b128 v119, v[48:51] offset:20480
    ds_write_b128 v119, v[52:55] offset:21504
    ds_write_b128 v119, v[56:59] offset:22528
    ds_write_b128 v119, v[60:63] offset:23552
    s_waitcnt lgkmcnt(0)
    ds_write_b128 v119, v[64:67] offset:24576
    ds_write_b128 v119, v[68:71] offset:25600
    ds_write_b128 v119, v[72:75] offset:26624
    ds_write_b128 v119, v[76:79] offset:27648
    ds_write_b128 v119, v[80:83] offset:28672
    ds_write_b128 v119, v[84:87] offset:29696
    ds_write_b128 v119, v[88:91] offset:30720
    ds_write_b128 v119, v[92:95] offset:31744
    s_waitcnt lgkmcnt(0)
    s_waitcnt vmcnt(0)
    s_barrier
    s_add_u32 m0, s30, 16384
    s_add_u32 s33, s28, 3670016
    buffer_load_dwordx4 v20, s[12:15], s33 offen lds
    s_add_u32 m0, s30, 17408
    s_add_u32 s33, s28, 3702784
    buffer_load_dwordx4 v20, s[12:15], s33 offen lds
    s_add_u32 m0, s30, 18432
    s_add_u32 s33, s28, 3735552
    buffer_load_dwordx4 v20, s[12:15], s33 offen lds
    s_add_u32 m0, s30, 19456
    s_add_u32 s33, s28, 3768320
    buffer_load_dwordx4 v20, s[12:15], s33 offen lds
    v_add_u32 v22, 0, v21
    v_xor_b32 v26, 32, v22
    ds_read_b64_tr_b16 v[144:145], v22 offset:0
    ds_read_b64_tr_b16 v[146:147], v22 offset:256
    ds_read_b64_tr_b16 v[148:149], v22 offset:2048
    ds_read_b64_tr_b16 v[150:151], v22 offset:2304
    ds_read_b64_tr_b16 v[208:209], v26 offset:0
    ds_read_b64_tr_b16 v[210:211], v26 offset:256
    ds_read_b64_tr_b16 v[212:213], v26 offset:2048
    ds_read_b64_tr_b16 v[214:215], v26 offset:2304
    s_waitcnt lgkmcnt(0)
    s_waitcnt vmcnt(0)
    s_barrier
    v_add_u32 v22, 16384, v21
    v_xor_b32 v26, 32, v22
    ds_read_b64_tr_b16 v[152:153], v22 offset:0
    ds_read_b64_tr_b16 v[154:155], v22 offset:256
    ds_read_b64_tr_b16 v[156:157], v22 offset:2048
    ds_read_b64_tr_b16 v[158:159], v22 offset:2304
    ds_read_b64_tr_b16 v[216:217], v26 offset:0
    ds_read_b64_tr_b16 v[218:219], v26 offset:256
    ds_read_b64_tr_b16 v[220:221], v26 offset:2048
    ds_read_b64_tr_b16 v[222:223], v26 offset:2304
    s_waitcnt lgkmcnt(0)
    s_branch L_wl_done
L_wl_3:
    s_add_u32 m0, s30, 0
    s_add_u32 s33, s28, 0
    buffer_load_dwordx4 v20, s[4:7], s33 offen lds
    s_add_u32 m0, s30, 1024
    s_add_u32 s33, s28, 32768
    buffer_load_dwordx4 v20, s[4:7], s33 offen lds
    s_add_u32 m0, s30, 2048
    s_add_u32 s33, s28, 65536
    buffer_load_dwordx4 v20, s[4:7], s33 offen lds
    s_add_u32 m0, s30, 3072
    s_add_u32 s33, s28, 98304
    buffer_load_dwordx4 v20, s[4:7], s33 offen lds
    s_add_u32 m0, s30, 16384
    s_add_u32 s33, s28, 524288
    buffer_load_dwordx4 v20, s[4:7], s33 offen lds
    s_add_u32 m0, s30, 17408
    s_add_u32 s33, s28, 557056
    buffer_load_dwordx4 v20, s[4:7], s33 offen lds
    s_add_u32 m0, s30, 18432
    s_add_u32 s33, s28, 589824
    buffer_load_dwordx4 v20, s[4:7], s33 offen lds
    s_add_u32 m0, s30, 19456
    s_add_u32 s33, s28, 622592
    buffer_load_dwordx4 v20, s[4:7], s33 offen lds
    s_add_u32 m0, s30, 49152
    s_add_u32 s33, s28, 1048576
    buffer_load_dwordx4 v20, s[4:7], s33 offen lds
    s_add_u32 m0, s30, 50176
    s_add_u32 s33, s28, 1081344
    buffer_load_dwordx4 v20, s[4:7], s33 offen lds
    s_add_u32 m0, s30, 51200
    s_add_u32 s33, s28, 1114112
    buffer_load_dwordx4 v20, s[4:7], s33 offen lds
    s_add_u32 m0, s30, 52224
    s_add_u32 s33, s28, 1146880
    buffer_load_dwordx4 v20, s[4:7], s33 offen lds
    s_add_u32 m0, s30, 81920
    s_add_u32 s33, s28, 1572864
    buffer_load_dwordx4 v20, s[4:7], s33 offen lds
    s_add_u32 m0, s30, 82944
    s_add_u32 s33, s28, 1605632
    buffer_load_dwordx4 v20, s[4:7], s33 offen lds
    s_add_u32 m0, s30, 83968
    s_add_u32 s33, s28, 1638400
    buffer_load_dwordx4 v20, s[4:7], s33 offen lds
    s_add_u32 m0, s30, 84992
    s_add_u32 s33, s28, 1671168
    buffer_load_dwordx4 v20, s[4:7], s33 offen lds
    s_add_u32 m0, s30, 114688
    s_add_u32 s33, s28, 2097152
    buffer_load_dwordx4 v20, s[4:7], s33 offen lds
    s_add_u32 m0, s30, 115712
    s_add_u32 s33, s28, 2129920
    buffer_load_dwordx4 v20, s[4:7], s33 offen lds
    s_add_u32 m0, s30, 116736
    s_add_u32 s33, s28, 2162688
    buffer_load_dwordx4 v20, s[4:7], s33 offen lds
    s_add_u32 m0, s30, 117760
    s_add_u32 s33, s28, 2195456
    buffer_load_dwordx4 v20, s[4:7], s33 offen lds
    s_add_u32 m0, s30, 147456
    s_add_u32 s33, s28, 2621440
    buffer_load_dwordx4 v20, s[4:7], s33 offen lds
    s_add_u32 m0, s30, 148480
    s_add_u32 s33, s28, 2654208
    buffer_load_dwordx4 v20, s[4:7], s33 offen lds
    s_add_u32 m0, s30, 149504
    s_add_u32 s33, s28, 2686976
    buffer_load_dwordx4 v20, s[4:7], s33 offen lds
    s_add_u32 m0, s30, 150528
    s_add_u32 s33, s28, 2719744
    buffer_load_dwordx4 v20, s[4:7], s33 offen lds
    s_waitcnt vmcnt(20)
    s_barrier
    v_xor_b32 v24, 0, v23
    s_add_u32 m0, s29, 0
    s_add_u32 s33, s31, 0
    buffer_load_dwordx4 v24, s[16:19], s33 offen lds
    s_add_u32 m0, s29, 1024
    s_add_u32 s33, s31, 4096
    buffer_load_dwordx4 v24, s[16:19], s33 offen lds
    s_add_u32 m0, s29, 2048
    s_add_u32 s33, s31, 8192
    buffer_load_dwordx4 v24, s[16:19], s33 offen lds
    s_add_u32 m0, s29, 3072
    s_add_u32 s33, s31, 12288
    buffer_load_dwordx4 v24, s[16:19], s33 offen lds
    v_add_u32 v22, 0, v21
    v_xor_b32 v26, 32, v22
    ds_read_b64_tr_b16 a[16:17], v22 offset:0
    ds_read_b64_tr_b16 a[18:19], v22 offset:256
    ds_read_b64_tr_b16 a[20:21], v22 offset:2048
    ds_read_b64_tr_b16 a[22:23], v22 offset:2304
    ds_read_b64_tr_b16 a[80:81], v26 offset:0
    ds_read_b64_tr_b16 a[82:83], v26 offset:256
    ds_read_b64_tr_b16 a[84:85], v26 offset:2048
    ds_read_b64_tr_b16 a[86:87], v26 offset:2304
    s_waitcnt lgkmcnt(0)
    s_waitcnt vmcnt(20)
    s_barrier
    s_add_u32 m0, s30, 0
    s_add_u32 s33, s28, 3145728
    buffer_load_dwordx4 v20, s[4:7], s33 offen lds
    s_add_u32 m0, s30, 1024
    s_add_u32 s33, s28, 3178496
    buffer_load_dwordx4 v20, s[4:7], s33 offen lds
    s_add_u32 m0, s30, 2048
    s_add_u32 s33, s28, 3211264
    buffer_load_dwordx4 v20, s[4:7], s33 offen lds
    s_add_u32 m0, s30, 3072
    s_add_u32 s33, s28, 3244032
    buffer_load_dwordx4 v20, s[4:7], s33 offen lds
    v_xor_b32 v24, 64, v23
    s_add_u32 m0, s29, 4096
    s_add_u32 s33, s31, 16384
    buffer_load_dwordx4 v24, s[16:19], s33 offen lds
    s_add_u32 m0, s29, 5120
    s_add_u32 s33, s31, 20480
    buffer_load_dwordx4 v24, s[16:19], s33 offen lds
    s_add_u32 m0, s29, 6144
    s_add_u32 s33, s31, 24576
    buffer_load_dwordx4 v24, s[16:19], s33 offen lds
    s_add_u32 m0, s29, 7168
    s_add_u32 s33, s31, 28672
    buffer_load_dwordx4 v24, s[16:19], s33 offen lds
    v_add_u32 v22, 16384, v21
    v_xor_b32 v26, 32, v22
    ds_read_b64_tr_b16 a[24:25], v22 offset:0
    ds_read_b64_tr_b16 a[26:27], v22 offset:256
    ds_read_b64_tr_b16 a[28:29], v22 offset:2048
    ds_read_b64_tr_b16 a[30:31], v22 offset:2304
    ds_read_b64_tr_b16 a[88:89], v26 offset:0
    ds_read_b64_tr_b16 a[90:91], v26 offset:256
    ds_read_b64_tr_b16 a[92:93], v26 offset:2048
    ds_read_b64_tr_b16 a[94:95], v26 offset:2304
    s_waitcnt lgkmcnt(0)
    s_waitcnt vmcnt(24)
    s_barrier
    s_add_u32 m0, s30, 16384
    s_add_u32 s33, s28, 3670016
    buffer_load_dwordx4 v20, s[4:7], s33 offen lds
    s_add_u32 m0, s30, 17408
    s_add_u32 s33, s28, 3702784
    buffer_load_dwordx4 v20, s[4:7], s33 offen lds
    s_add_u32 m0, s30, 18432
    s_add_u32 s33, s28, 3735552
    buffer_load_dwordx4 v20, s[4:7], s33 offen lds
    s_add_u32 m0, s30, 19456
    s_add_u32 s33, s28, 3768320
    buffer_load_dwordx4 v20, s[4:7], s33 offen lds
    v_xor_b32 v24, 128, v23
    s_add_u32 m0, s29, 8192
    s_add_u32 s33, s31, 32768
    buffer_load_dwordx4 v24, s[16:19], s33 offen lds
    s_add_u32 m0, s29, 9216
    s_add_u32 s33, s31, 36864
    buffer_load_dwordx4 v24, s[16:19], s33 offen lds
    s_add_u32 m0, s29, 10240
    s_add_u32 s33, s31, 40960
    buffer_load_dwordx4 v24, s[16:19], s33 offen lds
    s_add_u32 m0, s29, 11264
    s_add_u32 s33, s31, 45056
    buffer_load_dwordx4 v24, s[16:19], s33 offen lds
    v_add_u32 v22, 49152, v21
    v_xor_b32 v26, 32, v22
    ds_read_b64_tr_b16 a[32:33], v22 offset:0
    ds_read_b64_tr_b16 a[34:35], v22 offset:256
    ds_read_b64_tr_b16 a[36:37], v22 offset:2048
    ds_read_b64_tr_b16 a[38:39], v22 offset:2304
    ds_read_b64_tr_b16 a[96:97], v26 offset:0
    ds_read_b64_tr_b16 a[98:99], v26 offset:256
    ds_read_b64_tr_b16 a[100:101], v26 offset:2048
    ds_read_b64_tr_b16 a[102:103], v26 offset:2304
    s_waitcnt lgkmcnt(0)
    s_waitcnt vmcnt(28)
    s_barrier
    s_add_u32 m0, s30, 49152
    s_add_u32 s33, s28, 0
    buffer_load_dwordx4 v20, s[8:11], s33 offen lds
    s_add_u32 m0, s30, 50176
    s_add_u32 s33, s28, 32768
    buffer_load_dwordx4 v20, s[8:11], s33 offen lds
    s_add_u32 m0, s30, 51200
    s_add_u32 s33, s28, 65536
    buffer_load_dwordx4 v20, s[8:11], s33 offen lds
    s_add_u32 m0, s30, 52224
    s_add_u32 s33, s28, 98304
    buffer_load_dwordx4 v20, s[8:11], s33 offen lds
    v_xor_b32 v24, 192, v23
    s_add_u32 m0, s29, 12288
    s_add_u32 s33, s31, 49152
    buffer_load_dwordx4 v24, s[16:19], s33 offen lds
    s_add_u32 m0, s29, 13312
    s_add_u32 s33, s31, 53248
    buffer_load_dwordx4 v24, s[16:19], s33 offen lds
    s_add_u32 m0, s29, 14336
    s_add_u32 s33, s31, 57344
    buffer_load_dwordx4 v24, s[16:19], s33 offen lds
    s_add_u32 m0, s29, 15360
    s_add_u32 s33, s31, 61440
    buffer_load_dwordx4 v24, s[16:19], s33 offen lds
    v_add_u32 v22, 81920, v21
    v_xor_b32 v26, 32, v22
    ds_read_b64_tr_b16 a[40:41], v22 offset:0
    ds_read_b64_tr_b16 a[42:43], v22 offset:256
    ds_read_b64_tr_b16 a[44:45], v22 offset:2048
    ds_read_b64_tr_b16 a[46:47], v22 offset:2304
    ds_read_b64_tr_b16 a[104:105], v26 offset:0
    ds_read_b64_tr_b16 a[106:107], v26 offset:256
    ds_read_b64_tr_b16 a[108:109], v26 offset:2048
    ds_read_b64_tr_b16 a[110:111], v26 offset:2304
    s_waitcnt lgkmcnt(0)
    s_waitcnt vmcnt(32)
    s_barrier
    s_add_u32 m0, s30, 81920
    s_add_u32 s33, s28, 524288
    buffer_load_dwordx4 v20, s[8:11], s33 offen lds
    s_add_u32 m0, s30, 82944
    s_add_u32 s33, s28, 557056
    buffer_load_dwordx4 v20, s[8:11], s33 offen lds
    s_add_u32 m0, s30, 83968
    s_add_u32 s33, s28, 589824
    buffer_load_dwordx4 v20, s[8:11], s33 offen lds
    s_add_u32 m0, s30, 84992
    s_add_u32 s33, s28, 622592
    buffer_load_dwordx4 v20, s[8:11], s33 offen lds
    v_add_u32 v22, 114688, v21
    v_xor_b32 v26, 32, v22
    ds_read_b64_tr_b16 a[48:49], v22 offset:0
    ds_read_b64_tr_b16 a[50:51], v22 offset:256
    ds_read_b64_tr_b16 a[52:53], v22 offset:2048
    ds_read_b64_tr_b16 a[54:55], v22 offset:2304
    ds_read_b64_tr_b16 a[112:113], v26 offset:0
    ds_read_b64_tr_b16 a[114:115], v26 offset:256
    ds_read_b64_tr_b16 a[116:117], v26 offset:2048
    ds_read_b64_tr_b16 a[118:119], v26 offset:2304
    s_waitcnt lgkmcnt(0)
    s_waitcnt vmcnt(32)
    s_barrier
    s_add_u32 m0, s30, 114688
    s_add_u32 s33, s28, 1048576
    buffer_load_dwordx4 v20, s[8:11], s33 offen lds
    s_add_u32 m0, s30, 115712
    s_add_u32 s33, s28, 1081344
    buffer_load_dwordx4 v20, s[8:11], s33 offen lds
    s_add_u32 m0, s30, 116736
    s_add_u32 s33, s28, 1114112
    buffer_load_dwordx4 v20, s[8:11], s33 offen lds
    s_add_u32 m0, s30, 117760
    s_add_u32 s33, s28, 1146880
    buffer_load_dwordx4 v20, s[8:11], s33 offen lds
    v_add_u32 v22, 147456, v21
    v_xor_b32 v26, 32, v22
    ds_read_b64_tr_b16 a[56:57], v22 offset:0
    ds_read_b64_tr_b16 a[58:59], v22 offset:256
    ds_read_b64_tr_b16 a[60:61], v22 offset:2048
    ds_read_b64_tr_b16 a[62:63], v22 offset:2304
    ds_read_b64_tr_b16 a[120:121], v26 offset:0
    ds_read_b64_tr_b16 a[122:123], v26 offset:256
    ds_read_b64_tr_b16 a[124:125], v26 offset:2048
    ds_read_b64_tr_b16 a[126:127], v26 offset:2304
    s_waitcnt lgkmcnt(0)
    s_waitcnt vmcnt(28)
    s_barrier
    s_add_u32 m0, s30, 147456
    s_add_u32 s33, s28, 1572864
    buffer_load_dwordx4 v20, s[8:11], s33 offen lds
    s_add_u32 m0, s30, 148480
    s_add_u32 s33, s28, 1605632
    buffer_load_dwordx4 v20, s[8:11], s33 offen lds
    s_add_u32 m0, s30, 149504
    s_add_u32 s33, s28, 1638400
    buffer_load_dwordx4 v20, s[8:11], s33 offen lds
    s_add_u32 m0, s30, 150528
    s_add_u32 s33, s28, 1671168
    buffer_load_dwordx4 v20, s[8:11], s33 offen lds
    v_add_u32 v22, 0, v21
    v_xor_b32 v26, 32, v22
    ds_read_b64_tr_b16 a[0:1], v22 offset:0
    ds_read_b64_tr_b16 a[2:3], v22 offset:256
    ds_read_b64_tr_b16 a[4:5], v22 offset:2048
    ds_read_b64_tr_b16 a[6:7], v22 offset:2304
    ds_read_b64_tr_b16 a[64:65], v26 offset:0
    ds_read_b64_tr_b16 a[66:67], v26 offset:256
    ds_read_b64_tr_b16 a[68:69], v26 offset:2048
    ds_read_b64_tr_b16 a[70:71], v26 offset:2304
    s_waitcnt lgkmcnt(0)
    s_waitcnt vmcnt(24)
    s_barrier
    s_add_u32 m0, s30, 0
    s_add_u32 s33, s28, 2097152
    buffer_load_dwordx4 v20, s[8:11], s33 offen lds
    s_add_u32 m0, s30, 1024
    s_add_u32 s33, s28, 2129920
    buffer_load_dwordx4 v20, s[8:11], s33 offen lds
    s_add_u32 m0, s30, 2048
    s_add_u32 s33, s28, 2162688
    buffer_load_dwordx4 v20, s[8:11], s33 offen lds
    s_add_u32 m0, s30, 3072
    s_add_u32 s33, s28, 2195456
    buffer_load_dwordx4 v20, s[8:11], s33 offen lds
    v_add_u32 v22, 16384, v21
    v_xor_b32 v26, 32, v22
    ds_read_b64_tr_b16 a[8:9], v22 offset:0
    ds_read_b64_tr_b16 a[10:11], v22 offset:256
    ds_read_b64_tr_b16 a[12:13], v22 offset:2048
    ds_read_b64_tr_b16 a[14:15], v22 offset:2304
    ds_read_b64_tr_b16 a[72:73], v26 offset:0
    ds_read_b64_tr_b16 a[74:75], v26 offset:256
    ds_read_b64_tr_b16 a[76:77], v26 offset:2048
    ds_read_b64_tr_b16 a[78:79], v26 offset:2304
    s_waitcnt lgkmcnt(0)
    s_waitcnt vmcnt(20)
    s_barrier
    s_add_u32 m0, s30, 16384
    s_add_u32 s33, s28, 2621440
    buffer_load_dwordx4 v20, s[8:11], s33 offen lds
    s_add_u32 m0, s30, 17408
    s_add_u32 s33, s28, 2654208
    buffer_load_dwordx4 v20, s[8:11], s33 offen lds
    s_add_u32 m0, s30, 18432
    s_add_u32 s33, s28, 2686976
    buffer_load_dwordx4 v20, s[8:11], s33 offen lds
    s_add_u32 m0, s30, 19456
    s_add_u32 s33, s28, 2719744
    buffer_load_dwordx4 v20, s[8:11], s33 offen lds
    v_add_u32 v22, 49152, v21
    v_xor_b32 v26, 32, v22
    ds_read_b64_tr_b16 a[144:145], v22 offset:0
    ds_read_b64_tr_b16 a[146:147], v22 offset:256
    ds_read_b64_tr_b16 a[148:149], v22 offset:2048
    ds_read_b64_tr_b16 a[150:151], v22 offset:2304
    ds_read_b64_tr_b16 a[208:209], v26 offset:0
    ds_read_b64_tr_b16 a[210:211], v26 offset:256
    ds_read_b64_tr_b16 a[212:213], v26 offset:2048
    ds_read_b64_tr_b16 a[214:215], v26 offset:2304
    s_waitcnt lgkmcnt(0)
    s_waitcnt vmcnt(16)
    s_barrier
    s_add_u32 m0, s30, 49152
    s_add_u32 s33, s28, 3145728
    buffer_load_dwordx4 v20, s[8:11], s33 offen lds
    s_add_u32 m0, s30, 50176
    s_add_u32 s33, s28, 3178496
    buffer_load_dwordx4 v20, s[8:11], s33 offen lds
    s_add_u32 m0, s30, 51200
    s_add_u32 s33, s28, 3211264
    buffer_load_dwordx4 v20, s[8:11], s33 offen lds
    s_add_u32 m0, s30, 52224
    s_add_u32 s33, s28, 3244032
    buffer_load_dwordx4 v20, s[8:11], s33 offen lds
    v_add_u32 v22, 81920, v21
    v_xor_b32 v26, 32, v22
    ds_read_b64_tr_b16 a[152:153], v22 offset:0
    ds_read_b64_tr_b16 a[154:155], v22 offset:256
    ds_read_b64_tr_b16 a[156:157], v22 offset:2048
    ds_read_b64_tr_b16 a[158:159], v22 offset:2304
    ds_read_b64_tr_b16 a[216:217], v26 offset:0
    ds_read_b64_tr_b16 a[218:219], v26 offset:256
    ds_read_b64_tr_b16 a[220:221], v26 offset:2048
    ds_read_b64_tr_b16 a[222:223], v26 offset:2304
    s_waitcnt lgkmcnt(0)
    s_waitcnt vmcnt(16)
    s_barrier
    s_add_u32 m0, s30, 81920
    s_add_u32 s33, s28, 3670016
    buffer_load_dwordx4 v20, s[8:11], s33 offen lds
    s_add_u32 m0, s30, 82944
    s_add_u32 s33, s28, 3702784
    buffer_load_dwordx4 v20, s[8:11], s33 offen lds
    s_add_u32 m0, s30, 83968
    s_add_u32 s33, s28, 3735552
    buffer_load_dwordx4 v20, s[8:11], s33 offen lds
    s_add_u32 m0, s30, 84992
    s_add_u32 s33, s28, 3768320
    buffer_load_dwordx4 v20, s[8:11], s33 offen lds
    v_add_u32 v22, 114688, v21
    v_xor_b32 v26, 32, v22
    ds_read_b64_tr_b16 a[160:161], v22 offset:0
    ds_read_b64_tr_b16 a[162:163], v22 offset:256
    ds_read_b64_tr_b16 a[164:165], v22 offset:2048
    ds_read_b64_tr_b16 a[166:167], v22 offset:2304
    ds_read_b64_tr_b16 a[224:225], v26 offset:0
    ds_read_b64_tr_b16 a[226:227], v26 offset:256
    ds_read_b64_tr_b16 a[228:229], v26 offset:2048
    ds_read_b64_tr_b16 a[230:231], v26 offset:2304
    s_waitcnt lgkmcnt(0)
    ds_read_b64_tr_b16 v[32:33], v25 offset:0
    ds_read_b64_tr_b16 v[34:35], v25 offset:512
    ds_read_b64_tr_b16 v[36:37], v25 offset:2048
    ds_read_b64_tr_b16 v[38:39], v25 offset:2560
    v_xor_b32 v27, 32, v25
    ds_read_b64_tr_b16 v[40:41], v27 offset:0
    ds_read_b64_tr_b16 v[42:43], v27 offset:512
    ds_read_b64_tr_b16 v[44:45], v27 offset:2048
    ds_read_b64_tr_b16 v[46:47], v27 offset:2560
    s_waitcnt lgkmcnt(0)
    v_xor_b32 v27, 64, v25
    ds_read_b64_tr_b16 v[48:49], v27 offset:0
    ds_read_b64_tr_b16 v[50:51], v27 offset:512
    ds_read_b64_tr_b16 v[52:53], v27 offset:2048
    ds_read_b64_tr_b16 v[54:55], v27 offset:2560
    v_xor_b32 v27, 96, v25
    ds_read_b64_tr_b16 v[56:57], v27 offset:0
    ds_read_b64_tr_b16 v[58:59], v27 offset:512
    ds_read_b64_tr_b16 v[60:61], v27 offset:2048
    ds_read_b64_tr_b16 v[62:63], v27 offset:2560
    s_waitcnt lgkmcnt(0)
    v_xor_b32 v27, 128, v25
    ds_read_b64_tr_b16 v[64:65], v27 offset:0
    ds_read_b64_tr_b16 v[66:67], v27 offset:512
    ds_read_b64_tr_b16 v[68:69], v27 offset:2048
    ds_read_b64_tr_b16 v[70:71], v27 offset:2560
    v_xor_b32 v27, 160, v25
    ds_read_b64_tr_b16 v[72:73], v27 offset:0
    ds_read_b64_tr_b16 v[74:75], v27 offset:512
    ds_read_b64_tr_b16 v[76:77], v27 offset:2048
    ds_read_b64_tr_b16 v[78:79], v27 offset:2560
    s_waitcnt lgkmcnt(0)
    v_xor_b32 v27, 192, v25
    ds_read_b64_tr_b16 v[80:81], v27 offset:0
    ds_read_b64_tr_b16 v[82:83], v27 offset:512
    ds_read_b64_tr_b16 v[84:85], v27 offset:2048
    ds_read_b64_tr_b16 v[86:87], v27 offset:2560
    v_xor_b32 v27, 224, v25
    ds_read_b64_tr_b16 v[88:89], v27 offset:0
    ds_read_b64_tr_b16 v[90:91], v27 offset:512
    ds_read_b64_tr_b16 v[92:93], v27 offset:2048
    ds_read_b64_tr_b16 v[94:95], v27 offset:2560
    s_waitcnt lgkmcnt(0)
    ds_write_b128 v119, v[32:35] offset:0
    ds_write_b128 v119, v[36:39] offset:1024
    ds_write_b128 v119, v[40:43] offset:2048
    ds_write_b128 v119, v[44:47] offset:3072
    ds_write_b128 v119, v[48:51] offset:4096
    ds_write_b128 v119, v[52:55] offset:5120
    ds_write_b128 v119, v[56:59] offset:6144
    ds_write_b128 v119, v[60:63] offset:7168
    s_waitcnt lgkmcnt(0)
    ds_write_b128 v119, v[64:67] offset:8192
    ds_write_b128 v119, v[68:71] offset:9216
    ds_write_b128 v119, v[72:75] offset:10240
    ds_write_b128 v119, v[76:79] offset:11264
    ds_write_b128 v119, v[80:83] offset:12288
    ds_write_b128 v119, v[84:87] offset:13312
    ds_write_b128 v119, v[88:91] offset:14336
    ds_write_b128 v119, v[92:95] offset:15360
    s_waitcnt lgkmcnt(0)
    s_waitcnt vmcnt(16)
    s_barrier
    s_add_u32 m0, s30, 114688
    s_add_u32 s33, s28, 0
    buffer_load_dwordx4 v20, s[12:15], s33 offen lds
    s_add_u32 m0, s30, 115712
    s_add_u32 s33, s28, 32768
    buffer_load_dwordx4 v20, s[12:15], s33 offen lds
    s_add_u32 m0, s30, 116736
    s_add_u32 s33, s28, 65536
    buffer_load_dwordx4 v20, s[12:15], s33 offen lds
    s_add_u32 m0, s30, 117760
    s_add_u32 s33, s28, 98304
    buffer_load_dwordx4 v20, s[12:15], s33 offen lds
    v_add_u32 v22, 147456, v21
    v_xor_b32 v26, 32, v22
    ds_read_b64_tr_b16 a[168:169], v22 offset:0
    ds_read_b64_tr_b16 a[170:171], v22 offset:256
    ds_read_b64_tr_b16 a[172:173], v22 offset:2048
    ds_read_b64_tr_b16 a[174:175], v22 offset:2304
    ds_read_b64_tr_b16 a[232:233], v26 offset:0
    ds_read_b64_tr_b16 a[234:235], v26 offset:256
    ds_read_b64_tr_b16 a[236:237], v26 offset:2048
    ds_read_b64_tr_b16 a[238:239], v26 offset:2304
    s_waitcnt lgkmcnt(0)
    s_waitcnt vmcnt(16)
    s_barrier
    s_add_u32 m0, s30, 147456
    s_add_u32 s33, s28, 524288
    buffer_load_dwordx4 v20, s[12:15], s33 offen lds
    s_add_u32 m0, s30, 148480
    s_add_u32 s33, s28, 557056
    buffer_load_dwordx4 v20, s[12:15], s33 offen lds
    s_add_u32 m0, s30, 149504
    s_add_u32 s33, s28, 589824
    buffer_load_dwordx4 v20, s[12:15], s33 offen lds
    s_add_u32 m0, s30, 150528
    s_add_u32 s33, s28, 622592
    buffer_load_dwordx4 v20, s[12:15], s33 offen lds
    v_add_u32 v22, 0, v21
    v_xor_b32 v26, 32, v22
    ds_read_b64_tr_b16 a[176:177], v22 offset:0
    ds_read_b64_tr_b16 a[178:179], v22 offset:256
    ds_read_b64_tr_b16 a[180:181], v22 offset:2048
    ds_read_b64_tr_b16 a[182:183], v22 offset:2304
    ds_read_b64_tr_b16 a[240:241], v26 offset:0
    ds_read_b64_tr_b16 a[242:243], v26 offset:256
    ds_read_b64_tr_b16 a[244:245], v26 offset:2048
    ds_read_b64_tr_b16 a[246:247], v26 offset:2304
    s_waitcnt lgkmcnt(0)
    s_waitcnt vmcnt(16)
    s_barrier
    s_add_u32 m0, s30, 0
    s_add_u32 s33, s28, 1048576
    buffer_load_dwordx4 v20, s[12:15], s33 offen lds
    s_add_u32 m0, s30, 1024
    s_add_u32 s33, s28, 1081344
    buffer_load_dwordx4 v20, s[12:15], s33 offen lds
    s_add_u32 m0, s30, 2048
    s_add_u32 s33, s28, 1114112
    buffer_load_dwordx4 v20, s[12:15], s33 offen lds
    s_add_u32 m0, s30, 3072
    s_add_u32 s33, s28, 1146880
    buffer_load_dwordx4 v20, s[12:15], s33 offen lds
    v_add_u32 v22, 16384, v21
    v_xor_b32 v26, 32, v22
    ds_read_b64_tr_b16 a[184:185], v22 offset:0
    ds_read_b64_tr_b16 a[186:187], v22 offset:256
    ds_read_b64_tr_b16 a[188:189], v22 offset:2048
    ds_read_b64_tr_b16 a[190:191], v22 offset:2304
    ds_read_b64_tr_b16 a[248:249], v26 offset:0
    ds_read_b64_tr_b16 a[250:251], v26 offset:256
    ds_read_b64_tr_b16 a[252:253], v26 offset:2048
    ds_read_b64_tr_b16 a[254:255], v26 offset:2304
    s_waitcnt lgkmcnt(0)
    s_waitcnt vmcnt(16)
    s_barrier
    s_add_u32 m0, s30, 16384
    s_add_u32 s33, s28, 1572864
    buffer_load_dwordx4 v20, s[12:15], s33 offen lds
    s_add_u32 m0, s30, 17408
    s_add_u32 s33, s28, 1605632
    buffer_load_dwordx4 v20, s[12:15], s33 offen lds
    s_add_u32 m0, s30, 18432
    s_add_u32 s33, s28, 1638400
    buffer_load_dwordx4 v20, s[12:15], s33 offen lds
    s_add_u32 m0, s30, 19456
    s_add_u32 s33, s28, 1671168
    buffer_load_dwordx4 v20, s[12:15], s33 offen lds
    v_add_u32 v22, 49152, v21
    v_xor_b32 v26, 32, v22
    ds_read_b64_tr_b16 a[128:129], v22 offset:0
    ds_read_b64_tr_b16 a[130:131], v22 offset:256
    ds_read_b64_tr_b16 a[132:133], v22 offset:2048
    ds_read_b64_tr_b16 a[134:135], v22 offset:2304
    ds_read_b64_tr_b16 a[192:193], v26 offset:0
    ds_read_b64_tr_b16 a[194:195], v26 offset:256
    ds_read_b64_tr_b16 a[196:197], v26 offset:2048
    ds_read_b64_tr_b16 a[198:199], v26 offset:2304
    s_waitcnt lgkmcnt(0)
    s_waitcnt vmcnt(16)
    s_barrier
    v_add_u32 v22, 81920, v21
    v_xor_b32 v26, 32, v22
    ds_read_b64_tr_b16 a[136:137], v22 offset:0
    ds_read_b64_tr_b16 a[138:139], v22 offset:256
    ds_read_b64_tr_b16 a[140:141], v22 offset:2048
    ds_read_b64_tr_b16 a[142:143], v22 offset:2304
    ds_read_b64_tr_b16 a[200:201], v26 offset:0
    ds_read_b64_tr_b16 a[202:203], v26 offset:256
    ds_read_b64_tr_b16 a[204:205], v26 offset:2048
    ds_read_b64_tr_b16 a[206:207], v26 offset:2304
    s_waitcnt lgkmcnt(0)
    s_waitcnt vmcnt(12)
    s_barrier
    v_add_u32 v22, 114688, v21
    v_xor_b32 v26, 32, v22
    ds_read_b64_tr_b16 v[144:145], v22 offset:0
    ds_read_b64_tr_b16 v[146:147], v22 offset:256
    ds_read_b64_tr_b16 v[148:149], v22 offset:2048
    ds_read_b64_tr_b16 v[150:151], v22 offset:2304
    ds_read_b64_tr_b16 v[208:209], v26 offset:0
    ds_read_b64_tr_b16 v[210:211], v26 offset:256
    ds_read_b64_tr_b16 v[212:213], v26 offset:2048
    ds_read_b64_tr_b16 v[214:215], v26 offset:2304
    s_waitcnt lgkmcnt(0)
    s_waitcnt vmcnt(8)
    s_barrier
    v_add_u32 v22, 147456, v21
    v_xor_b32 v26, 32, v22
    ds_read_b64_tr_b16 v[152:153], v22 offset:0
    ds_read_b64_tr_b16 v[154:155], v22 offset:256
    ds_read_b64_tr_b16 v[156:157], v22 offset:2048
    ds_read_b64_tr_b16 v[158:159], v22 offset:2304
    ds_read_b64_tr_b16 v[216:217], v26 offset:0
    ds_read_b64_tr_b16 v[218:219], v26 offset:256
    ds_read_b64_tr_b16 v[220:221], v26 offset:2048
    ds_read_b64_tr_b16 v[222:223], v26 offset:2304
    s_waitcnt lgkmcnt(0)
    s_waitcnt vmcnt(4)
    s_barrier
    v_xor_b32 v24, 0, v23
    s_add_u32 m0, s29, 16384
    s_add_u32 s33, s31, 65536
    buffer_load_dwordx4 v24, s[16:19], s33 offen lds
    s_add_u32 m0, s29, 17408
    s_add_u32 s33, s31, 69632
    buffer_load_dwordx4 v24, s[16:19], s33 offen lds
    s_add_u32 m0, s29, 18432
    s_add_u32 s33, s31, 73728
    buffer_load_dwordx4 v24, s[16:19], s33 offen lds
    s_add_u32 m0, s29, 19456
    s_add_u32 s33, s31, 77824
    buffer_load_dwordx4 v24, s[16:19], s33 offen lds
    v_xor_b32 v24, 64, v23
    s_add_u32 m0, s29, 20480
    s_add_u32 s33, s31, 81920
    buffer_load_dwordx4 v24, s[16:19], s33 offen lds
    s_add_u32 m0, s29, 21504
    s_add_u32 s33, s31, 86016
    buffer_load_dwordx4 v24, s[16:19], s33 offen lds
    s_add_u32 m0, s29, 22528
    s_add_u32 s33, s31, 90112
    buffer_load_dwordx4 v24, s[16:19], s33 offen lds
    s_add_u32 m0, s29, 23552
    s_add_u32 s33, s31, 94208
    buffer_load_dwordx4 v24, s[16:19], s33 offen lds
    v_xor_b32 v24, 128, v23
    s_add_u32 m0, s29, 24576
    s_add_u32 s33, s31, 98304
    buffer_load_dwordx4 v24, s[16:19], s33 offen lds
    s_add_u32 m0, s29, 25600
    s_add_u32 s33, s31, 102400
    buffer_load_dwordx4 v24, s[16:19], s33 offen lds
    s_add_u32 m0, s29, 26624
    s_add_u32 s33, s31, 106496
    buffer_load_dwordx4 v24, s[16:19], s33 offen lds
    s_add_u32 m0, s29, 27648
    s_add_u32 s33, s31, 110592
    buffer_load_dwordx4 v24, s[16:19], s33 offen lds
    v_xor_b32 v24, 192, v23
    s_add_u32 m0, s29, 28672
    s_add_u32 s33, s31, 114688
    buffer_load_dwordx4 v24, s[16:19], s33 offen lds
    s_add_u32 m0, s29, 29696
    s_add_u32 s33, s31, 118784
    buffer_load_dwordx4 v24, s[16:19], s33 offen lds
    s_add_u32 m0, s29, 30720
    s_add_u32 s33, s31, 122880
    buffer_load_dwordx4 v24, s[16:19], s33 offen lds
    s_add_u32 m0, s29, 31744
    s_add_u32 s33, s31, 126976
    buffer_load_dwordx4 v24, s[16:19], s33 offen lds
    v_add_u32 v22, 0, v21
    v_xor_b32 v26, 32, v22
    ds_read_b64_tr_b16 v[160:161], v22 offset:0
    ds_read_b64_tr_b16 v[162:163], v22 offset:256
    ds_read_b64_tr_b16 v[164:165], v22 offset:2048
    ds_read_b64_tr_b16 v[166:167], v22 offset:2304
    ds_read_b64_tr_b16 v[224:225], v26 offset:0
    ds_read_b64_tr_b16 v[226:227], v26 offset:256
    ds_read_b64_tr_b16 v[228:229], v26 offset:2048
    ds_read_b64_tr_b16 v[230:231], v26 offset:2304
    s_waitcnt lgkmcnt(0)
    s_waitcnt vmcnt(16)
    s_barrier
    s_add_u32 m0, s30, 0
    s_add_u32 s33, s28, 2097152
    buffer_load_dwordx4 v20, s[12:15], s33 offen lds
    s_add_u32 m0, s30, 1024
    s_add_u32 s33, s28, 2129920
    buffer_load_dwordx4 v20, s[12:15], s33 offen lds
    s_add_u32 m0, s30, 2048
    s_add_u32 s33, s28, 2162688
    buffer_load_dwordx4 v20, s[12:15], s33 offen lds
    s_add_u32 m0, s30, 3072
    s_add_u32 s33, s28, 2195456
    buffer_load_dwordx4 v20, s[12:15], s33 offen lds
    v_add_u32 v22, 16384, v21
    v_xor_b32 v26, 32, v22
    ds_read_b64_tr_b16 v[168:169], v22 offset:0
    ds_read_b64_tr_b16 v[170:171], v22 offset:256
    ds_read_b64_tr_b16 v[172:173], v22 offset:2048
    ds_read_b64_tr_b16 v[174:175], v22 offset:2304
    ds_read_b64_tr_b16 v[232:233], v26 offset:0
    ds_read_b64_tr_b16 v[234:235], v26 offset:256
    ds_read_b64_tr_b16 v[236:237], v26 offset:2048
    ds_read_b64_tr_b16 v[238:239], v26 offset:2304
    s_waitcnt lgkmcnt(0)
    s_waitcnt vmcnt(0)
    s_barrier
    s_add_u32 m0, s30, 16384
    s_add_u32 s33, s28, 2621440
    buffer_load_dwordx4 v20, s[12:15], s33 offen lds
    s_add_u32 m0, s30, 17408
    s_add_u32 s33, s28, 2654208
    buffer_load_dwordx4 v20, s[12:15], s33 offen lds
    s_add_u32 m0, s30, 18432
    s_add_u32 s33, s28, 2686976
    buffer_load_dwordx4 v20, s[12:15], s33 offen lds
    s_add_u32 m0, s30, 19456
    s_add_u32 s33, s28, 2719744
    buffer_load_dwordx4 v20, s[12:15], s33 offen lds
    v_add_u32 v22, 0, v21
    v_xor_b32 v26, 32, v22
    ds_read_b64_tr_b16 v[176:177], v22 offset:0
    ds_read_b64_tr_b16 v[178:179], v22 offset:256
    ds_read_b64_tr_b16 v[180:181], v22 offset:2048
    ds_read_b64_tr_b16 v[182:183], v22 offset:2304
    ds_read_b64_tr_b16 v[240:241], v26 offset:0
    ds_read_b64_tr_b16 v[242:243], v26 offset:256
    ds_read_b64_tr_b16 v[244:245], v26 offset:2048
    ds_read_b64_tr_b16 v[246:247], v26 offset:2304
    s_waitcnt lgkmcnt(0)
    s_waitcnt vmcnt(0)
    s_barrier
    s_add_u32 m0, s30, 0
    s_add_u32 s33, s28, 3145728
    buffer_load_dwordx4 v20, s[12:15], s33 offen lds
    s_add_u32 m0, s30, 1024
    s_add_u32 s33, s28, 3178496
    buffer_load_dwordx4 v20, s[12:15], s33 offen lds
    s_add_u32 m0, s30, 2048
    s_add_u32 s33, s28, 3211264
    buffer_load_dwordx4 v20, s[12:15], s33 offen lds
    s_add_u32 m0, s30, 3072
    s_add_u32 s33, s28, 3244032
    buffer_load_dwordx4 v20, s[12:15], s33 offen lds
    v_add_u32 v22, 16384, v21
    v_xor_b32 v26, 32, v22
    ds_read_b64_tr_b16 v[184:185], v22 offset:0
    ds_read_b64_tr_b16 v[186:187], v22 offset:256
    ds_read_b64_tr_b16 v[188:189], v22 offset:2048
    ds_read_b64_tr_b16 v[190:191], v22 offset:2304
    ds_read_b64_tr_b16 v[248:249], v26 offset:0
    ds_read_b64_tr_b16 v[250:251], v26 offset:256
    ds_read_b64_tr_b16 v[252:253], v26 offset:2048
    ds_read_b64_tr_b16 v[254:255], v26 offset:2304
    s_waitcnt lgkmcnt(0)
    ds_read_b64_tr_b16 v[32:33], v25 offset:16384
    ds_read_b64_tr_b16 v[34:35], v25 offset:16896
    ds_read_b64_tr_b16 v[36:37], v25 offset:18432
    ds_read_b64_tr_b16 v[38:39], v25 offset:18944
    v_xor_b32 v27, 32, v25
    ds_read_b64_tr_b16 v[40:41], v27 offset:16384
    ds_read_b64_tr_b16 v[42:43], v27 offset:16896
    ds_read_b64_tr_b16 v[44:45], v27 offset:18432
    ds_read_b64_tr_b16 v[46:47], v27 offset:18944
    s_waitcnt lgkmcnt(0)
    v_xor_b32 v27, 64, v25
    ds_read_b64_tr_b16 v[48:49], v27 offset:16384
    ds_read_b64_tr_b16 v[50:51], v27 offset:16896
    ds_read_b64_tr_b16 v[52:53], v27 offset:18432
    ds_read_b64_tr_b16 v[54:55], v27 offset:18944
    v_xor_b32 v27, 96, v25
    ds_read_b64_tr_b16 v[56:57], v27 offset:16384
    ds_read_b64_tr_b16 v[58:59], v27 offset:16896
    ds_read_b64_tr_b16 v[60:61], v27 offset:18432
    ds_read_b64_tr_b16 v[62:63], v27 offset:18944
    s_waitcnt lgkmcnt(0)
    v_xor_b32 v27, 128, v25
    ds_read_b64_tr_b16 v[64:65], v27 offset:16384
    ds_read_b64_tr_b16 v[66:67], v27 offset:16896
    ds_read_b64_tr_b16 v[68:69], v27 offset:18432
    ds_read_b64_tr_b16 v[70:71], v27 offset:18944
    v_xor_b32 v27, 160, v25
    ds_read_b64_tr_b16 v[72:73], v27 offset:16384
    ds_read_b64_tr_b16 v[74:75], v27 offset:16896
    ds_read_b64_tr_b16 v[76:77], v27 offset:18432
    ds_read_b64_tr_b16 v[78:79], v27 offset:18944
    s_waitcnt lgkmcnt(0)
    v_xor_b32 v27, 192, v25
    ds_read_b64_tr_b16 v[80:81], v27 offset:16384
    ds_read_b64_tr_b16 v[82:83], v27 offset:16896
    ds_read_b64_tr_b16 v[84:85], v27 offset:18432
    ds_read_b64_tr_b16 v[86:87], v27 offset:18944
    v_xor_b32 v27, 224, v25
    ds_read_b64_tr_b16 v[88:89], v27 offset:16384
    ds_read_b64_tr_b16 v[90:91], v27 offset:16896
    ds_read_b64_tr_b16 v[92:93], v27 offset:18432
    ds_read_b64_tr_b16 v[94:95], v27 offset:18944
    s_waitcnt lgkmcnt(0)
    ds_write_b128 v119, v[32:35] offset:16384
    ds_write_b128 v119, v[36:39] offset:17408
    ds_write_b128 v119, v[40:43] offset:18432
    ds_write_b128 v119, v[44:47] offset:19456
    ds_write_b128 v119, v[48:51] offset:20480
    ds_write_b128 v119, v[52:55] offset:21504
    ds_write_b128 v119, v[56:59] offset:22528
    ds_write_b128 v119, v[60:63] offset:23552
    s_waitcnt lgkmcnt(0)
    ds_write_b128 v119, v[64:67] offset:24576
    ds_write_b128 v119, v[68:71] offset:25600
    ds_write_b128 v119, v[72:75] offset:26624
    ds_write_b128 v119, v[76:79] offset:27648
    ds_write_b128 v119, v[80:83] offset:28672
    ds_write_b128 v119, v[84:87] offset:29696
    ds_write_b128 v119, v[88:91] offset:30720
    ds_write_b128 v119, v[92:95] offset:31744
    s_waitcnt lgkmcnt(0)
    s_waitcnt vmcnt(0)
    s_barrier
    s_add_u32 m0, s30, 16384
    s_add_u32 s33, s28, 3670016
    buffer_load_dwordx4 v20, s[12:15], s33 offen lds
    s_add_u32 m0, s30, 17408
    s_add_u32 s33, s28, 3702784
    buffer_load_dwordx4 v20, s[12:15], s33 offen lds
    s_add_u32 m0, s30, 18432
    s_add_u32 s33, s28, 3735552
    buffer_load_dwordx4 v20, s[12:15], s33 offen lds
    s_add_u32 m0, s30, 19456
    s_add_u32 s33, s28, 3768320
    buffer_load_dwordx4 v20, s[12:15], s33 offen lds
    v_add_u32 v22, 0, v21
    v_xor_b32 v26, 32, v22
    ds_read_b64_tr_b16 v[128:129], v22 offset:0
    ds_read_b64_tr_b16 v[130:131], v22 offset:256
    ds_read_b64_tr_b16 v[132:133], v22 offset:2048
    ds_read_b64_tr_b16 v[134:135], v22 offset:2304
    ds_read_b64_tr_b16 v[192:193], v26 offset:0
    ds_read_b64_tr_b16 v[194:195], v26 offset:256
    ds_read_b64_tr_b16 v[196:197], v26 offset:2048
    ds_read_b64_tr_b16 v[198:199], v26 offset:2304
    s_waitcnt lgkmcnt(0)
    s_waitcnt vmcnt(0)
    s_barrier
    v_add_u32 v22, 16384, v21
    v_xor_b32 v26, 32, v22
    ds_read_b64_tr_b16 v[136:137], v22 offset:0
    ds_read_b64_tr_b16 v[138:139], v22 offset:256
    ds_read_b64_tr_b16 v[140:141], v22 offset:2048
    ds_read_b64_tr_b16 v[142:143], v22 offset:2304
    ds_read_b64_tr_b16 v[200:201], v26 offset:0
    ds_read_b64_tr_b16 v[202:203], v26 offset:256
    ds_read_b64_tr_b16 v[204:205], v26 offset:2048
    ds_read_b64_tr_b16 v[206:207], v26 offset:2304
    s_waitcnt lgkmcnt(0)
L_wl_done:
    s_waitcnt vmcnt(0)
    s_barrier
    s_load_dwordx2 s[64:65], s[0:1], 88
    v_mov_b32 v125, 0
    s_mov_b32 s61, 0
    s_waitcnt lgkmcnt(0)
Lwi_1:
    global_load_dword v126, v125, s[64:65] offset:40 sc1
    s_add_u32 s61, s61, 1
    s_cmp_gt_u32 s61, 2000000
    s_cbranch_scc1 L_fail
    s_waitcnt vmcnt(0)
    v_cmp_gt_u32 vcc, 64, v126
    s_cbranch_vccz Lwi_1_ok
    s_sleep 4
    s_branch Lwi_1
Lwi_1_ok:
    v_mov_b32 v125, 0
    v_mov_b32 v126, 0
    s_mov_b32 s42, 0x00003f80
    s_mov_b32 s43, 0x3f800000
    s_mov_b32 s38, 0xf0f0f0f0
    s_mov_b32 s39, 0xf0f0f0f0
    s_lshl_b32 s27, s25, 11
    s_add_u32 s92, s27, 0x0
    s_add_u32 s93, s27, 0x2000
    s_add_u32 s47, s27, 0
    s_add_u32 s28, s27, 2048
    s_and_b32 s96, s28, 0x1fff
    s_add_u32 s28, s27, 4096
    s_and_b32 s97, s28, 0x1fff
    s_add_u32 s28, s27, 6144
    s_and_b32 s98, s28, 0x1fff
    s_add_u32 s52, s27, 0x400000
    s_mov_b32 s26, 0
    s_lshl_b32 s33, s24, 13
    s_add_u32 s90, s33, s27
    s_add_u32 s90, s90, 0x1000000
    s_lshl_b32 s34, s25, 6
    s_add_u32 s91, s33, s34
    s_add_u32 s91, s91, 0x2000000
    s_lshl_b32 s33, s24, 3
    s_add_u32 s99, s33, 0x410000
    v_lshrrev_b32 v110, 2, v112
    s_mov_b32 s45, 0
L_fkv0:
    buffer_load_dword v111, v110, s[20:23], s99 offen sc1
    s_add_u32 s45, s45, 1
    s_cmp_gt_u32 s45, 2000000
    s_cbranch_scc1 L_fail
    s_waitcnt vmcnt(0)
    v_cmp_eq_u32 vcc, 0, v111
    s_and_b32 vcc_lo, vcc_lo, 3
    s_cbranch_scc1 L_fkv0
    s_add_u32 s99, s99, 2048
    buffer_load_dword v116, v110, s[20:23], s99 offen sc1
    s_lshl_b32 s33, s24, 4
    s_lshl_b32 s34, s25, 2
    s_add_u32 s33, s33, s34
    s_add_u32 s100, s33, 0x40f400
    s_lshl_b32 s33, s24, 13
    s_and_b32 s34, s25, 1
    s_lshl_b32 s34, s34, 12
    s_add_u32 s33, s33, s34
    s_lshr_b32 s34, s25, 1
    s_lshl_b32 s34, s34, 24
    s_add_u32 s33, s33, s34
    s_add_u32 s94, s33, 0x1040000
    s_mov_b32 m0, s92
    v_xor_b32 v110, 64, v122
    buffer_load_dwordx4 v122, s[20:23], s90 offen lds
    s_add_u32 m0, s92, 1024
    s_add_u32 s90, s90, 1024
    buffer_load_dwordx4 v110, s[20:23], s90 offen lds
    s_mov_b32 m0, s93
    s_add_u32 s33, s91, 4096
    buffer_load_dwordx4 v123, s[20:23], s91 offen lds
    s_add_u32 m0, s93, 1024
    s_nop 0
    buffer_load_dwordx4 v123, s[20:23], s33 offen lds
    v_mov_b64 v[32:33], 0
    v_mov_b64 v[34:35], 0
    v_mov_b64 v[36:37], 0
    v_mov_b64 v[38:39], 0
    v_mov_b64 v[40:41], 0
    v_mov_b64 v[42:43], 0
    v_mov_b64 v[44:45], 0
    v_mov_b64 v[46:47], 0
    v_mov_b64 v[48:49], 0
    v_mov_b64 v[50:51], 0
    v_mov_b64 v[52:53], 0
    v_mov_b64 v[54:55], 0
    s_lshl_b32 s29, s24, 13
    s_lshl_b32 s30, s25, 11
    s_add_u32 s29, s29, s30
    s_add_u32 s55, s29, 0x500000
    s_mov_b32 s46, 1
    s_lshl_b32 s29, s25, 16
    s_lshl_b32 s30, s24, 6
    s_add_u32 s29, s29, s30
    s_add_u32 s95, s29, 0x500000
    s_lshl_b32 s29, s24, 8
    s_add_u32 s58, s29, 0x400000
    s_xor_b32 s57, s58, 0x2000
    s_lshl_b32 s27, s24, 12
    s_lshl_b32 s28, s25, 10
    s_add_u32 s27, s27, s28
    s_add_u32 s59, s27, 0x7e0000
    v_add_u32 v88, s47, v112
    v_add_u32 v89, s96, v112
    v_add_u32 v90, s97, v112
    v_add_u32 v91, s98, v112
    s_waitcnt vmcnt(0)
L_step:
    s_sleep 2
    buffer_load_dwordx4 v[0:3], v112, s[20:23], s52 offen sc1
    buffer_load_dwordx4 v[4:7], v112, s[20:23], s52 offen offset:1024 sc1
    s_sleep 2
    s_mov_b32 s45, 0
    buffer_load_dwordx4 v[96:99], v112, s[20:23], s52 offen sc1
    buffer_load_dwordx4 v[100:103], v112, s[20:23], s52 offen offset:1024 sc1
L_poll2:
    s_waitcnt vmcnt(2)
    ds_write_b128 v88, v[0:3] offset:24576
    ds_write_b128 v88, v[4:7] offset:25600
    v_max3_u32 v108, v0, v1, v2
    v_max3_u32 v109, v3, v4, v5
    v_max3_u32 v108, v108, v6, v7
    v_max_u32 v108, v108, v109
    v_cmp_eq_u32 vcc, -1, v108
    s_cbranch_vccz L_h2_A
    buffer_load_dwordx4 v[0:3], v112, s[20:23], s52 offen sc1
    buffer_load_dwordx4 v[4:7], v112, s[20:23], s52 offen offset:1024 sc1
    s_waitcnt vmcnt(2)
    ds_write_b128 v88, v[96:99] offset:24576
    ds_write_b128 v88, v[100:103] offset:25600
    v_max3_u32 v108, v96, v97, v98
    v_max3_u32 v109, v99, v100, v101
    v_max3_u32 v108, v108, v102, v103
    v_max_u32 v108, v108, v109
    v_cmp_eq_u32 vcc, -1, v108
    s_cbranch_vccz L_h2_B
    buffer_load_dwordx4 v[96:99], v112, s[20:23], s52 offen sc1
    buffer_load_dwordx4 v[100:103], v112, s[20:23], s52 offen offset:1024 sc1
    s_add_u32 s45, s45, 1
    s_cmp_gt_u32 s45, 1000000
    s_cbranch_scc0 L_poll2
    s_branch L_fail
L_h2_B:
    v_smfmac_f32_16x16x64_bf16 v[32:35], v[96:99], a[0:7], v113
    v_smfmac_f32_16x16x64_bf16 v[36:39], v[96:99], a[64:71], v113
    v_smfmac_f32_16x16x64_bf16 v[40:43], v[96:99], a[128:135], v113
    v_smfmac_f32_16x16x64_bf16 v[44:47], v[96:99], a[192:199], v113
    s_waitcnt lgkmcnt(0)
    s_barrier
    ds_read_b128 v[8:11], v89 offset:24576
    ds_read_b128 v[12:15], v89 offset:25600
    v_smfmac_f32_16x16x64_bf16 v[32:35], v[100:103], a[8:15], v113
    ds_read_b128 v[16:19], v90 offset:24576
    ds_read_b128 v[20:23], v90 offset:25600
    v_smfmac_f32_16x16x64_bf16 v[36:39], v[100:103], a[72:79], v113
    ds_read_b128 v[24:27], v91 offset:24576
    ds_read_b128 v[28:31], v91 offset:25600
    v_smfmac_f32_16x16x64_bf16 v[40:43], v[100:103], a[136:143], v113
    v_smfmac_f32_16x16x64_bf16 v[44:47], v[100:103], a[200:207], v113
    s_branch L_h2_join
L_h2_A:
    v_smfmac_f32_16x16x64_bf16 v[32:35], v[0:3], a[0:7], v113
    v_smfmac_f32_16x16x64_bf16 v[36:39], v[0:3], a[64:71], v113
    v_smfmac_f32_16x16x64_bf16 v[40:43], v[0:3], a[128:135], v113
    v_smfmac_f32_16x16x64_bf16 v[44:47], v[0:3], a[192:199], v113
    s_waitcnt lgkmcnt(0)
    s_barrier
    ds_read_b128 v[8:11], v89 offset:24576
    ds_read_b128 v[12:15], v89 offset:25600
    v_smfmac_f32_16x16x64_bf16 v[32:35], v[4:7], a[8:15], v113
    ds_read_b128 v[16:19], v90 offset:24576
    ds_read_b128 v[20:23], v90 offset:25600
    v_smfmac_f32_16x16x64_bf16 v[36:39], v[4:7], a[72:79], v113
    ds_read_b128 v[24:27], v91 offset:24576
    ds_read_b128 v[28:31], v91 offset:25600
    v_smfmac_f32_16x16x64_bf16 v[40:43], v[4:7], a[136:143], v113
    v_smfmac_f32_16x16x64_bf16 v[44:47], v[4:7], a[200:207], v113
L_h2_join:
    s_waitcnt lgkmcnt(5)
    v_smfmac_f32_16x16x64_bf16 v[32:35], v[8:11], a[16:23], v113
    ds_read_b128 v[56:59], v117 offset:0
    ds_read_b128 v[72:75], v117 offset:4096
    v_xor_b32 v109, 64, v117
    v_smfmac_f32_16x16x64_bf16 v[36:39], v[8:11], a[80:87], v113
    ds_read_b128 v[60:63], v109 offset:0
    ds_read_b128 v[76:79], v109 offset:4096
    v_xor_b32 v109, 128, v117
    v_smfmac_f32_16x16x64_bf16 v[40:43], v[8:11], a[144:151], v113
    ds_read_b128 v[64:67], v109 offset:0
    ds_read_b128 v[80:83], v109 offset:4096
    v_xor_b32 v109, 192, v117
    v_smfmac_f32_16x16x64_bf16 v[44:47], v[8:11], a[208:215], v113
    ds_read_b128 v[68:71], v109 offset:0
    ds_read_b128 v[84:87], v109 offset:4096
    v_lshlrev_b32 v110, 2, v112
    s_waitcnt lgkmcnt(12)
    v_smfmac_f32_16x16x64_bf16 v[32:35], v[12:15], a[24:31], v113
    v_cmp_eq_u32 vcc, 0, v116
    v_smfmac_f32_16x16x64_bf16 v[36:39], v[12:15], a[88:95], v113
    v_smfmac_f32_16x16x64_bf16 v[40:43], v[12:15], a[152:159], v113
    s_and_b32 vcc_lo, vcc_lo, 3
    s_cbranch_scc1 L_fkv_slow
L_fkv_ok:
    v_smfmac_f32_16x16x64_bf16 v[44:47], v[12:15], a[216:223], v113
    buffer_load_dword v116, v110, s[20:23], s94 offen
    s_add_u32 s94, s94, 0x40000
    v_lshrrev_b32 v110, 2, v112
    s_waitcnt lgkmcnt(11)
    v_smfmac_f32_16x16x64_bf16 v[32:35], v[16:19], a[32:39], v113
    v_smfmac_f32_16x16x64_bf16 v[36:39], v[16:19], a[96:103], v113
    s_add_u32 s99, s99, 2048
    buffer_load_dword v116, v110, s[20:23], s99 offen sc1
    v_smfmac_f32_16x16x64_bf16 v[40:43], v[16:19], a[160:167], v113
    s_mov_b32 s54, s95
    s_add_u32 s90, s90, 0x3fc00
    v_smfmac_f32_16x16x64_bf16 v[44:47], v[16:19], a[224:231], v113
    s_add_u32 s91, s91, 0x40000
    s_waitcnt lgkmcnt(10)
    v_smfmac_f32_16x16x64_bf16 v[32:35], v[20:23], a[40:47], v113
    s_mov_b64 exec, 1
    buffer_store_dword v113, v125, s[20:23], s100 offen sc1
    s_mov_b64 exec, -1
    v_smfmac_f32_16x16x64_bf16 v[36:39], v[20:23], a[104:111], v113
    s_add_u32 s100, s100, 2048
    v_smfmac_f32_16x16x64_bf16 v[40:43], v[20:23], a[168:175], v113
    s_cmp_gt_u32 s26, 61
    s_cbranch_scc1 L_pub_flag
L_pub_flag_ok:
    v_smfmac_f32_16x16x64_bf16 v[44:47], v[20:23], a[232:239], v113
    buffer_store_dwordx4 v[104:107], v112, s[20:23], s59 offen sc1
    s_waitcnt lgkmcnt(9)
    v_smfmac_f32_16x16x64_bf16 v[32:35], v[24:27], a[48:55], v113
    s_add_u32 s59, s59, 0x20000
    v_smfmac_f32_16x16x64_bf16 v[36:39], v[24:27], a[112:119], v113
    v_smfmac_f32_16x16x64_bf16 v[40:43], v[24:27], a[176:183], v113
    v_smfmac_f32_16x16x64_bf16 v[44:47], v[24:27], a[240:247], v113
    s_waitcnt lgkmcnt(8)
    v_smfmac_f32_16x16x64_bf16 v[32:35], v[28:31], a[56:63], v113
    v_smfmac_f32_16x16x64_bf16 v[36:39], v[28:31], a[120:127], v113
    v_smfmac_f32_16x16x64_bf16 v[40:43], v[28:31], a[184:191], v113
    v_smfmac_f32_16x16x64_bf16 v[44:47], v[28:31], a[248:255], v113
    s_waitcnt vmcnt(4)
    v_smfmac_f32_16x16x64_bf16 v[48:51], v[0:3], v[128:135], v113
    v_smfmac_f32_16x16x64_bf16 v[52:55], v[0:3], v[192:199], v113
    s_cmp_eq_u32 s26, 63
    v_pk_add_f32 v[32:33], v[32:33], v[34:35]
    v_pk_add_f32 v[36:37], v[36:37], v[38:39]
    v_pk_add_f32 v[40:41], v[40:41], v[42:43]
    v_pk_add_f32 v[44:45], v[44:45], v[46:47]
    v_cvt_pk_bf16_f32 v108, v32, v33
    v_cvt_pk_bf16_f32 v109, v36, v37
    ds_write2_b32 v114, v108, v108 offset0:0 offset1:1
    v_cvt_pk_bf16_f32 v104, v40, v41
    ds_write2_b32 v114, v109, v109 offset0:128 offset1:129
    v_cvt_pk_bf16_f32 v105, v44, v45
    ds_write2st64_b32 v114, v104, v105 offset0:16 offset1:18
    s_cbranch_scc1 L_last
    v_smfmac_f32_16x16x64_bf16 v[48:51], v[4:7], v[136:143], v113
    v_smfmac_f32_16x16x64_bf16 v[52:55], v[4:7], v[200:207], v113
    v_smfmac_f32_16x16x64_bf16 v[48:51], v[8:11], v[144:151], v113
    v_smfmac_f32_16x16x64_bf16 v[52:55], v[8:11], v[208:215], v113
    v_smfmac_f32_16x16x64_bf16 v[48:51], v[12:15], v[152:159], v113
    v_smfmac_f32_16x16x64_bf16 v[52:55], v[12:15], v[216:223], v113
    s_waitcnt lgkmcnt(0)
    s_barrier
    v_xor_b32 v110, 136, v115
    ds_read_b64_tr_b16 v[88:89], v115 offset:0
    ds_read_b64_tr_b16 v[90:91], v110 offset:0
    ds_read_b64_tr_b16 v[92:93], v115 offset:1024
    ds_read_b64_tr_b16 v[94:95], v110 offset:1024
    v_smfmac_f32_16x16x64_bf16 v[48:51], v[16:19], v[160:167], v113
    ds_read_b64_tr_b16 v[96:97], v115 offset:2048
    ds_read_b64_tr_b16 v[98:99], v110 offset:2048
    v_smfmac_f32_16x16x64_bf16 v[52:55], v[16:19], v[224:231], v113
    ds_read_b64_tr_b16 v[100:101], v115 offset:3072
    ds_read_b64_tr_b16 v[102:103], v110 offset:3072
    v_smfmac_f32_16x16x64_bf16 v[48:51], v[20:23], v[168:175], v113
    ds_read_b64_tr_b16 v[0:1], v115 offset:4096
    ds_read_b64_tr_b16 v[2:3], v110 offset:4096
    v_smfmac_f32_16x16x64_bf16 v[52:55], v[20:23], v[232:239], v113
    ds_read_b64_tr_b16 v[4:5], v115 offset:5120
    ds_read_b64_tr_b16 v[6:7], v110 offset:5120
    s_waitcnt lgkmcnt(10)
    v_mfma_f32_16x16x32_bf16 v[32:35], v[56:59], v[88:91], 0
    ds_read_b64_tr_b16 v[8:9], v115 offset:6144
    ds_read_b64_tr_b16 v[10:11], v110 offset:6144
    v_mfma_f32_16x16x32_bf16 v[36:39], v[72:75], v[88:91], 0
    ds_read_b64_tr_b16 v[12:13], v115 offset:7168
    ds_read_b64_tr_b16 v[14:15], v110 offset:7168
    s_waitcnt lgkmcnt(12)
    v_mfma_f32_16x16x32_bf16 v[32:35], v[60:63], v[92:95], v[32:35]
    s_mov_b32 m0, s92
    v_xor_b32 v110, 64, v122
    v_mfma_f32_16x16x32_bf16 v[36:39], v[76:79], v[92:95], v[36:39]
    buffer_load_dwordx4 v122, s[20:23], s90 offen lds
    s_add_u32 m0, s92, 1024
    s_waitcnt lgkmcnt(10)
    v_mfma_f32_16x16x32_bf16 v[32:35], v[64:67], v[96:99], v[32:35]
    s_add_u32 s90, s90, 1024
    v_mfma_f32_16x16x32_bf16 v[36:39], v[80:83], v[96:99], v[36:39]
    buffer_load_dwordx4 v110, s[20:23], s90 offen lds
    s_waitcnt lgkmcnt(8)
    v_mfma_f32_16x16x32_bf16 v[32:35], v[68:71], v[100:103], v[32:35]
    v_mov_b32 v44, 0x3f803f80
    v_mfma_f32_16x16x32_bf16 v[36:39], v[84:87], v[100:103], v[36:39]
    v_mov_b32 v45, 0x3f803f80
    s_waitcnt lgkmcnt(0)
    v_mfma_f32_16x16x32_bf16 v[40:43], v[0:3], v[88:91], 0
    ds_read_b64_tr_b16 v[56:57], v118
    ds_read_b64_tr_b16 v[58:59], v118 offset:1024
    v_xor_b32 v110, 32, v118
    v_mfma_f32_16x16x32_bf16 v[40:43], v[4:7], v[92:95], v[40:43]
    ds_read_b64_tr_b16 v[60:61], v110
    ds_read_b64_tr_b16 v[62:63], v110 offset:1024
    v_mfma_f32_16x16x32_bf16 v[40:43], v[8:11], v[96:99], v[40:43]
    v_mov_b32 v46, 0x3f803f80
    v_mfma_f32_16x16x32_bf16 v[40:43], v[12:15], v[100:103], v[40:43]
    v_mov_b32 v47, 0x3f803f80
    v_smfmac_f32_16x16x64_bf16 v[48:51], v[24:27], v[176:183], v113
    ds_read_b128 v[0:3], v119 offset:0
    ds_read_b128 v[4:7], v119 offset:1024
    v_smfmac_f32_16x16x64_bf16 v[52:55], v[24:27], v[240:247], v113
    ds_read_b128 v[8:11], v119 offset:16384
    ds_read_b128 v[12:15], v119 offset:17408
    v_smfmac_f32_16x16x64_bf16 v[48:51], v[28:31], v[184:191], v113
    v_smfmac_f32_16x16x64_bf16 v[52:55], v[28:31], v[248:255], v113
    v_max3_f32 v108, v32, v33, v34
    v_max3_f32 v109, v35, v36, v37
    v_max3_f32 v108, v108, v38, v39
    v_max3_f32 v109, v109, v40, v41
    v_max_f32 v110, v108, v109
    v_max_f32 v111, v108, v109
    ds_read_b128 v[16:19], v119 offset:2048
    ds_read_b128 v[20:23], v119 offset:3072
    v_permlane32_swap_b32 v110, v111
    v_max_f32 v108, v110, v111
    v_max_f32 v109, v110, v111
    ds_read_b128 v[24:27], v119 offset:18432
    ds_read_b128 v[28:31], v119 offset:19456
    v_permlane16_swap_b32 v108, v109
    v_max_f32 v108, v108, v109
    v_mul_f32 v108, s40, v108
    v_pk_fma_f32 v[40:41], v[40:41], s[40:41], v[108:109] op_sel_hi:[1,1,0] neg_lo:[0,0,1] neg_hi:[0,0,1]
    v_pk_fma_f32 v[32:33], v[32:33], s[40:41], v[108:109] op_sel_hi:[1,1,0] neg_lo:[0,0,1] neg_hi:[0,0,1]
    v_pk_fma_f32 v[34:35], v[34:35], s[40:41], v[108:109] op_sel_hi:[1,1,0] neg_lo:[0,0,1] neg_hi:[0,0,1]
    v_pk_fma_f32 v[36:37], v[36:37], s[40:41], v[108:109] op_sel_hi:[1,1,0] neg_lo:[0,0,1] neg_hi:[0,0,1]
    v_pk_fma_f32 v[38:39], v[38:39], s[40:41], v[108:109] op_sel_hi:[1,1,0] neg_lo:[0,0,1] neg_hi:[0,0,1]
    v_exp_f32 v40, v40
    v_exp_f32 v41, v41
    v_exp_f32 v32, v32
    v_exp_f32 v33, v33
    v_exp_f32 v34, v34
    v_exp_f32 v35, v35
    v_exp_f32 v36, v36
    v_exp_f32 v37, v37
    v_exp_f32 v38, v38
    v_exp_f32 v39, v39
    v_cvt_pk_bf16_f32 v124, v40, v41
    v_cvt_pk_bf16_f32 v127, v40, v41
    v_pk_add_f32 v[48:49], v[48:49], v[50:51]
    v_pk_add_f32 v[52:53], v[52:53], v[54:55]
    v_cvt_pk_bf16_f32 v108, v32, v33
    v_cvt_pk_bf16_f32 v109, v34, v35
    v_cvt_pk_bf16_f32 v110, v36, v37
    v_cvt_pk_bf16_f32 v111, v38, v39
    v_cvt_pk_bf16_f32 v106, v48, v49
    v_cvt_pk_bf16_f32 v107, v52, v53
    s_waitcnt lgkmcnt(8)
    v_mfma_f32_16x16x16_bf16 v[52:55], v[44:45], v[124:125], 0
    v_mfma_f32_16x16x32_bf16 v[52:55], v[44:47], v[108:111], v[52:55]
    s_lshr_b32 s27, s25, 1
    s_lshl_b32 s27, s27, 10
    v_mov_b64 v[48:49], 0
    v_mfma_f32_16x16x32_bf16 v[96:99], v[56:59], v[108:111], 0
    s_cmp_ge_u32 s26, 61
    s_cbranch_scc1 L_pub_data
L_pub_data_ok:
    v_mfma_f32_16x16x32_bf16 v[100:103], v[60:63], v[108:111], 0
    v_add_u32 v50, s27, v112
    v_mfma_f32_16x16x16_bf16 v[96:99], v[106:107], v[124:125], v[96:99]
    v_mfma_f32_16x16x16_bf16 v[100:103], v[106:107], v[126:127], v[100:103]
    v_rcp_f32 v52, v52
    s_nop 6
    v_pk_mul_f32 v[96:97], v[96:97], v[52:53] op_sel_hi:[1,0]
    v_pk_mul_f32 v[98:99], v[98:99], v[52:53] op_sel_hi:[1,0]
    v_pk_mul_f32 v[100:101], v[100:101], v[52:53] op_sel_hi:[1,0]
    v_pk_mul_f32 v[102:103], v[102:103], v[52:53] op_sel_hi:[1,0]
    v_cvt_pk_bf16_f32 v108, v96, v97
    v_cvt_pk_bf16_f32 v109, v98, v99
    v_cvt_pk_bf16_f32 v110, v100, v101
    v_cvt_pk_bf16_f32 v111, v102, v103
    s_mov_b64 exec, s[48:49]
    ds_write_b128 v50, v[108:111] offset:24576
    s_mov_b64 exec, -1
    v_mfma_f32_32x32x8_bf16 v[64:79], v[48:49], v[48:49], 0
    ds_read_b128 v[32:35], v119 offset:20480
    ds_read_b128 v[36:39], v119 offset:21504
    v_mfma_f32_32x32x8_bf16 v[80:95], v[48:49], v[48:49], 0
    s_waitcnt lgkmcnt(2)
    s_barrier
    ds_read_b128 v[56:59], v112 offset:24576
    ds_read_b128 v[60:63], v112 offset:25600
    ds_read_b128 v[44:47], v119 offset:4096
    ds_read_b128 v[48:51], v119 offset:5120
    ds_read_b128 v[96:99], v119 offset:6144
    ds_read_b128 v[100:103], v119 offset:7168
    s_waitcnt lgkmcnt(4)
    v_smfmac_f32_16x16x64_bf16 v[64:67], v[56:59], v[0:7], v113
    ds_read_b128 v[0:3], v119 offset:22528
    ds_read_b128 v[4:7], v119 offset:23552
    v_smfmac_f32_16x16x64_bf16 v[64:67], v[60:63], v[8:15], v113
    ds_read_b128 v[8:11], v119 offset:8192
    ds_read_b128 v[12:15], v119 offset:9216
    v_smfmac_f32_16x16x64_bf16 v[68:71], v[56:59], v[16:23], v113
    ds_read_b128 v[16:19], v119 offset:24576
    ds_read_b128 v[20:23], v119 offset:25600
    v_smfmac_f32_16x16x64_bf16 v[68:71], v[60:63], v[24:31], v113
    ds_read_b128 v[24:27], v119 offset:10240
    ds_read_b128 v[28:31], v119 offset:11264
    v_pk_add_f32 v[64:65], v[64:65], v[66:67]
    s_waitcnt lgkmcnt(10)
    v_smfmac_f32_16x16x64_bf16 v[72:75], v[56:59], v[44:51], v113
    ds_read_b128 v[44:47], v119 offset:26624
    ds_read_b128 v[48:51], v119 offset:27648
    v_cvt_pk_bf16_f32 v64, v64, v65
    v_smfmac_f32_16x16x64_bf16 v[72:75], v[60:63], v[32:39], v113
    ds_read_b128 v[32:35], v119 offset:12288
    ds_read_b128 v[36:39], v119 offset:13312
    v_and_or_b32 v64, v64, -2, s46
    s_waitcnt lgkmcnt(10)
    v_smfmac_f32_16x16x64_bf16 v[76:79], v[56:59], v[96:103], v113
    ds_read_b128 v[96:99], v119 offset:28672
    ds_read_b128 v[100:103], v119 offset:29696
    v_pk_add_f32 v[68:69], v[68:69], v[70:71]
    v_smfmac_f32_16x16x64_bf16 v[76:79], v[60:63], v[0:7], v113
    ds_read_b128 v[0:3], v119 offset:14336
    ds_read_b128 v[4:7], v119 offset:15360
    v_cvt_pk_bf16_f32 v65, v68, v69
    s_waitcnt lgkmcnt(10)
    v_smfmac_f32_16x16x64_bf16 v[80:83], v[56:59], v[8:15], v113
    ds_read_b128 v[8:11], v119 offset:30720
    ds_read_b128 v[12:15], v119 offset:31744
    v_pk_add_f32 v[72:73], v[72:73], v[74:75]
    v_smfmac_f32_16x16x64_bf16 v[80:83], v[60:63], v[16:23], v113
    v_cvt_pk_bf16_f32 v66, v72, v73
    s_waitcnt lgkmcnt(8)
    v_smfmac_f32_16x16x64_bf16 v[84:87], v[56:59], v[24:31], v113
    v_pk_add_f32 v[76:77], v[76:77], v[78:79]
    v_smfmac_f32_16x16x64_bf16 v[84:87], v[60:63], v[44:51], v113
    v_cvt_pk_bf16_f32 v67, v76, v77
    s_waitcnt lgkmcnt(4)
    v_smfmac_f32_16x16x64_bf16 v[88:91], v[56:59], v[32:39], v113
    buffer_store_dwordx4 v[64:67], v120, s[20:23], s54 offen
    s_add_u32 s54, s54, 0x8000
    v_pk_add_f32 v[80:81], v[80:81], v[82:83]
    v_smfmac_f32_16x16x64_bf16 v[88:91], v[60:63], v[96:103], v113
    v_cvt_pk_bf16_f32 v80, v80, v81
    s_waitcnt lgkmcnt(0)
    v_smfmac_f32_16x16x64_bf16 v[92:95], v[56:59], v[0:7], v113
    v_and_or_b32 v80, v80, -2, s46
    v_smfmac_f32_16x16x64_bf16 v[92:95], v[60:63], v[8:15], v113
    v_pk_add_f32 v[84:85], v[84:85], v[86:87]
    v_cvt_pk_bf16_f32 v81, v84, v85
    v_pk_add_f32 v[88:89], v[88:89], v[90:91]
    v_cvt_pk_bf16_f32 v82, v88, v89
    v_mov_b64 v[32:33], 0
    v_mov_b64 v[34:35], 0
    v_mov_b64 v[36:37], 0
    v_mov_b64 v[38:39], 0
    v_mov_b64 v[40:41], 0
    v_pk_add_f32 v[92:93], v[92:93], v[94:95]
    v_cvt_pk_bf16_f32 v83, v92, v93
    buffer_store_dwordx4 v[80:83], v120, s[20:23], s54 offen
    v_mov_b64 v[42:43], 0
    v_mov_b64 v[44:45], 0
    v_mov_b64 v[46:47], 0
    v_mov_b64 v[48:49], 0
    v_mov_b64 v[50:51], 0
    v_mov_b64 v[52:53], 0
    v_mov_b64 v[54:55], 0
    v_add_u32 v88, s47, v112
    v_add_u32 v89, s96, v112
    v_add_u32 v90, s97, v112
    v_add_u32 v91, s98, v112
    v_and_b32 v28, 16, v112
    v_bfe_u32 v29, v112, 5, 3
    v_lshlrev_b32_e64 v28, v28, s42
    v_cmp_eq_u32 s[28:29], 0, v29
    v_cmp_eq_u32 s[30:31], 1, v29
    v_cmp_eq_u32 s[32:33], 2, v29
    v_cmp_eq_u32 s[34:35], 3, v29
    v_cndmask_b32 v24, 0, v28, s[28:29]
    v_cndmask_b32 v25, 0, v28, s[30:31]
    v_cndmask_b32 v26, 0, v28, s[32:33]
    v_cndmask_b32 v27, 0, v28, s[34:35]
    s_sleep 3
    buffer_load_dwordx4 v[0:3], v112, s[20:23], s55 offen sc1
    buffer_load_dwordx4 v[4:7], v112, s[20:23], s55 offen offset:1024 sc1
    s_sleep 2
    s_mov_b32 s45, 0
    buffer_load_dwordx4 v[16:19], v112, s[20:23], s55 offen sc1
    buffer_load_dwordx4 v[20:23], v112, s[20:23], s55 offen offset:1024 sc1
L_poll1:
    s_waitcnt vmcnt(2)
    v_bitop3_b32 v108, v0, v4, s46 bitop3:0x7e
    v_and_b32 v108, 1, v108
    v_cmp_ne_u32 vcc, 0, v108
    s_cbranch_vccz L_h1_A
    buffer_load_dwordx4 v[0:3], v112, s[20:23], s55 offen sc1
    buffer_load_dwordx4 v[4:7], v112, s[20:23], s55 offen offset:1024 sc1
    s_waitcnt vmcnt(2)
    v_bitop3_b32 v108, v16, v20, s46 bitop3:0x7e
    v_and_b32 v108, 1, v108
    v_cmp_ne_u32 vcc, 0, v108
    s_cbranch_vccz L_h1_B
    buffer_load_dwordx4 v[16:19], v112, s[20:23], s55 offen sc1
    buffer_load_dwordx4 v[20:23], v112, s[20:23], s55 offen offset:1024 sc1
    s_add_u32 s45, s45, 1
    s_cmp_gt_u32 s45, 1000000
    s_cbranch_scc0 L_poll1
    s_branch L_fail
L_h1_B:
    v_mfma_f32_16x16x32_bf16 v[8:11], v[24:27], v[16:19], 0
    v_mfma_f32_16x16x32_bf16 v[8:11], v[24:27], v[20:23], v[8:11]
    s_nop 2
    s_branch L_h1_join
L_h1_A:
    v_mfma_f32_16x16x32_bf16 v[8:11], v[24:27], v[0:3], 0
    v_mfma_f32_16x16x32_bf16 v[8:11], v[24:27], v[4:7], v[8:11]
    s_nop 3
L_h1_join:
    v_mov_b32 v12, -1
    s_xor_b32 s52, s52, 0x2000
    s_nop 1
    v_add_f32_dpp v8, v8, v8 row_ror:8 row_mask:0xf bank_mask:0xf
    v_add_f32_dpp v9, v9, v9 row_ror:8 row_mask:0xf bank_mask:0xf
    v_add_f32_dpp v10, v10, v10 row_ror:8 row_mask:0xf bank_mask:0xf
    v_add_f32_dpp v11, v11, v11 row_ror:8 row_mask:0xf bank_mask:0xf
    v_add_f32_dpp v8, v8, v8 row_ror:4 row_mask:0xf bank_mask:0xf
    v_add_f32_dpp v9, v9, v9 row_ror:4 row_mask:0xf bank_mask:0xf
    v_add_f32_dpp v10, v10, v10 row_ror:4 row_mask:0xf bank_mask:0xf
    v_add_f32_dpp v11, v11, v11 row_ror:4 row_mask:0xf bank_mask:0xf
    v_cvt_pk_bf16_f32 v13, v8, v10
    v_cvt_pk_bf16_f32 v14, v9, v11
    v_cndmask_b32 v13, v13, v14, s[38:39]
    s_mov_b64 exec, s[50:51]
    buffer_store_dword v13, v121, s[20:23], s57 offen
    buffer_store_dword v12, v121, s[20:23], s58 offen
    s_mov_b64 exec, -1
    s_mov_b32 m0, s93
    s_add_u32 s33, s91, 4096
    buffer_load_dwordx4 v123, s[20:23], s91 offen lds
    s_add_u32 m0, s93, 1024
    s_nop 0
    buffer_load_dwordx4 v123, s[20:23], s33 offen lds
    s_xor_b32 s57, s57, 0x2000
    s_xor_b32 s58, s58, 0x2000
    s_xor_b32 s55, s55, 0x40000
    s_xor_b32 s95, s95, 0x40000
    s_add_u32 s26, s26, 1
    s_lshr_b32 s27, s26, 1
    s_and_b32 s27, s27, 1
    s_xor_b32 s46, s27, 1
    s_branch L_step
L_pub_data:
    buffer_store_dwordx4 v[104:107], v112, s[20:23], s59 offen sc1
    s_branch L_pub_data_ok
L_pub_flag:
    s_mov_b64 exec, 1
    buffer_store_dword v113, v125, s[20:23], s100 offen sc1
    s_mov_b64 exec, -1
    s_branch L_pub_flag_ok
L_fkv_slow:
    s_cmp_ge_u32 s26, 63
    s_cbranch_scc1 L_fkv_ok
    s_mov_b32 s45, 0
L_fkv_loop:
    v_lshrrev_b32 v111, 2, v112
    buffer_load_dword v116, v111, s[20:23], s99 offen sc1
    s_add_u32 s45, s45, 1
    s_cmp_gt_u32 s45, 2000000
    s_cbranch_scc1 L_fail
    s_waitcnt vmcnt(0)
    v_cmp_eq_u32 vcc, 0, v116
    s_and_b32 vcc_lo, vcc_lo, 3
    s_cbranch_scc1 L_fkv_loop
    s_branch L_fkv_ok
L_last:
    v_smfmac_f32_16x16x64_bf16 v[48:51], v[4:7], v[136:143], v113
    v_smfmac_f32_16x16x64_bf16 v[52:55], v[4:7], v[200:207], v113
    v_smfmac_f32_16x16x64_bf16 v[48:51], v[8:11], v[144:151], v113
    v_smfmac_f32_16x16x64_bf16 v[52:55], v[8:11], v[208:215], v113
    v_smfmac_f32_16x16x64_bf16 v[48:51], v[12:15], v[152:159], v113
    v_smfmac_f32_16x16x64_bf16 v[52:55], v[12:15], v[216:223], v113
    v_smfmac_f32_16x16x64_bf16 v[48:51], v[16:19], v[160:167], v113
    v_smfmac_f32_16x16x64_bf16 v[52:55], v[16:19], v[224:231], v113
    v_smfmac_f32_16x16x64_bf16 v[48:51], v[20:23], v[168:175], v113
    v_smfmac_f32_16x16x64_bf16 v[52:55], v[20:23], v[232:239], v113
    v_smfmac_f32_16x16x64_bf16 v[48:51], v[24:27], v[176:183], v113
    v_smfmac_f32_16x16x64_bf16 v[52:55], v[24:27], v[240:247], v113
    v_smfmac_f32_16x16x64_bf16 v[48:51], v[28:31], v[184:191], v113
    v_smfmac_f32_16x16x64_bf16 v[52:55], v[28:31], v[248:255], v113
    s_nop 7
    v_pk_add_f32 v[48:49], v[48:49], v[50:51]
    v_pk_add_f32 v[52:53], v[52:53], v[54:55]
    v_cvt_pk_bf16_f32 v106, v48, v49
    v_cvt_pk_bf16_f32 v107, v52, v53
    buffer_store_dwordx4 v[104:107], v112, s[20:23], s59 offen sc1
    s_waitcnt vmcnt(0)
    s_mov_b64 exec, 1
    buffer_store_dword v113, v125, s[20:23], s100 offen sc1
    s_add_u32 s100, s100, 2048
    buffer_store_dword v113, v125, s[20:23], s100 offen sc1
    s_mov_b64 exec, -1
    s_waitcnt vmcnt(0)
    s_branch L_exit
L_fail:
    s_mov_b64 exec, -1
    s_load_dwordx2 s[36:37], s[0:1], 88
    s_waitcnt vmcnt(0) lgkmcnt(0)
    v_mov_b32 v1, 0
    v_mov_b32 v2, 0xdead
    global_store_dword v1, v2, s[36:37] offset:252
    s_waitcnt vmcnt(0)
    s_branch L_exit
L_worker:
    s_mov_b32 s62, s24
    s_load_dwordx2 s[20:21], s[0:1], 96
    v_lshrrev_b32 v1, 6, v0
    v_and_b32 v2, 63, v0
    v_readfirstlane_b32 s25, v1
    s_waitcnt lgkmcnt(0)
    s_mov_b32 s22, 0x10000000
    s_mov_b32 s23, 0x00020000
    s_mov_b32 s58, -1
    s_sub_u32 s27, s62, 32
    s_cmp_lt_u32 s27, 32
    s_cselect_b32 s28, 1, 0
    s_add_u32 s27, s27, 0
    s_cmp_eq_u32 s28, 1
    s_cselect_b32 s58, s27, s58
    s_sub_u32 s27, s62, 64
    s_cmp_lt_u32 s27, 64
    s_cselect_b32 s28, 1, 0
    s_add_u32 s27, s27, 32
    s_cmp_eq_u32 s28, 1
    s_cselect_b32 s58, s27, s58
    s_sub_u32 s27, s62, 128
    s_cmp_lt_u32 s27, 16
    s_cselect_b32 s28, 1, 0
    s_add_u32 s27, s27, 96
    s_cmp_eq_u32 s28, 1
    s_cselect_b32 s58, s27, s58
    s_sub_u32 s27, s62, 144
    s_cmp_lt_u32 s27, 16
    s_cselect_b32 s28, 1, 0
    s_add_u32 s27, s27, 112
    s_cmp_eq_u32 s28, 1
    s_cselect_b32 s58, s27, s58
    s_cmp_ge_u32 s58, 128
    s_cbranch_scc1 LI_done
    s_load_dwordx2 s[4:5], s[0:1], 0
    s_load_dwordx2 s[8:9], s[0:1], 8
    s_load_dwordx2 s[36:37], s[0:1], 88
    s_waitcnt lgkmcnt(0)
    s_mov_b32 s6, 0x200000
    s_mov_b32 s7, 0x00020000
    s_mov_b32 s10, 0x2000
    s_mov_b32 s11, 0x00020000
    v_lshlrev_b32 v3, 4, v2
    v_lshlrev_b32 v4, 4, v0
    s_lshl_b32 s39, s58, 4
    s_lshl_b32 s28, s25, 2
    s_add_u32 s39, s39, s28
    s_lshl_b32 s39, s39, 10
    buffer_load_dwordx4 v[8:11], v3, s[4:7], s39 offen offset:0
    buffer_load_dwordx4 v[12:15], v3, s[4:7], s39 offen offset:1024
    buffer_load_dwordx4 v[16:19], v3, s[4:7], s39 offen offset:2048
    buffer_load_dwordx4 v[20:23], v3, s[4:7], s39 offen offset:3072
    s_cmp_ge_u32 s58, 64
    s_cbranch_scc1 LI_ln
    s_mov_b32 s27, s58
    v_mov_b32 v24, 0
    v_mov_b32 v25, 0
    v_mov_b32 v26, 0
    v_mov_b32 v27, 0
    v_mov_b32 v28, -1
    v_mov_b32 v29, -1
    v_mov_b32 v30, -1
    v_mov_b32 v31, -1
    s_lshl_b32 s28, s27, 13
    s_add_u32 s29, s28, 0x500000
    buffer_store_dwordx4 v[24:27], v4, s[20:23], s29 offen sc1
    s_add_u32 s29, s29, 4096
    buffer_store_dwordx4 v[24:27], v4, s[20:23], s29 offen sc1
    s_lshl_b32 s28, s27, 11
    s_add_u32 s29, s28, 0x410000
    s_cmp_ge_u32 s25, 2
    s_cbranch_scc1 LI_nf
    buffer_store_dwordx4 v[24:27], v4, s[20:23], s29 offen sc1
LI_nf:
    s_cmp_lg_u32 s27, 0
    s_cbranch_scc1 LI_nopz
    s_mov_b32 s29, 0x402000
    buffer_store_dwordx4 v[28:31], v4, s[20:23], s29 offen sc1
    s_mov_b32 s29, 0x403000
    buffer_store_dwordx4 v[28:31], v4, s[20:23], s29 offen sc1
LI_nopz:
    s_cmp_lg_u32 s27, 1
    s_cbranch_scc1 LI_sig1
    v_and_b32 v5, 15, v0
    v_lshrrev_b32 v6, 2, v5
    v_lshlrev_b32 v6, 1, v6
    v_and_b32 v7, 1, v5
    v_add_u32 v6, v6, v7
    v_lshlrev_b32 v6, 10, v6
    v_bfe_u32 v7, v5, 1, 1
    v_lshl_add_u32 v6, v7, 6, v6
    v_bfe_u32 v7, v0, 4, 2
    v_lshl_add_u32 v6, v7, 3, v6
    v_lshrrev_b32 v7, 6, v0
    v_lshl_add_u32 v6, v7, 7, v6
    buffer_load_dwordx2 v[32:33], v6, s[8:11], 0 offen
    buffer_load_dwordx2 v[34:35], v6, s[8:11], 0 offen offset:32
    buffer_load_dwordx2 v[36:37], v6, s[8:11], 0 offen offset:512
    buffer_load_dwordx2 v[38:39], v6, s[8:11], 0 offen offset:544
    s_mov_b32 s28, 0x05040100
    s_mov_b32 s29, 0x07060302
    s_waitcnt vmcnt(0)
    v_perm_b32 v40, v34, v32, s28
    v_perm_b32 v41, v34, v32, s29
    v_perm_b32 v42, v35, v33, s28
    v_perm_b32 v43, v35, v33, s29
    v_perm_b32 v44, v38, v36, s28
    v_perm_b32 v45, v38, v36, s29
    v_perm_b32 v46, v39, v37, s28
    v_perm_b32 v47, v39, v37, s29
    s_mov_b32 s29, 0x400000
    buffer_store_dwordx4 v[40:43], v4, s[20:23], s29 offen sc1
    s_mov_b32 s29, 0x401000
    buffer_store_dwordx4 v[44:47], v4, s[20:23], s29 offen sc1
LI_sig1:
    s_waitcnt vmcnt(0)
    s_barrier
    s_cmp_lg_u32 s25, 0
    s_cbranch_scc1 LI_ln
    v_mov_b32 v5, 0
    v_mov_b32 v6, 1
    s_mov_b64 exec, 1
    global_atomic_add v5, v6, s[36:37] offset:40
    s_mov_b64 exec, -1
LI_ln:
    s_waitcnt vmcnt(0)
    s_add_u32 s39, s39, 0x0
    v_lshlrev_b32 v32, 16, v8
    v_and_b32 v33, 0xffff0000, v8
    v_lshlrev_b32 v34, 16, v9
    v_and_b32 v35, 0xffff0000, v9
    v_lshlrev_b32 v36, 16, v10
    v_and_b32 v37, 0xffff0000, v10
    v_lshlrev_b32 v38, 16, v11
    v_and_b32 v39, 0xffff0000, v11
    v_pk_add_f32 v[40:41], v[32:33], v[34:35]
    v_pk_add_f32 v[42:43], v[36:37], v[38:39]
    v_pk_add_f32 v[40:41], v[40:41], v[42:43]
    v_add_f32 v40, v40, v41
    s_nop 1
    v_add_f32_dpp v40, v40, v40 quad_perm:[1,0,3,2] row_mask:0xf bank_mask:0xf
    s_nop 1
    v_add_f32_dpp v40, v40, v40 quad_perm:[2,3,0,1] row_mask:0xf bank_mask:0xf
    s_nop 1
    v_add_f32_dpp v40, v40, v40 row_half_mirror row_mask:0xf bank_mask:0xf
    s_nop 1
    v_add_f32_dpp v40, v40, v40 row_mirror row_mask:0xf bank_mask:0xf
    v_mov_b32 v41, v40
    s_nop 1
    v_permlane16_swap_b32 v40, v41
    v_add_f32 v40, v40, v41
    v_mov_b32 v41, v40
    s_nop 1
    v_permlane32_swap_b32 v40, v41
    v_add_f32 v40, v40, v41
    v_mul_f32 v40, 0x3b000000, v40
    v_sub_f32 v44, v32, v40
    v_sub_f32 v45, v33, v40
    v_sub_f32 v46, v34, v40
    v_sub_f32 v47, v35, v40
    v_sub_f32 v48, v36, v40
    v_sub_f32 v49, v37, v40
    v_sub_f32 v50, v38, v40
    v_sub_f32 v51, v39, v40
    v_mul_f32 v42, v44, v44
    v_fmac_f32 v42, v45, v45
    v_fmac_f32 v42, v46, v46
    v_fmac_f32 v42, v47, v47
    v_fmac_f32 v42, v48, v48
    v_fmac_f32 v42, v49, v49
    v_fmac_f32 v42, v50, v50
    v_fmac_f32 v42, v51, v51
    s_nop 1
    v_add_f32_dpp v42, v42, v42 quad_perm:[1,0,3,2] row_mask:0xf bank_mask:0xf
    s_nop 1
    v_add_f32_dpp v42, v42, v42 quad_perm:[2,3,0,1] row_mask:0xf bank_mask:0xf
    s_nop 1
    v_add_f32_dpp v42, v42, v42 row_half_mirror row_mask:0xf bank_mask:0xf
    s_nop 1
    v_add_f32_dpp v42, v42, v42 row_mirror row_mask:0xf bank_mask:0xf
    v_mov_b32 v43, v42
    s_nop 1
    v_permlane16_swap_b32 v42, v43
    v_add_f32 v42, v42, v43
    v_mov_b32 v43, v42
    s_nop 1
    v_permlane32_swap_b32 v42, v43
    v_add_f32 v42, v42, v43
    v_mul_f32 v42, 0x3b000000, v42
    v_cvt_pk_bf16_f32 v42, v42, v42
    v_lshlrev_b32 v42, 16, v42
    v_add_f32 v42, 0x3727c5ac, v42
    v_cvt_pk_bf16_f32 v42, v42, v42
    v_lshlrev_b32 v42, 16, v42
    v_sqrt_f32 v42, v42
    s_nop 0
    v_cvt_pk_bf16_f32 v42, v42, v42
    v_lshlrev_b32 v42, 16, v42
    v_rcp_f32 v42, v42
    v_cvt_pk_bf16_f32 v40, v40, v40
    v_lshlrev_b32 v40, 16, v40
    v_sub_f32 v44, v32, v40
    v_sub_f32 v45, v33, v40
    v_sub_f32 v46, v34, v40
    v_sub_f32 v47, v35, v40
    v_sub_f32 v48, v36, v40
    v_sub_f32 v49, v37, v40
    v_sub_f32 v50, v38, v40
    v_sub_f32 v51, v39, v40
    v_cvt_pk_bf16_f32 v41, v44, v45
    v_lshlrev_b32 v44, 16, v41
    v_and_b32 v45, 0xffff0000, v41
    v_cvt_pk_bf16_f32 v41, v46, v47
    v_lshlrev_b32 v46, 16, v41
    v_and_b32 v47, 0xffff0000, v41
    v_cvt_pk_bf16_f32 v41, v48, v49
    v_lshlrev_b32 v48, 16, v41
    v_and_b32 v49, 0xffff0000, v41
    v_cvt_pk_bf16_f32 v41, v50, v51
    v_lshlrev_b32 v50, 16, v41
    v_and_b32 v51, 0xffff0000, v41
    v_mul_f32 v44, v44, v42
    v_mul_f32 v45, v45, v42
    v_mul_f32 v46, v46, v42
    v_mul_f32 v47, v47, v42
    v_mul_f32 v48, v48, v42
    v_mul_f32 v49, v49, v42
    v_mul_f32 v50, v50, v42
    v_mul_f32 v51, v51, v42
    v_cvt_pk_bf16_f32 v28, v44, v45
    v_cvt_pk_bf16_f32 v29, v46, v47
    v_cvt_pk_bf16_f32 v30, v48, v49
    v_cvt_pk_bf16_f32 v31, v50, v51
    buffer_store_dwordx4 v[28:31], v3, s[20:23], s39 offen offset:0 sc1
    s_nop 1
    v_lshlrev_b32 v32, 16, v12
    v_and_b32 v33, 0xffff0000, v12
    v_lshlrev_b32 v34, 16, v13
    v_and_b32 v35, 0xffff0000, v13
    v_lshlrev_b32 v36, 16, v14
    v_and_b32 v37, 0xffff0000, v14
    v_lshlrev_b32 v38, 16, v15
    v_and_b32 v39, 0xffff0000, v15
    v_pk_add_f32 v[40:41], v[32:33], v[34:35]
    v_pk_add_f32 v[42:43], v[36:37], v[38:39]
    v_pk_add_f32 v[40:41], v[40:41], v[42:43]
    v_add_f32 v40, v40, v41
    s_nop 1
    v_add_f32_dpp v40, v40, v40 quad_perm:[1,0,3,2] row_mask:0xf bank_mask:0xf
    s_nop 1
    v_add_f32_dpp v40, v40, v40 quad_perm:[2,3,0,1] row_mask:0xf bank_mask:0xf
    s_nop 1
    v_add_f32_dpp v40, v40, v40 row_half_mirror row_mask:0xf bank_mask:0xf
    s_nop 1
    v_add_f32_dpp v40, v40, v40 row_mirror row_mask:0xf bank_mask:0xf
    v_mov_b32 v41, v40
    s_nop 1
    v_permlane16_swap_b32 v40, v41
    v_add_f32 v40, v40, v41
    v_mov_b32 v41, v40
    s_nop 1
    v_permlane32_swap_b32 v40, v41
    v_add_f32 v40, v40, v41
    v_mul_f32 v40, 0x3b000000, v40
    v_sub_f32 v44, v32, v40
    v_sub_f32 v45, v33, v40
    v_sub_f32 v46, v34, v40
    v_sub_f32 v47, v35, v40
    v_sub_f32 v48, v36, v40
    v_sub_f32 v49, v37, v40
    v_sub_f32 v50, v38, v40
    v_sub_f32 v51, v39, v40
    v_mul_f32 v42, v44, v44
    v_fmac_f32 v42, v45, v45
    v_fmac_f32 v42, v46, v46
    v_fmac_f32 v42, v47, v47
    v_fmac_f32 v42, v48, v48
    v_fmac_f32 v42, v49, v49
    v_fmac_f32 v42, v50, v50
    v_fmac_f32 v42, v51, v51
    s_nop 1
    v_add_f32_dpp v42, v42, v42 quad_perm:[1,0,3,2] row_mask:0xf bank_mask:0xf
    s_nop 1
    v_add_f32_dpp v42, v42, v42 quad_perm:[2,3,0,1] row_mask:0xf bank_mask:0xf
    s_nop 1
    v_add_f32_dpp v42, v42, v42 row_half_mirror row_mask:0xf bank_mask:0xf
    s_nop 1
    v_add_f32_dpp v42, v42, v42 row_mirror row_mask:0xf bank_mask:0xf
    v_mov_b32 v43, v42
    s_nop 1
    v_permlane16_swap_b32 v42, v43
    v_add_f32 v42, v42, v43
    v_mov_b32 v43, v42
    s_nop 1
    v_permlane32_swap_b32 v42, v43
    v_add_f32 v42, v42, v43
    v_mul_f32 v42, 0x3b000000, v42
    v_cvt_pk_bf16_f32 v42, v42, v42
    v_lshlrev_b32 v42, 16, v42
    v_add_f32 v42, 0x3727c5ac, v42
    v_cvt_pk_bf16_f32 v42, v42, v42
    v_lshlrev_b32 v42, 16, v42
    v_sqrt_f32 v42, v42
    s_nop 0
    v_cvt_pk_bf16_f32 v42, v42, v42
    v_lshlrev_b32 v42, 16, v42
    v_rcp_f32 v42, v42
    v_cvt_pk_bf16_f32 v40, v40, v40
    v_lshlrev_b32 v40, 16, v40
    v_sub_f32 v44, v32, v40
    v_sub_f32 v45, v33, v40
    v_sub_f32 v46, v34, v40
    v_sub_f32 v47, v35, v40
    v_sub_f32 v48, v36, v40
    v_sub_f32 v49, v37, v40
    v_sub_f32 v50, v38, v40
    v_sub_f32 v51, v39, v40
    v_cvt_pk_bf16_f32 v41, v44, v45
    v_lshlrev_b32 v44, 16, v41
    v_and_b32 v45, 0xffff0000, v41
    v_cvt_pk_bf16_f32 v41, v46, v47
    v_lshlrev_b32 v46, 16, v41
    v_and_b32 v47, 0xffff0000, v41
    v_cvt_pk_bf16_f32 v41, v48, v49
    v_lshlrev_b32 v48, 16, v41
    v_and_b32 v49, 0xffff0000, v41
    v_cvt_pk_bf16_f32 v41, v50, v51
    v_lshlrev_b32 v50, 16, v41
    v_and_b32 v51, 0xffff0000, v41
    v_mul_f32 v44, v44, v42
    v_mul_f32 v45, v45, v42
    v_mul_f32 v46, v46, v42
    v_mul_f32 v47, v47, v42
    v_mul_f32 v48, v48, v42
    v_mul_f32 v49, v49, v42
    v_mul_f32 v50, v50, v42
    v_mul_f32 v51, v51, v42
    v_cvt_pk_bf16_f32 v28, v44, v45
    v_cvt_pk_bf16_f32 v29, v46, v47
    v_cvt_pk_bf16_f32 v30, v48, v49
    v_cvt_pk_bf16_f32 v31, v50, v51
    buffer_store_dwordx4 v[28:31], v3, s[20:23], s39 offen offset:1024 sc1
    s_nop 1
    v_lshlrev_b32 v32, 16, v16
    v_and_b32 v33, 0xffff0000, v16
    v_lshlrev_b32 v34, 16, v17
    v_and_b32 v35, 0xffff0000, v17
    v_lshlrev_b32 v36, 16, v18
    v_and_b32 v37, 0xffff0000, v18
    v_lshlrev_b32 v38, 16, v19
    v_and_b32 v39, 0xffff0000, v19
    v_pk_add_f32 v[40:41], v[32:33], v[34:35]
    v_pk_add_f32 v[42:43], v[36:37], v[38:39]
    v_pk_add_f32 v[40:41], v[40:41], v[42:43]
    v_add_f32 v40, v40, v41
    s_nop 1
    v_add_f32_dpp v40, v40, v40 quad_perm:[1,0,3,2] row_mask:0xf bank_mask:0xf
    s_nop 1
    v_add_f32_dpp v40, v40, v40 quad_perm:[2,3,0,1] row_mask:0xf bank_mask:0xf
    s_nop 1
    v_add_f32_dpp v40, v40, v40 row_half_mirror row_mask:0xf bank_mask:0xf
    s_nop 1
    v_add_f32_dpp v40, v40, v40 row_mirror row_mask:0xf bank_mask:0xf
    v_mov_b32 v41, v40
    s_nop 1
    v_permlane16_swap_b32 v40, v41
    v_add_f32 v40, v40, v41
    v_mov_b32 v41, v40
    s_nop 1
    v_permlane32_swap_b32 v40, v41
    v_add_f32 v40, v40, v41
    v_mul_f32 v40, 0x3b000000, v40
    v_sub_f32 v44, v32, v40
    v_sub_f32 v45, v33, v40
    v_sub_f32 v46, v34, v40
    v_sub_f32 v47, v35, v40
    v_sub_f32 v48, v36, v40
    v_sub_f32 v49, v37, v40
    v_sub_f32 v50, v38, v40
    v_sub_f32 v51, v39, v40
    v_mul_f32 v42, v44, v44
    v_fmac_f32 v42, v45, v45
    v_fmac_f32 v42, v46, v46
    v_fmac_f32 v42, v47, v47
    v_fmac_f32 v42, v48, v48
    v_fmac_f32 v42, v49, v49
    v_fmac_f32 v42, v50, v50
    v_fmac_f32 v42, v51, v51
    s_nop 1
    v_add_f32_dpp v42, v42, v42 quad_perm:[1,0,3,2] row_mask:0xf bank_mask:0xf
    s_nop 1
    v_add_f32_dpp v42, v42, v42 quad_perm:[2,3,0,1] row_mask:0xf bank_mask:0xf
    s_nop 1
    v_add_f32_dpp v42, v42, v42 row_half_mirror row_mask:0xf bank_mask:0xf
    s_nop 1
    v_add_f32_dpp v42, v42, v42 row_mirror row_mask:0xf bank_mask:0xf
    v_mov_b32 v43, v42
    s_nop 1
    v_permlane16_swap_b32 v42, v43
    v_add_f32 v42, v42, v43
    v_mov_b32 v43, v42
    s_nop 1
    v_permlane32_swap_b32 v42, v43
    v_add_f32 v42, v42, v43
    v_mul_f32 v42, 0x3b000000, v42
    v_cvt_pk_bf16_f32 v42, v42, v42
    v_lshlrev_b32 v42, 16, v42
    v_add_f32 v42, 0x3727c5ac, v42
    v_cvt_pk_bf16_f32 v42, v42, v42
    v_lshlrev_b32 v42, 16, v42
    v_sqrt_f32 v42, v42
    s_nop 0
    v_cvt_pk_bf16_f32 v42, v42, v42
    v_lshlrev_b32 v42, 16, v42
    v_rcp_f32 v42, v42
    v_cvt_pk_bf16_f32 v40, v40, v40
    v_lshlrev_b32 v40, 16, v40
    v_sub_f32 v44, v32, v40
    v_sub_f32 v45, v33, v40
    v_sub_f32 v46, v34, v40
    v_sub_f32 v47, v35, v40
    v_sub_f32 v48, v36, v40
    v_sub_f32 v49, v37, v40
    v_sub_f32 v50, v38, v40
    v_sub_f32 v51, v39, v40
    v_cvt_pk_bf16_f32 v41, v44, v45
    v_lshlrev_b32 v44, 16, v41
    v_and_b32 v45, 0xffff0000, v41
    v_cvt_pk_bf16_f32 v41, v46, v47
    v_lshlrev_b32 v46, 16, v41
    v_and_b32 v47, 0xffff0000, v41
    v_cvt_pk_bf16_f32 v41, v48, v49
    v_lshlrev_b32 v48, 16, v41
    v_and_b32 v49, 0xffff0000, v41
    v_cvt_pk_bf16_f32 v41, v50, v51
    v_lshlrev_b32 v50, 16, v41
    v_and_b32 v51, 0xffff0000, v41
    v_mul_f32 v44, v44, v42
    v_mul_f32 v45, v45, v42
    v_mul_f32 v46, v46, v42
    v_mul_f32 v47, v47, v42
    v_mul_f32 v48, v48, v42
    v_mul_f32 v49, v49, v42
    v_mul_f32 v50, v50, v42
    v_mul_f32 v51, v51, v42
    v_cvt_pk_bf16_f32 v28, v44, v45
    v_cvt_pk_bf16_f32 v29, v46, v47
    v_cvt_pk_bf16_f32 v30, v48, v49
    v_cvt_pk_bf16_f32 v31, v50, v51
    buffer_store_dwordx4 v[28:31], v3, s[20:23], s39 offen offset:2048 sc1
    s_nop 1
    v_lshlrev_b32 v32, 16, v20
    v_and_b32 v33, 0xffff0000, v20
    v_lshlrev_b32 v34, 16, v21
    v_and_b32 v35, 0xffff0000, v21
    v_lshlrev_b32 v36, 16, v22
    v_and_b32 v37, 0xffff0000, v22
    v_lshlrev_b32 v38, 16, v23
    v_and_b32 v39, 0xffff0000, v23
    v_pk_add_f32 v[40:41], v[32:33], v[34:35]
    v_pk_add_f32 v[42:43], v[36:37], v[38:39]
    v_pk_add_f32 v[40:41], v[40:41], v[42:43]
    v_add_f32 v40, v40, v41
    s_nop 1
    v_add_f32_dpp v40, v40, v40 quad_perm:[1,0,3,2] row_mask:0xf bank_mask:0xf
    s_nop 1
    v_add_f32_dpp v40, v40, v40 quad_perm:[2,3,0,1] row_mask:0xf bank_mask:0xf
    s_nop 1
    v_add_f32_dpp v40, v40, v40 row_half_mirror row_mask:0xf bank_mask:0xf
    s_nop 1
    v_add_f32_dpp v40, v40, v40 row_mirror row_mask:0xf bank_mask:0xf
    v_mov_b32 v41, v40
    s_nop 1
    v_permlane16_swap_b32 v40, v41
    v_add_f32 v40, v40, v41
    v_mov_b32 v41, v40
    s_nop 1
    v_permlane32_swap_b32 v40, v41
    v_add_f32 v40, v40, v41
    v_mul_f32 v40, 0x3b000000, v40
    v_sub_f32 v44, v32, v40
    v_sub_f32 v45, v33, v40
    v_sub_f32 v46, v34, v40
    v_sub_f32 v47, v35, v40
    v_sub_f32 v48, v36, v40
    v_sub_f32 v49, v37, v40
    v_sub_f32 v50, v38, v40
    v_sub_f32 v51, v39, v40
    v_mul_f32 v42, v44, v44
    v_fmac_f32 v42, v45, v45
    v_fmac_f32 v42, v46, v46
    v_fmac_f32 v42, v47, v47
    v_fmac_f32 v42, v48, v48
    v_fmac_f32 v42, v49, v49
    v_fmac_f32 v42, v50, v50
    v_fmac_f32 v42, v51, v51
    s_nop 1
    v_add_f32_dpp v42, v42, v42 quad_perm:[1,0,3,2] row_mask:0xf bank_mask:0xf
    s_nop 1
    v_add_f32_dpp v42, v42, v42 quad_perm:[2,3,0,1] row_mask:0xf bank_mask:0xf
    s_nop 1
    v_add_f32_dpp v42, v42, v42 row_half_mirror row_mask:0xf bank_mask:0xf
    s_nop 1
    v_add_f32_dpp v42, v42, v42 row_mirror row_mask:0xf bank_mask:0xf
    v_mov_b32 v43, v42
    s_nop 1
    v_permlane16_swap_b32 v42, v43
    v_add_f32 v42, v42, v43
    v_mov_b32 v43, v42
    s_nop 1
    v_permlane32_swap_b32 v42, v43
    v_add_f32 v42, v42, v43
    v_mul_f32 v42, 0x3b000000, v42
    v_cvt_pk_bf16_f32 v42, v42, v42
    v_lshlrev_b32 v42, 16, v42
    v_add_f32 v42, 0x3727c5ac, v42
    v_cvt_pk_bf16_f32 v42, v42, v42
    v_lshlrev_b32 v42, 16, v42
    v_sqrt_f32 v42, v42
    s_nop 0
    v_cvt_pk_bf16_f32 v42, v42, v42
    v_lshlrev_b32 v42, 16, v42
    v_rcp_f32 v42, v42
    v_cvt_pk_bf16_f32 v40, v40, v40
    v_lshlrev_b32 v40, 16, v40
    v_sub_f32 v44, v32, v40
    v_sub_f32 v45, v33, v40
    v_sub_f32 v46, v34, v40
    v_sub_f32 v47, v35, v40
    v_sub_f32 v48, v36, v40
    v_sub_f32 v49, v37, v40
    v_sub_f32 v50, v38, v40
    v_sub_f32 v51, v39, v40
    v_cvt_pk_bf16_f32 v41, v44, v45
    v_lshlrev_b32 v44, 16, v41
    v_and_b32 v45, 0xffff0000, v41
    v_cvt_pk_bf16_f32 v41, v46, v47
    v_lshlrev_b32 v46, 16, v41
    v_and_b32 v47, 0xffff0000, v41
    v_cvt_pk_bf16_f32 v41, v48, v49
    v_lshlrev_b32 v48, 16, v41
    v_and_b32 v49, 0xffff0000, v41
    v_cvt_pk_bf16_f32 v41, v50, v51
    v_lshlrev_b32 v50, 16, v41
    v_and_b32 v51, 0xffff0000, v41
    v_mul_f32 v44, v44, v42
    v_mul_f32 v45, v45, v42
    v_mul_f32 v46, v46, v42
    v_mul_f32 v47, v47, v42
    v_mul_f32 v48, v48, v42
    v_mul_f32 v49, v49, v42
    v_mul_f32 v50, v50, v42
    v_mul_f32 v51, v51, v42
    v_cvt_pk_bf16_f32 v28, v44, v45
    v_cvt_pk_bf16_f32 v29, v46, v47
    v_cvt_pk_bf16_f32 v30, v48, v49
    v_cvt_pk_bf16_f32 v31, v50, v51
    buffer_store_dwordx4 v[28:31], v3, s[20:23], s39 offen offset:3072 sc1
    s_nop 1
    s_waitcnt vmcnt(0)
    s_barrier
    s_cmp_lg_u32 s25, 0
    s_cbranch_scc1 LI_done
    s_lshr_b32 s27, s58, 5
    s_lshl_b32 s27, s27, 2
    s_add_u32 s27, s27, 48
    s_and_b32 s28, s58, 31
    s_lshl_b32 s28, 1, s28
    v_mov_b32 v5, s27
    v_mov_b32 v6, s28
    s_mov_b64 exec, 1
    global_atomic_or v5, v6, s[36:37]
    s_mov_b64 exec, -1
    s_waitcnt vmcnt(0)
LI_done:
    s_cmp_lt_u32 s62, 32
    s_cbranch_scc1 LR0
    s_cmp_lt_u32 s62, 64
    s_cbranch_scc1 LR1
    s_cmp_lt_u32 s62, 128
    s_cbranch_scc1 LR2
    s_cmp_lt_u32 s62, 144
    s_cbranch_scc1 LR3
    s_cmp_lt_u32 s62, 160
    s_cbranch_scc1 LR4
    s_cmp_lt_u32 s62, 176
    s_cbranch_scc1 LR5
    s_cmp_lt_u32 s62, 192
    s_cbranch_scc1 LR6
    s_cmp_lt_u32 s62, 220
    s_cbranch_scc1 LR7
    s_cmp_lt_u32 s62, 224
    s_cbranch_scc1 LR8
    s_branch L_exit
LR0:
    s_sub_u32 s63, s62, 0
LB_kv2:
    s_and_b32 s27, s63, 31
    s_lshr_b32 s26, s63, 5
    s_load_dwordx2 s[4:5], s[0:1], 24
    s_load_dwordx2 s[8:9], s[0:1], 32
    s_waitcnt lgkmcnt(0)
    s_lshl_b32 s40, s27, 8
    s_mov_b32 s41, s40
    s_lshl_b32 s29, s27, 13
    s_add_u32 s42, s29, 0x1000000
    s_add_u32 s43, s29, 0x2000000
    s_lshl_b32 s44, s27, 1
    s_add_u32 s45, s44, 1
    s_mov_b32 s6, 0x400000
    s_mov_b32 s7, 0x00020000
    s_mov_b32 s10, 0x400000
    s_mov_b32 s11, 0x00020000
    s_cmp_ge_u32 s26, 64
    s_cbranch_scc1 LR0_exit
    v_and_b32 v9, 15, v2
    v_lshrrev_b32 v10, 4, v2
    v_lshrrev_b32 v8, 1, v9
    v_lshlrev_b32 v11, 1, v10
    v_xor_b32 v8, v8, v11
    v_lshlrev_b32 v8, 5, v8
    s_mov_b32 s33, 8192
    v_mul_lo_u32 v11, v10, s33
    v_add_u32 v8, v8, v11
    v_and_b32 v11, 1, v2
    v_lshl_add_u32 v8, v11, 4, v8
    v_lshrrev_b32 v9, 5, v2
    v_bfe_u32 v10, v2, 2, 2
    v_lshl_add_u32 v9, v9, 3, v10
    v_lshlrev_b32 v9, 8, v9
    v_bfe_u32 v11, v2, 4, 1
    s_lshl_b32 s33, s25, 1
    v_add_u32 v11, s33, v11
    v_lshlrev_b32 v10, 1, v10
    v_xor_b32 v11, v11, v10
    v_lshl_add_u32 v9, v11, 5, v9
    v_and_b32 v11, 3, v2
    v_lshl_add_u32 v9, v11, 3, v9
    s_mul_i32 s30, s25, 131072
    s_lshl_b32 s29, s25, 12
    s_add_u32 m0, s29, 0
    s_add_u32 s33, s30, s40
    s_add_u32 s33, s33, 0
    buffer_load_dwordx4 v8, s[4:7], s33 offen lds
    s_add_u32 m0, s29, 1024
    s_add_u32 s33, s30, s40
    s_add_u32 s33, s33, 32768
    buffer_load_dwordx4 v8, s[4:7], s33 offen lds
    s_add_u32 m0, s29, 2048
    s_add_u32 s33, s30, s40
    s_add_u32 s33, s33, 65536
    buffer_load_dwordx4 v8, s[4:7], s33 offen lds
    s_add_u32 m0, s29, 3072
    s_add_u32 s33, s30, s40
    s_add_u32 s33, s33, 98304
    buffer_load_dwordx4 v8, s[4:7], s33 offen lds
    s_add_u32 m0, s29, 16384
    s_add_u32 s33, s30, s40
    s_add_u32 s33, s33, 524288
    buffer_load_dwordx4 v8, s[4:7], s33 offen lds
    s_add_u32 m0, s29, 17408
    s_add_u32 s33, s30, s40
    s_add_u32 s33, s33, 557056
    buffer_load_dwordx4 v8, s[4:7], s33 offen lds
    s_add_u32 m0, s29, 18432
    s_add_u32 s33, s30, s40
    s_add_u32 s33, s33, 589824
    buffer_load_dwordx4 v8, s[4:7], s33 offen lds
    s_add_u32 m0, s29, 19456
    s_add_u32 s33, s30, s40
    s_add_u32 s33, s33, 622592
    buffer_load_dwordx4 v8, s[4:7], s33 offen lds
    s_add_u32 m0, s29, 32768
    s_add_u32 s33, s30, s40
    s_add_u32 s33, s33, 1048576
    buffer_load_dwordx4 v8, s[4:7], s33 offen lds
    s_add_u32 m0, s29, 33792
    s_add_u32 s33, s30, s40
    s_add_u32 s33, s33, 1081344
    buffer_load_dwordx4 v8, s[4:7], s33 offen lds
    s_add_u32 m0, s29, 34816
    s_add_u32 s33, s30, s40
    s_add_u32 s33, s33, 1114112
    buffer_load_dwordx4 v8, s[4:7], s33 offen lds
    s_add_u32 m0, s29, 35840
    s_add_u32 s33, s30, s40
    s_add_u32 s33, s33, 1146880
    buffer_load_dwordx4 v8, s[4:7], s33 offen lds
    s_add_u32 m0, s29, 49152
    s_add_u32 s33, s30, s40
    s_add_u32 s33, s33, 1572864
    buffer_load_dwordx4 v8, s[4:7], s33 offen lds
    s_add_u32 m0, s29, 50176
    s_add_u32 s33, s30, s40
    s_add_u32 s33, s33, 1605632
    buffer_load_dwordx4 v8, s[4:7], s33 offen lds
    s_add_u32 m0, s29, 51200
    s_add_u32 s33, s30, s40
    s_add_u32 s33, s33, 1638400
    buffer_load_dwordx4 v8, s[4:7], s33 offen lds
    s_add_u32 m0, s29, 52224
    s_add_u32 s33, s30, s40
    s_add_u32 s33, s33, 1671168
    buffer_load_dwordx4 v8, s[4:7], s33 offen lds
    s_add_u32 m0, s29, 65536
    s_add_u32 s33, s30, s40
    s_add_u32 s33, s33, 2097152
    buffer_load_dwordx4 v8, s[4:7], s33 offen lds
    s_add_u32 m0, s29, 66560
    s_add_u32 s33, s30, s40
    s_add_u32 s33, s33, 2129920
    buffer_load_dwordx4 v8, s[4:7], s33 offen lds
    s_add_u32 m0, s29, 67584
    s_add_u32 s33, s30, s40
    s_add_u32 s33, s33, 2162688
    buffer_load_dwordx4 v8, s[4:7], s33 offen lds
    s_add_u32 m0, s29, 68608
    s_add_u32 s33, s30, s40
    s_add_u32 s33, s33, 2195456
    buffer_load_dwordx4 v8, s[4:7], s33 offen lds
    s_add_u32 m0, s29, 81920
    s_add_u32 s33, s30, s40
    s_add_u32 s33, s33, 2621440
    buffer_load_dwordx4 v8, s[4:7], s33 offen lds
    s_add_u32 m0, s29, 82944
    s_add_u32 s33, s30, s40
    s_add_u32 s33, s33, 2654208
    buffer_load_dwordx4 v8, s[4:7], s33 offen lds
    s_add_u32 m0, s29, 83968
    s_add_u32 s33, s30, s40
    s_add_u32 s33, s33, 2686976
    buffer_load_dwordx4 v8, s[4:7], s33 offen lds
    s_add_u32 m0, s29, 84992
    s_add_u32 s33, s30, s40
    s_add_u32 s33, s33, 2719744
    buffer_load_dwordx4 v8, s[4:7], s33 offen lds
    s_add_u32 m0, s29, 98304
    s_add_u32 s33, s30, s40
    s_add_u32 s33, s33, 3145728
    buffer_load_dwordx4 v8, s[4:7], s33 offen lds
    s_add_u32 m0, s29, 99328
    s_add_u32 s33, s30, s40
    s_add_u32 s33, s33, 3178496
    buffer_load_dwordx4 v8, s[4:7], s33 offen lds
    s_add_u32 m0, s29, 100352
    s_add_u32 s33, s30, s40
    s_add_u32 s33, s33, 3211264
    buffer_load_dwordx4 v8, s[4:7], s33 offen lds
    s_add_u32 m0, s29, 101376
    s_add_u32 s33, s30, s40
    s_add_u32 s33, s33, 3244032
    buffer_load_dwordx4 v8, s[4:7], s33 offen lds
    s_add_u32 m0, s29, 114688
    s_add_u32 s33, s30, s40
    s_add_u32 s33, s33, 3670016
    buffer_load_dwordx4 v8, s[4:7], s33 offen lds
    s_add_u32 m0, s29, 115712
    s_add_u32 s33, s30, s40
    s_add_u32 s33, s33, 3702784
    buffer_load_dwordx4 v8, s[4:7], s33 offen lds
    s_add_u32 m0, s29, 116736
    s_add_u32 s33, s30, s40
    s_add_u32 s33, s33, 3735552
    buffer_load_dwordx4 v8, s[4:7], s33 offen lds
    s_add_u32 m0, s29, 117760
    s_add_u32 s33, s30, s40
    s_add_u32 s33, s33, 3768320
    buffer_load_dwordx4 v8, s[4:7], s33 offen lds
    s_waitcnt vmcnt(28)
    s_barrier
    s_add_u32 m0, s29, 131072
    s_add_u32 s33, s30, s41
    s_add_u32 s33, s33, 0
    buffer_load_dwordx4 v8, s[8:11], s33 offen lds
    s_add_u32 m0, s29, 132096
    s_add_u32 s33, s30, s41
    s_add_u32 s33, s33, 32768
    buffer_load_dwordx4 v8, s[8:11], s33 offen lds
    s_add_u32 m0, s29, 133120
    s_add_u32 s33, s30, s41
    s_add_u32 s33, s33, 65536
    buffer_load_dwordx4 v8, s[8:11], s33 offen lds
    s_add_u32 m0, s29, 134144
    s_add_u32 s33, s30, s41
    s_add_u32 s33, s33, 98304
    buffer_load_dwordx4 v8, s[8:11], s33 offen lds
    v_add_u32 v10, 0, v9
    ds_read_b64_tr_b16 a[0:1], v10 offset:0
    ds_read_b64_tr_b16 a[2:3], v10 offset:1024
    ds_read_b64_tr_b16 a[4:5], v10 offset:4096
    ds_read_b64_tr_b16 a[6:7], v10 offset:5120
    ds_read_b64_tr_b16 a[8:9], v10 offset:8192
    ds_read_b64_tr_b16 a[10:11], v10 offset:9216
    ds_read_b64_tr_b16 a[12:13], v10 offset:12288
    ds_read_b64_tr_b16 a[14:15], v10 offset:13312
    s_waitcnt lgkmcnt(0)
    s_waitcnt vmcnt(28)
    s_barrier
    s_add_u32 m0, s29, 0
    s_add_u32 s33, s30, s41
    s_add_u32 s33, s33, 524288
    buffer_load_dwordx4 v8, s[8:11], s33 offen lds
    s_add_u32 m0, s29, 1024
    s_add_u32 s33, s30, s41
    s_add_u32 s33, s33, 557056
    buffer_load_dwordx4 v8, s[8:11], s33 offen lds
    s_add_u32 m0, s29, 2048
    s_add_u32 s33, s30, s41
    s_add_u32 s33, s33, 589824
    buffer_load_dwordx4 v8, s[8:11], s33 offen lds
    s_add_u32 m0, s29, 3072
    s_add_u32 s33, s30, s41
    s_add_u32 s33, s33, 622592
    buffer_load_dwordx4 v8, s[8:11], s33 offen lds
    v_add_u32 v10, 16384, v9
    ds_read_b64_tr_b16 a[16:17], v10 offset:0
    ds_read_b64_tr_b16 a[18:19], v10 offset:1024
    ds_read_b64_tr_b16 a[20:21], v10 offset:4096
    ds_read_b64_tr_b16 a[22:23], v10 offset:5120
    ds_read_b64_tr_b16 a[24:25], v10 offset:8192
    ds_read_b64_tr_b16 a[26:27], v10 offset:9216
    ds_read_b64_tr_b16 a[28:29], v10 offset:12288
    ds_read_b64_tr_b16 a[30:31], v10 offset:13312
    s_waitcnt lgkmcnt(0)
    s_waitcnt vmcnt(28)
    s_barrier
    s_add_u32 m0, s29, 16384
    s_add_u32 s33, s30, s41
    s_add_u32 s33, s33, 1048576
    buffer_load_dwordx4 v8, s[8:11], s33 offen lds
    s_add_u32 m0, s29, 17408
    s_add_u32 s33, s30, s41
    s_add_u32 s33, s33, 1081344
    buffer_load_dwordx4 v8, s[8:11], s33 offen lds
    s_add_u32 m0, s29, 18432
    s_add_u32 s33, s30, s41
    s_add_u32 s33, s33, 1114112
    buffer_load_dwordx4 v8, s[8:11], s33 offen lds
    s_add_u32 m0, s29, 19456
    s_add_u32 s33, s30, s41
    s_add_u32 s33, s33, 1146880
    buffer_load_dwordx4 v8, s[8:11], s33 offen lds
    v_add_u32 v10, 32768, v9
    ds_read_b64_tr_b16 a[32:33], v10 offset:0
    ds_read_b64_tr_b16 a[34:35], v10 offset:1024
    ds_read_b64_tr_b16 a[36:37], v10 offset:4096
    ds_read_b64_tr_b16 a[38:39], v10 offset:5120
    ds_read_b64_tr_b16 a[40:41], v10 offset:8192
    ds_read_b64_tr_b16 a[42:43], v10 offset:9216
    ds_read_b64_tr_b16 a[44:45], v10 offset:12288
    ds_read_b64_tr_b16 a[46:47], v10 offset:13312
    s_waitcnt lgkmcnt(0)
    s_waitcnt vmcnt(28)
    s_barrier
    s_add_u32 m0, s29, 32768
    s_add_u32 s33, s30, s41
    s_add_u32 s33, s33, 1572864
    buffer_load_dwordx4 v8, s[8:11], s33 offen lds
    s_add_u32 m0, s29, 33792
    s_add_u32 s33, s30, s41
    s_add_u32 s33, s33, 1605632
    buffer_load_dwordx4 v8, s[8:11], s33 offen lds
    s_add_u32 m0, s29, 34816
    s_add_u32 s33, s30, s41
    s_add_u32 s33, s33, 1638400
    buffer_load_dwordx4 v8, s[8:11], s33 offen lds
    s_add_u32 m0, s29, 35840
    s_add_u32 s33, s30, s41
    s_add_u32 s33, s33, 1671168
    buffer_load_dwordx4 v8, s[8:11], s33 offen lds
    v_add_u32 v10, 49152, v9
    ds_read_b64_tr_b16 a[48:49], v10 offset:0
    ds_read_b64_tr_b16 a[50:51], v10 offset:1024
    ds_read_b64_tr_b16 a[52:53], v10 offset:4096
    ds_read_b64_tr_b16 a[54:55], v10 offset:5120
    ds_read_b64_tr_b16 a[56:57], v10 offset:8192
    ds_read_b64_tr_b16 a[58:59], v10 offset:9216
    ds_read_b64_tr_b16 a[60:61], v10 offset:12288
    ds_read_b64_tr_b16 a[62:63], v10 offset:13312
    s_waitcnt lgkmcnt(0)
    s_waitcnt vmcnt(28)
    s_barrier
    s_add_u32 m0, s29, 49152
    s_add_u32 s33, s30, s41
    s_add_u32 s33, s33, 2097152
    buffer_load_dwordx4 v8, s[8:11], s33 offen lds
    s_add_u32 m0, s29, 50176
    s_add_u32 s33, s30, s41
    s_add_u32 s33, s33, 2129920
    buffer_load_dwordx4 v8, s[8:11], s33 offen lds
    s_add_u32 m0, s29, 51200
    s_add_u32 s33, s30, s41
    s_add_u32 s33, s33, 2162688
    buffer_load_dwordx4 v8, s[8:11], s33 offen lds
    s_add_u32 m0, s29, 52224
    s_add_u32 s33, s30, s41
    s_add_u32 s33, s33, 2195456
    buffer_load_dwordx4 v8, s[8:11], s33 offen lds
    v_add_u32 v10, 65536, v9
    ds_read_b64_tr_b16 a[64:65], v10 offset:0
    ds_read_b64_tr_b16 a[66:67], v10 offset:1024
    ds_read_b64_tr_b16 a[68:69], v10 offset:4096
    ds_read_b64_tr_b16 a[70:71], v10 offset:5120
    ds_read_b64_tr_b16 a[72:73], v10 offset:8192
    ds_read_b64_tr_b16 a[74:75], v10 offset:9216
    ds_read_b64_tr_b16 a[76:77], v10 offset:12288
    ds_read_b64_tr_b16 a[78:79], v10 offset:13312
    s_waitcnt lgkmcnt(0)
    s_waitcnt vmcnt(28)
    s_barrier
    s_add_u32 m0, s29, 65536
    s_add_u32 s33, s30, s41
    s_add_u32 s33, s33, 2621440
    buffer_load_dwordx4 v8, s[8:11], s33 offen lds
    s_add_u32 m0, s29, 66560
    s_add_u32 s33, s30, s41
    s_add_u32 s33, s33, 2654208
    buffer_load_dwordx4 v8, s[8:11], s33 offen lds
    s_add_u32 m0, s29, 67584
    s_add_u32 s33, s30, s41
    s_add_u32 s33, s33, 2686976
    buffer_load_dwordx4 v8, s[8:11], s33 offen lds
    s_add_u32 m0, s29, 68608
    s_add_u32 s33, s30, s41
    s_add_u32 s33, s33, 2719744
    buffer_load_dwordx4 v8, s[8:11], s33 offen lds
    v_add_u32 v10, 81920, v9
    ds_read_b64_tr_b16 a[80:81], v10 offset:0
    ds_read_b64_tr_b16 a[82:83], v10 offset:1024
    ds_read_b64_tr_b16 a[84:85], v10 offset:4096
    ds_read_b64_tr_b16 a[86:87], v10 offset:5120
    ds_read_b64_tr_b16 a[88:89], v10 offset:8192
    ds_read_b64_tr_b16 a[90:91], v10 offset:9216
    ds_read_b64_tr_b16 a[92:93], v10 offset:12288
    ds_read_b64_tr_b16 a[94:95], v10 offset:13312
    s_waitcnt lgkmcnt(0)
    s_waitcnt vmcnt(28)
    s_barrier
    s_add_u32 m0, s29, 81920
    s_add_u32 s33, s30, s41
    s_add_u32 s33, s33, 3145728
    buffer_load_dwordx4 v8, s[8:11], s33 offen lds
    s_add_u32 m0, s29, 82944
    s_add_u32 s33, s30, s41
    s_add_u32 s33, s33, 3178496
    buffer_load_dwordx4 v8, s[8:11], s33 offen lds
    s_add_u32 m0, s29, 83968
    s_add_u32 s33, s30, s41
    s_add_u32 s33, s33, 3211264
    buffer_load_dwordx4 v8, s[8:11], s33 offen lds
    s_add_u32 m0, s29, 84992
    s_add_u32 s33, s30, s41
    s_add_u32 s33, s33, 3244032
    buffer_load_dwordx4 v8, s[8:11], s33 offen lds
    v_add_u32 v10, 98304, v9
    ds_read_b64_tr_b16 a[96:97], v10 offset:0
    ds_read_b64_tr_b16 a[98:99], v10 offset:1024
    ds_read_b64_tr_b16 a[100:101], v10 offset:4096
    ds_read_b64_tr_b16 a[102:103], v10 offset:5120
    ds_read_b64_tr_b16 a[104:105], v10 offset:8192
    ds_read_b64_tr_b16 a[106:107], v10 offset:9216
    ds_read_b64_tr_b16 a[108:109], v10 offset:12288
    ds_read_b64_tr_b16 a[110:111], v10 offset:13312
    s_waitcnt lgkmcnt(0)
    s_waitcnt vmcnt(28)
    s_barrier
    s_add_u32 m0, s29, 98304
    s_add_u32 s33, s30, s41
    s_add_u32 s33, s33, 3670016
    buffer_load_dwordx4 v8, s[8:11], s33 offen lds
    s_add_u32 m0, s29, 99328
    s_add_u32 s33, s30, s41
    s_add_u32 s33, s33, 3702784
    buffer_load_dwordx4 v8, s[8:11], s33 offen lds
    s_add_u32 m0, s29, 100352
    s_add_u32 s33, s30, s41
    s_add_u32 s33, s33, 3735552
    buffer_load_dwordx4 v8, s[8:11], s33 offen lds
    s_add_u32 m0, s29, 101376
    s_add_u32 s33, s30, s41
    s_add_u32 s33, s33, 3768320
    buffer_load_dwordx4 v8, s[8:11], s33 offen lds
    v_add_u32 v10, 114688, v9
    ds_read_b64_tr_b16 a[112:113], v10 offset:0
    ds_read_b64_tr_b16 a[114:115], v10 offset:1024
    ds_read_b64_tr_b16 a[116:117], v10 offset:4096
    ds_read_b64_tr_b16 a[118:119], v10 offset:5120
    ds_read_b64_tr_b16 a[120:121], v10 offset:8192
    ds_read_b64_tr_b16 a[122:123], v10 offset:9216
    ds_read_b64_tr_b16 a[124:125], v10 offset:12288
    ds_read_b64_tr_b16 a[126:127], v10 offset:13312
    s_waitcnt lgkmcnt(0)
    s_waitcnt vmcnt(28)
    s_barrier
    v_add_u32 v10, 131072, v9
    ds_read_b64_tr_b16 a[128:129], v10 offset:0
    ds_read_b64_tr_b16 a[130:131], v10 offset:1024
    ds_read_b64_tr_b16 a[132:133], v10 offset:4096
    ds_read_b64_tr_b16 a[134:135], v10 offset:5120
    ds_read_b64_tr_b16 a[136:137], v10 offset:8192
    ds_read_b64_tr_b16 a[138:139], v10 offset:9216
    ds_read_b64_tr_b16 a[140:141], v10 offset:12288
    ds_read_b64_tr_b16 a[142:143], v10 offset:13312
    s_waitcnt lgkmcnt(0)
    s_waitcnt vmcnt(24)
    s_barrier
    v_add_u32 v10, 0, v9
    ds_read_b64_tr_b16 a[144:145], v10 offset:0
    ds_read_b64_tr_b16 a[146:147], v10 offset:1024
    ds_read_b64_tr_b16 a[148:149], v10 offset:4096
    ds_read_b64_tr_b16 a[150:151], v10 offset:5120
    ds_read_b64_tr_b16 a[152:153], v10 offset:8192
    ds_read_b64_tr_b16 a[154:155], v10 offset:9216
    ds_read_b64_tr_b16 a[156:157], v10 offset:12288
    ds_read_b64_tr_b16 a[158:159], v10 offset:13312
    s_waitcnt lgkmcnt(0)
    s_waitcnt vmcnt(20)
    s_barrier
    v_add_u32 v10, 16384, v9
    ds_read_b64_tr_b16 a[160:161], v10 offset:0
    ds_read_b64_tr_b16 a[162:163], v10 offset:1024
    ds_read_b64_tr_b16 a[164:165], v10 offset:4096
    ds_read_b64_tr_b16 a[166:167], v10 offset:5120
    ds_read_b64_tr_b16 a[168:169], v10 offset:8192
    ds_read_b64_tr_b16 a[170:171], v10 offset:9216
    ds_read_b64_tr_b16 a[172:173], v10 offset:12288
    ds_read_b64_tr_b16 a[174:175], v10 offset:13312
    s_waitcnt lgkmcnt(0)
    s_waitcnt vmcnt(16)
    s_barrier
    v_add_u32 v10, 32768, v9
    ds_read_b64_tr_b16 a[176:177], v10 offset:0
    ds_read_b64_tr_b16 a[178:179], v10 offset:1024
    ds_read_b64_tr_b16 a[180:181], v10 offset:4096
    ds_read_b64_tr_b16 a[182:183], v10 offset:5120
    ds_read_b64_tr_b16 a[184:185], v10 offset:8192
    ds_read_b64_tr_b16 a[186:187], v10 offset:9216
    ds_read_b64_tr_b16 a[188:189], v10 offset:12288
    ds_read_b64_tr_b16 a[190:191], v10 offset:13312
    s_waitcnt lgkmcnt(0)
    s_waitcnt vmcnt(12)
    s_barrier
    v_add_u32 v10, 49152, v9
    ds_read_b64_tr_b16 a[192:193], v10 offset:0
    ds_read_b64_tr_b16 a[194:195], v10 offset:1024
    ds_read_b64_tr_b16 a[196:197], v10 offset:4096
    ds_read_b64_tr_b16 a[198:199], v10 offset:5120
    ds_read_b64_tr_b16 a[200:201], v10 offset:8192
    ds_read_b64_tr_b16 a[202:203], v10 offset:9216
    ds_read_b64_tr_b16 a[204:205], v10 offset:12288
    ds_read_b64_tr_b16 a[206:207], v10 offset:13312
    s_waitcnt lgkmcnt(0)
    s_waitcnt vmcnt(8)
    s_barrier
    v_add_u32 v10, 65536, v9
    ds_read_b64_tr_b16 a[208:209], v10 offset:0
    ds_read_b64_tr_b16 a[210:211], v10 offset:1024
    ds_read_b64_tr_b16 a[212:213], v10 offset:4096
    ds_read_b64_tr_b16 a[214:215], v10 offset:5120
    ds_read_b64_tr_b16 a[216:217], v10 offset:8192
    ds_read_b64_tr_b16 a[218:219], v10 offset:9216
    ds_read_b64_tr_b16 a[220:221], v10 offset:12288
    ds_read_b64_tr_b16 a[222:223], v10 offset:13312
    s_waitcnt lgkmcnt(0)
    s_waitcnt vmcnt(4)
    s_barrier
    v_add_u32 v10, 81920, v9
    ds_read_b64_tr_b16 a[224:225], v10 offset:0
    ds_read_b64_tr_b16 a[226:227], v10 offset:1024
    ds_read_b64_tr_b16 a[228:229], v10 offset:4096
    ds_read_b64_tr_b16 a[230:231], v10 offset:5120
    ds_read_b64_tr_b16 a[232:233], v10 offset:8192
    ds_read_b64_tr_b16 a[234:235], v10 offset:9216
    ds_read_b64_tr_b16 a[236:237], v10 offset:12288
    ds_read_b64_tr_b16 a[238:239], v10 offset:13312
    s_waitcnt lgkmcnt(0)
    s_waitcnt vmcnt(0)
    s_barrier
    v_add_u32 v10, 98304, v9
    ds_read_b64_tr_b16 a[240:241], v10 offset:0
    ds_read_b64_tr_b16 a[242:243], v10 offset:1024
    ds_read_b64_tr_b16 a[244:245], v10 offset:4096
    ds_read_b64_tr_b16 a[246:247], v10 offset:5120
    ds_read_b64_tr_b16 a[248:249], v10 offset:8192
    ds_read_b64_tr_b16 a[250:251], v10 offset:9216
    ds_read_b64_tr_b16 a[252:253], v10 offset:12288
    ds_read_b64_tr_b16 a[254:255], v10 offset:13312
    s_waitcnt lgkmcnt(0)
    s_load_dwordx2 s[64:65], s[0:1], 88
    v_mov_b32 v125, 0
    s_mov_b32 s61, 0
    s_waitcnt lgkmcnt(0)
Lwi_2:
    global_load_dword v126, v125, s[64:65] offset:40 sc1
    s_add_u32 s61, s61, 1
    s_cmp_gt_u32 s61, 2000000
    s_cbranch_scc1 L_fail
    s_waitcnt vmcnt(0)
    v_cmp_gt_u32 vcc, 64, v126
    s_cbranch_vccz Lwi_2_ok
    s_sleep 4
    s_branch Lwi_2
Lwi_2_ok:
    s_barrier
    v_lshlrev_b32 v3, 4, v2
    v_and_b32 v4, 31, v2
    s_movk_i32 s33, 1040
    v_mul_lo_u32 v4, v4, s33
    v_lshrrev_b32 v5, 5, v2
    v_lshl_add_u32 v4, v5, 4, v4
    v_and_b32 v6, 31, v2
    s_movk_i32 s33, 272
    v_mul_lo_u32 v6, v6, s33
    v_lshl_add_u32 v6, v5, 3, v6
    s_lshl_b32 s33, s25, 6
    s_add_u32 s33, s33, 66560
    v_add_u32 v6, s33, v6
    v_lshrrev_b32 v7, 4, v2
    s_lshl_b32 s33, s25, 3
    v_add_u32 v7, s33, v7
    v_and_b32 v8, 15, v2
    s_movk_i32 s33, 272
    v_mul_lo_u32 v9, v7, s33
    v_lshl_add_u32 v9, v8, 4, v9
    v_add_u32 v9, 66560, v9
    s_mov_b32 s33, 256
    v_mul_lo_u32 v10, v7, s33
    v_lshl_add_u32 v10, v8, 4, v10
    s_mov_b32 s67, 0
    s_mov_b32 s66, 0
    s_mov_b32 s35, 0
    s_mov_b32 s38, 0
    s_mov_b32 s31, s26
    s_mov_b32 s37, -1
    s_mov_b32 s39, -1
    s_lshr_b32 s60, s31, 4
    s_lshl_b32 s60, s60, 2
    s_add_u32 s60, s60, 48
    v_mov_b32 v125, s60
    s_and_b32 s60, s31, 15
    s_lshl_b32 s60, s60, 1
    s_lshl_b32 s60, 3, s60
    s_mov_b32 s61, 0
Lwx_3:
    global_load_dword v126, v125, s[64:65] sc1
    s_add_u32 s61, s61, 1
    s_cmp_gt_u32 s61, 2000000
    s_cbranch_scc1 L_fail
    s_waitcnt vmcnt(0)
    v_and_b32 v126, s60, v126
    v_cmp_ne_u32 vcc, s60, v126
    s_cbranch_vccz Lwx_3_ok
    s_sleep 2
    s_branch Lwx_3
Lwx_3_ok:
    s_lshl_b32 s33, s31, 5
    s_lshl_b32 s34, s25, 3
    s_add_u32 s33, s33, s34
    s_lshl_b32 s33, s33, 10
    s_add_u32 s33, s33, 0x0
    s_mul_i32 s34, s34, 1040
    s_add_u32 s34, s34, s35
    s_add_u32 m0, s34, 0
    s_nop 0
    buffer_load_dwordx4 v3, s[20:23], s33 offen sc1 lds
    s_add_u32 m0, s34, 1040
    s_add_u32 s33, s33, 1024
    buffer_load_dwordx4 v3, s[20:23], s33 offen sc1 lds
    s_add_u32 m0, s34, 2080
    s_add_u32 s33, s33, 1024
    buffer_load_dwordx4 v3, s[20:23], s33 offen sc1 lds
    s_add_u32 m0, s34, 3120
    s_add_u32 s33, s33, 1024
    buffer_load_dwordx4 v3, s[20:23], s33 offen sc1 lds
    s_add_u32 m0, s34, 4160
    s_add_u32 s33, s33, 1024
    buffer_load_dwordx4 v3, s[20:23], s33 offen sc1 lds
    s_add_u32 m0, s34, 5200
    s_add_u32 s33, s33, 1024
    buffer_load_dwordx4 v3, s[20:23], s33 offen sc1 lds
    s_add_u32 m0, s34, 6240
    s_add_u32 s33, s33, 1024
    buffer_load_dwordx4 v3, s[20:23], s33 offen sc1 lds
    s_add_u32 m0, s34, 7280
    s_add_u32 s33, s33, 1024
    buffer_load_dwordx4 v3, s[20:23], s33 offen sc1 lds
LR0_loop:
    s_waitcnt vmcnt(0) lgkmcnt(0)
    s_barrier
    s_xor_b32 s36, s35, 33280
    s_add_u32 s31, s26, 1
    s_min_u32 s31, s31, 63
    s_cmp_eq_u32 s67, 1
    s_cbranch_scc1 Lx_4
    s_lshr_b32 s60, s31, 4
    s_lshl_b32 s60, s60, 2
    s_add_u32 s60, s60, 48
    v_mov_b32 v125, s60
    s_and_b32 s60, s31, 15
    s_lshl_b32 s60, s60, 1
    s_lshl_b32 s60, 3, s60
    s_mov_b32 s61, 0
Lwx_5:
    global_load_dword v126, v125, s[64:65] sc1
    s_add_u32 s61, s61, 1
    s_cmp_gt_u32 s61, 2000000
    s_cbranch_scc1 L_fail
    s_waitcnt vmcnt(0)
    v_and_b32 v126, s60, v126
    v_cmp_ne_u32 vcc, s60, v126
    s_cbranch_vccz Lwx_5_ok
    s_sleep 2
    s_branch Lwx_5
Lwx_5_ok:
    s_cmp_ge_u32 s31, 2
    s_cselect_b32 s67, 1, 0
    s_cbranch_scc0 Lx_4
    v_lshlrev_b32 v125, 2, v2
    v_add_u32 v125, 48, v125
    s_mov_b32 s61, 0
Lwa_6:
    global_load_dword v126, v125, s[64:65] sc1
    s_add_u32 s61, s61, 1
    s_cmp_gt_u32 s61, 2000000
    s_cbranch_scc1 L_fail
    s_waitcnt vmcnt(0)
    v_cmp_ne_u32 vcc, -1, v126
    s_and_b32 vcc_lo, vcc_lo, 15
    s_cbranch_scc0 Lwa_6_ok
    s_sleep 2
    s_branch Lwa_6
Lwa_6_ok:
Lx_4:
    v_add_u32 v11, s35, v4
    ds_read_b128 v[32:35], v11 offset:0
    ds_read_b128 v[36:39], v11 offset:32
    ds_read_b128 v[40:43], v11 offset:64
    ds_read_b128 v[44:47], v11 offset:96
    s_xor_b32 s56, s38, 17408
    v_add_u32 v12, s56, v9
    s_cmp_eq_u32 s39, -1
    s_cbranch_scc1 Lp_7
    s_cmp_lg_u32 s25, 0
    s_cbranch_scc1 Lf_8
    s_mov_b32 s60, s39
    s_lshl_b32 s60, s60, 11
    s_lshl_b32 s61, s44, 2
    s_add_u32 s60, s60, s61
    s_add_u32 s60, s60, 0x410000
    v_mov_b32 v127, 0
    v_mov_b32 v125, 1
    s_mov_b64 exec, 1
    buffer_store_dword v125, v127, s[20:23], s60 offen sc1
    s_mov_b64 exec, -1
Lf_8:
    s_cmp_lg_u32 s25, 0
    s_cbranch_scc1 Lf_9
    s_mov_b32 s60, s39
    s_lshl_b32 s60, s60, 11
    s_lshl_b32 s61, s45, 2
    s_add_u32 s60, s60, s61
    s_add_u32 s60, s60, 0x410000
    v_mov_b32 v127, 0
    v_mov_b32 v125, 1
    s_mov_b64 exec, 1
    buffer_store_dword v125, v127, s[20:23], s60 offen sc1
    s_mov_b64 exec, -1
Lf_9:
Lp_7:
    s_waitcnt lgkmcnt(3)
    v_mfma_f32_32x32x16_bf16 v[64:79], a[0:3], v[32:35], 0
    ds_read_b128 v[48:51], v11 offset:128
    s_lshl_b32 s33, s31, 5
    s_lshl_b32 s34, s25, 3
    s_add_u32 s33, s33, s34
    v_mfma_f32_32x32x16_bf16 v[80:95], a[128:131], v[32:35], 0
    s_lshl_b32 s33, s33, 10
    s_add_u32 s33, s33, 0x0
    s_mul_i32 s34, s34, 1040
    s_waitcnt lgkmcnt(3)
    v_mfma_f32_32x32x16_bf16 v[64:79], a[4:7], v[36:39], v[64:79]
    ds_read_b128 v[32:35], v11 offset:160
    s_add_u32 s34, s34, s36
    s_add_u32 m0, s34, 0
    s_nop 0
    v_mfma_f32_32x32x16_bf16 v[80:95], a[132:135], v[36:39], v[80:95]
    buffer_load_dwordx4 v3, s[20:23], s33 offen sc1 lds
    s_add_u32 m0, s34, 1040
    s_add_u32 s33, s33, 1024
    s_waitcnt lgkmcnt(3)
    v_mfma_f32_32x32x16_bf16 v[64:79], a[8:11], v[40:43], v[64:79]
    ds_read_b128 v[36:39], v11 offset:192
    buffer_load_dwordx4 v3, s[20:23], s33 offen sc1 lds
    s_add_u32 m0, s34, 2080
    s_add_u32 s33, s33, 1024
    v_mfma_f32_32x32x16_bf16 v[80:95], a[136:139], v[40:43], v[80:95]
    buffer_load_dwordx4 v3, s[20:23], s33 offen sc1 lds
    s_add_u32 m0, s34, 3120
    s_add_u32 s33, s33, 1024
    s_waitcnt lgkmcnt(3)
    v_mfma_f32_32x32x16_bf16 v[64:79], a[12:15], v[44:47], v[64:79]
    ds_read_b128 v[40:43], v11 offset:224
    buffer_load_dwordx4 v3, s[20:23], s33 offen sc1 lds
    s_add_u32 m0, s34, 4160
    s_add_u32 s33, s33, 1024
    v_mfma_f32_32x32x16_bf16 v[80:95], a[140:143], v[44:47], v[80:95]
    buffer_load_dwordx4 v3, s[20:23], s33 offen sc1 lds
    s_add_u32 m0, s34, 5200
    s_add_u32 s33, s33, 1024
    s_waitcnt lgkmcnt(3)
    v_mfma_f32_32x32x16_bf16 v[64:79], a[16:19], v[48:51], v[64:79]
    ds_read_b128 v[44:47], v11 offset:256
    buffer_load_dwordx4 v3, s[20:23], s33 offen sc1 lds
    s_add_u32 m0, s34, 6240
    s_add_u32 s33, s33, 1024
    v_mfma_f32_32x32x16_bf16 v[80:95], a[144:147], v[48:51], v[80:95]
    buffer_load_dwordx4 v3, s[20:23], s33 offen sc1 lds
    s_add_u32 m0, s34, 7280
    s_add_u32 s33, s33, 1024
    s_waitcnt lgkmcnt(3)
    v_mfma_f32_32x32x16_bf16 v[64:79], a[20:23], v[32:35], v[64:79]
    ds_read_b128 v[48:51], v11 offset:288
    buffer_load_dwordx4 v3, s[20:23], s33 offen sc1 lds
    v_mfma_f32_32x32x16_bf16 v[80:95], a[148:151], v[32:35], v[80:95]
    s_waitcnt lgkmcnt(3)
    v_mfma_f32_32x32x16_bf16 v[64:79], a[24:27], v[36:39], v[64:79]
    ds_read_b128 v[32:35], v11 offset:320
    v_mfma_f32_32x32x16_bf16 v[80:95], a[152:155], v[36:39], v[80:95]
    ds_read_b128 v[112:115], v12 offset:0
    ds_read_b128 v[116:119], v12 offset:1088
    ds_read_b128 v[120:123], v12 offset:8704
    ds_read_b128 v[124:127], v12 offset:9792
    s_waitcnt lgkmcnt(7)
    v_mfma_f32_32x32x16_bf16 v[64:79], a[28:31], v[40:43], v[64:79]
    ds_read_b128 v[36:39], v11 offset:352
    v_mfma_f32_32x32x16_bf16 v[80:95], a[156:159], v[40:43], v[80:95]
    s_waitcnt lgkmcnt(7)
    v_mfma_f32_32x32x16_bf16 v[64:79], a[32:35], v[44:47], v[64:79]
    ds_read_b128 v[40:43], v11 offset:384
    v_mfma_f32_32x32x16_bf16 v[80:95], a[160:163], v[44:47], v[80:95]
    s_waitcnt lgkmcnt(7)
    v_mfma_f32_32x32x16_bf16 v[64:79], a[36:39], v[48:51], v[64:79]
    ds_read_b128 v[44:47], v11 offset:416
    v_mfma_f32_32x32x16_bf16 v[80:95], a[164:167], v[48:51], v[80:95]
    s_waitcnt lgkmcnt(7)
    v_mfma_f32_32x32x16_bf16 v[64:79], a[40:43], v[32:35], v[64:79]
    ds_read_b128 v[48:51], v11 offset:448
    v_mfma_f32_32x32x16_bf16 v[80:95], a[168:171], v[32:35], v[80:95]
    s_waitcnt lgkmcnt(3)
    v_mfma_f32_32x32x16_bf16 v[64:79], a[44:47], v[36:39], v[64:79]
    ds_read_b128 v[32:35], v11 offset:480
    v_mfma_f32_32x32x16_bf16 v[80:95], a[172:175], v[36:39], v[80:95]
    s_waitcnt lgkmcnt(3)
    v_mfma_f32_32x32x16_bf16 v[64:79], a[48:51], v[40:43], v[64:79]
    ds_read_b128 v[36:39], v11 offset:512
    v_mfma_f32_32x32x16_bf16 v[80:95], a[176:179], v[40:43], v[80:95]
    s_cmp_eq_u32 s37, -1
    s_cbranch_scc1 Ls_10
    s_mul_i32 s57, s37, 262144
    s_add_u32 s57, s57, s42
    buffer_store_dwordx4 v[112:115], v10, s[20:23], s57 offen sc1
    s_add_u32 s57, s57, 1024
    buffer_store_dwordx4 v[116:119], v10, s[20:23], s57 offen sc1
    s_mul_i32 s57, s37, 262144
    s_add_u32 s57, s57, s43
    buffer_store_dwordx4 v[120:123], v10, s[20:23], s57 offen sc1
    s_add_u32 s57, s57, 1024
    buffer_store_dwordx4 v[124:127], v10, s[20:23], s57 offen sc1
Ls_10:
    s_waitcnt lgkmcnt(3)
    v_mfma_f32_32x32x16_bf16 v[64:79], a[52:55], v[44:47], v[64:79]
    ds_read_b128 v[40:43], v11 offset:544
    v_mfma_f32_32x32x16_bf16 v[80:95], a[180:183], v[44:47], v[80:95]
    s_waitcnt lgkmcnt(3)
    v_mfma_f32_32x32x16_bf16 v[64:79], a[56:59], v[48:51], v[64:79]
    ds_read_b128 v[44:47], v11 offset:576
    v_mfma_f32_32x32x16_bf16 v[80:95], a[184:187], v[48:51], v[80:95]
    s_waitcnt lgkmcnt(3)
    v_mfma_f32_32x32x16_bf16 v[64:79], a[60:63], v[32:35], v[64:79]
    ds_read_b128 v[48:51], v11 offset:608
    v_mfma_f32_32x32x16_bf16 v[80:95], a[188:191], v[32:35], v[80:95]
    s_waitcnt lgkmcnt(3)
    v_mfma_f32_32x32x16_bf16 v[64:79], a[64:67], v[36:39], v[64:79]
    ds_read_b128 v[32:35], v11 offset:640
    v_mfma_f32_32x32x16_bf16 v[80:95], a[192:195], v[36:39], v[80:95]
    s_waitcnt lgkmcnt(3)
    v_mfma_f32_32x32x16_bf16 v[64:79], a[68:71], v[40:43], v[64:79]
    ds_read_b128 v[36:39], v11 offset:672
    v_mfma_f32_32x32x16_bf16 v[80:95], a[196:199], v[40:43], v[80:95]
    s_waitcnt lgkmcnt(3)
    v_mfma_f32_32x32x16_bf16 v[64:79], a[72:75], v[44:47], v[64:79]
    ds_read_b128 v[40:43], v11 offset:704
    v_mfma_f32_32x32x16_bf16 v[80:95], a[200:203], v[44:47], v[80:95]
    s_waitcnt lgkmcnt(3)
    v_mfma_f32_32x32x16_bf16 v[64:79], a[76:79], v[48:51], v[64:79]
    ds_read_b128 v[44:47], v11 offset:736
    v_mfma_f32_32x32x16_bf16 v[80:95], a[204:207], v[48:51], v[80:95]
    s_waitcnt lgkmcnt(3)
    v_mfma_f32_32x32x16_bf16 v[64:79], a[80:83], v[32:35], v[64:79]
    ds_read_b128 v[48:51], v11 offset:768
    v_mfma_f32_32x32x16_bf16 v[80:95], a[208:211], v[32:35], v[80:95]
    s_waitcnt lgkmcnt(3)
    v_mfma_f32_32x32x16_bf16 v[64:79], a[84:87], v[36:39], v[64:79]
    ds_read_b128 v[32:35], v11 offset:800
    v_mfma_f32_32x32x16_bf16 v[80:95], a[212:215], v[36:39], v[80:95]
    s_waitcnt lgkmcnt(3)
    v_mfma_f32_32x32x16_bf16 v[64:79], a[88:91], v[40:43], v[64:79]
    ds_read_b128 v[36:39], v11 offset:832
    v_mfma_f32_32x32x16_bf16 v[80:95], a[216:219], v[40:43], v[80:95]
    s_waitcnt lgkmcnt(3)
    v_mfma_f32_32x32x16_bf16 v[64:79], a[92:95], v[44:47], v[64:79]
    ds_read_b128 v[40:43], v11 offset:864
    v_mfma_f32_32x32x16_bf16 v[80:95], a[220:223], v[44:47], v[80:95]
    s_waitcnt lgkmcnt(3)
    v_mfma_f32_32x32x16_bf16 v[64:79], a[96:99], v[48:51], v[64:79]
    ds_read_b128 v[44:47], v11 offset:896
    v_mfma_f32_32x32x16_bf16 v[80:95], a[224:227], v[48:51], v[80:95]
    s_waitcnt lgkmcnt(3)
    v_mfma_f32_32x32x16_bf16 v[64:79], a[100:103], v[32:35], v[64:79]
    ds_read_b128 v[48:51], v11 offset:928
    v_mfma_f32_32x32x16_bf16 v[80:95], a[228:231], v[32:35], v[80:95]
    s_waitcnt lgkmcnt(3)
    v_mfma_f32_32x32x16_bf16 v[64:79], a[104:107], v[36:39], v[64:79]
    ds_read_b128 v[32:35], v11 offset:960
    v_mfma_f32_32x32x16_bf16 v[80:95], a[232:235], v[36:39], v[80:95]
    s_waitcnt lgkmcnt(3)
    v_mfma_f32_32x32x16_bf16 v[64:79], a[108:111], v[40:43], v[64:79]
    ds_read_b128 v[36:39], v11 offset:992
    v_mfma_f32_32x32x16_bf16 v[80:95], a[236:239], v[40:43], v[80:95]
    s_waitcnt lgkmcnt(3)
    v_mfma_f32_32x32x16_bf16 v[64:79], a[112:115], v[44:47], v[64:79]
    v_mfma_f32_32x32x16_bf16 v[80:95], a[240:243], v[44:47], v[80:95]
    s_waitcnt lgkmcnt(2)
    v_mfma_f32_32x32x16_bf16 v[64:79], a[116:119], v[48:51], v[64:79]
    v_mfma_f32_32x32x16_bf16 v[80:95], a[244:247], v[48:51], v[80:95]
    s_waitcnt lgkmcnt(1)
    v_mfma_f32_32x32x16_bf16 v[64:79], a[120:123], v[32:35], v[64:79]
    v_mfma_f32_32x32x16_bf16 v[80:95], a[248:251], v[32:35], v[80:95]
    s_waitcnt lgkmcnt(0)
    v_mfma_f32_32x32x16_bf16 v[64:79], a[124:127], v[36:39], v[64:79]
    v_mfma_f32_32x32x16_bf16 v[80:95], a[252:255], v[36:39], v[80:95]
    s_nop 7
    s_nop 3
    v_add_u32 v12, s38, v6
    v_cvt_pk_bf16_f32 v96, v64, v65
    v_cvt_pk_bf16_f32 v97, v66, v67
    v_cvt_pk_bf16_f32 v98, v68, v69
    v_cvt_pk_bf16_f32 v99, v70, v71
    v_cvt_pk_bf16_f32 v100, v72, v73
    v_cvt_pk_bf16_f32 v101, v74, v75
    v_cvt_pk_bf16_f32 v102, v76, v77
    v_cvt_pk_bf16_f32 v103, v78, v79
    ds_write_b64 v12, v[96:97] offset:0
    ds_write_b64 v12, v[98:99] offset:16
    ds_write_b64 v12, v[100:101] offset:32
    ds_write_b64 v12, v[102:103] offset:48
    v_cvt_pk_bf16_f32 v104, v80, v81
    v_cvt_pk_bf16_f32 v105, v82, v83
    v_cvt_pk_bf16_f32 v106, v84, v85
    v_cvt_pk_bf16_f32 v107, v86, v87
    v_cvt_pk_bf16_f32 v108, v88, v89
    v_cvt_pk_bf16_f32 v109, v90, v91
    v_cvt_pk_bf16_f32 v110, v92, v93
    v_cvt_pk_bf16_f32 v111, v94, v95
    ds_write_b64 v12, v[104:105] offset:8704
    ds_write_b64 v12, v[106:107] offset:8720
    ds_write_b64 v12, v[108:109] offset:8736
    ds_write_b64 v12, v[110:111] offset:8752
    s_mov_b32 s39, s37
    s_mov_b32 s37, s26
    s_cmp_ge_u32 s66, 0
    s_cbranch_scc1 Lq_11
    s_waitcnt lgkmcnt(0)
    s_barrier
    v_add_u32 v12, s38, v9
    ds_read_b128 v[112:115], v12 offset:0
    ds_read_b128 v[116:119], v12 offset:1088
    ds_read_b128 v[120:123], v12 offset:8704
    ds_read_b128 v[124:127], v12 offset:9792
    s_waitcnt lgkmcnt(0)
    s_mul_i32 s57, s26, 262144
    s_add_u32 s57, s57, s42
    buffer_store_dwordx4 v[112:115], v10, s[20:23], s57 offen sc1
    s_add_u32 s57, s57, 1024
    buffer_store_dwordx4 v[116:119], v10, s[20:23], s57 offen sc1
    s_mul_i32 s57, s26, 262144
    s_add_u32 s57, s57, s43
    buffer_store_dwordx4 v[120:123], v10, s[20:23], s57 offen sc1
    s_add_u32 s57, s57, 1024
    buffer_store_dwordx4 v[124:127], v10, s[20:23], s57 offen sc1
    s_waitcnt vmcnt(0)
    s_barrier
    s_cmp_lg_u32 s25, 0
    s_cbranch_scc1 Lf_12
    s_mov_b32 s60, s26
    s_lshl_b32 s60, s60, 11
    s_lshl_b32 s61, s44, 2
    s_add_u32 s60, s60, s61
    s_add_u32 s60, s60, 0x410000
    v_mov_b32 v127, 0
    v_mov_b32 v125, 1
    s_mov_b64 exec, 1
    buffer_store_dword v125, v127, s[20:23], s60 offen sc1
    s_mov_b64 exec, -1
Lf_12:
    s_cmp_lg_u32 s25, 0
    s_cbranch_scc1 Lf_13
    s_mov_b32 s60, s26
    s_lshl_b32 s60, s60, 11
    s_lshl_b32 s61, s45, 2
    s_add_u32 s60, s60, s61
    s_add_u32 s60, s60, 0x410000
    v_mov_b32 v127, 0
    v_mov_b32 v125, 1
    s_mov_b64 exec, 1
    buffer_store_dword v125, v127, s[20:23], s60 offen sc1
    s_mov_b64 exec, -1
Lf_13:
    s_mov_b32 s37, -1
    s_mov_b32 s39, -1
Lq_11:
    s_add_u32 s66, s66, 1
    s_mov_b32 s35, s36
    s_xor_b32 s38, s38, 17408
    s_add_u32 s26, s26, 1
    s_cmp_lt_u32 s26, 64
    s_cbranch_scc1 LR0_loop
    s_xor_b32 s38, s38, 17408
    s_waitcnt lgkmcnt(0)
    s_barrier
    v_add_u32 v12, s38, v9
    ds_read_b128 v[112:115], v12 offset:0
    ds_read_b128 v[116:119], v12 offset:1088
    ds_read_b128 v[120:123], v12 offset:8704
    ds_read_b128 v[124:127], v12 offset:9792
    s_waitcnt lgkmcnt(0)
    s_mul_i32 s57, s37, 262144
    s_add_u32 s57, s57, s42
    buffer_store_dwordx4 v[112:115], v10, s[20:23], s57 offen sc1
    s_add_u32 s57, s57, 1024
    buffer_store_dwordx4 v[116:119], v10, s[20:23], s57 offen sc1
    s_mul_i32 s57, s37, 262144
    s_add_u32 s57, s57, s43
    buffer_store_dwordx4 v[120:123], v10, s[20:23], s57 offen sc1
    s_add_u32 s57, s57, 1024
    buffer_store_dwordx4 v[124:127], v10, s[20:23], s57 offen sc1
    s_waitcnt vmcnt(0)
    s_barrier
    s_cmp_lg_u32 s25, 0
    s_cbranch_scc1 Lf_14
    s_mov_b32 s60, s37
    s_lshl_b32 s60, s60, 11
    s_lshl_b32 s61, s44, 2
    s_add_u32 s60, s60, s61
    s_add_u32 s60, s60, 0x410000
    v_mov_b32 v127, 0
    v_mov_b32 v125, 1
    s_mov_b64 exec, 1
    buffer_store_dword v125, v127, s[20:23], s60 offen sc1
    s_mov_b64 exec, -1
Lf_14:
    s_cmp_lg_u32 s25, 0
    s_cbranch_scc1 Lf_15
    s_mov_b32 s60, s37
    s_lshl_b32 s60, s60, 11
    s_lshl_b32 s61, s45, 2
    s_add_u32 s60, s60, s61
    s_add_u32 s60, s60, 0x410000
    v_mov_b32 v127, 0
    v_mov_b32 v125, 1
    s_mov_b64 exec, 1
    buffer_store_dword v125, v127, s[20:23], s60 offen sc1
    s_mov_b64 exec, -1
Lf_15:
    s_cmp_eq_u32 s39, -1
    s_cbranch_scc1 Lz_16
    s_cmp_lg_u32 s25, 0
    s_cbranch_scc1 Lf_17
    s_mov_b32 s60, s39
    s_lshl_b32 s60, s60, 11
    s_lshl_b32 s61, s44, 2
    s_add_u32 s60, s60, s61
    s_add_u32 s60, s60, 0x410000
    v_mov_b32 v127, 0
    v_mov_b32 v125, 1
    s_mov_b64 exec, 1
    buffer_store_dword v125, v127, s[20:23], s60 offen sc1
    s_mov_b64 exec, -1
Lf_17:
    s_cmp_lg_u32 s25, 0
    s_cbranch_scc1 Lf_18
    s_mov_b32 s60, s39
    s_lshl_b32 s60, s60, 11
    s_lshl_b32 s61, s45, 2
    s_add_u32 s60, s60, s61
    s_add_u32 s60, s60, 0x410000
    v_mov_b32 v127, 0
    v_mov_b32 v125, 1
    s_mov_b64 exec, 1
    buffer_store_dword v125, v127, s[20:23], s60 offen sc1
    s_mov_b64 exec, -1
Lf_18:
Lz_16:
    s_waitcnt vmcnt(0)
LR0_exit:
    s_barrier
    s_mov_b32 s26, 45
    s_branch L_wo_entry
LR1:
    s_sub_u32 s63, s62, 32
LB_wo:
    s_lshr_b32 s26, s63, 5
L_wo_entry:
    s_load_dwordx2 s[4:5], s[0:1], 40
    s_waitcnt lgkmcnt(0)
    s_mov_b32 s6, 0x400000
    s_mov_b32 s7, 0x00020000
    s_and_b32 s24, s63, 31
    s_lshr_b32 s33, s24, 3
    s_lshl_b32 s33, s33, 5
    s_add_u32 s33, s33, 384
    v_lshlrev_b32 v124, 2, v2
    v_add_u32 v124, s33, v124
    s_mov_b32 s59, s24
    s_cmp_ge_u32 s26, 64
    s_cbranch_scc1 LR1_exit
    s_lshr_b32 s27, s24, 3
    s_and_b32 s28, s24, 7
    s_and_b32 s37, s25, 1
    s_lshr_b32 s38, s25, 1
    s_lshl_b32 s29, s27, 20
    s_lshl_b32 s33, s38, 19
    s_add_u32 s29, s29, s33
    s_lshl_b32 s33, s28, 7
    s_add_u32 s29, s29, s33
    s_lshl_b32 s33, s37, 6
    s_add_u32 s29, s29, s33
    s_lshl_b32 s30, s25, 15
    s_load_dwordx2 s[64:65], s[0:1], 88
    v_mov_b32 v125, 0
    s_mov_b32 s61, 0
    s_waitcnt lgkmcnt(0)
Lwi_19:
    global_load_dword v126, v125, s[64:65] offset:40 sc1
    s_add_u32 s61, s61, 1
    s_cmp_gt_u32 s61, 2000000
    s_cbranch_scc1 L_fail
    s_waitcnt vmcnt(0)
    v_cmp_gt_u32 vcc, 64, v126
    s_cbranch_vccz Lwi_19_ok
    s_sleep 4
    s_branch Lwi_19
Lwi_19_ok:
    v_lshrrev_b32 v8, 2, v2
    s_mov_b32 s33, 1024
    v_mul_lo_u32 v8, v8, s33
    v_and_b32 v9, 3, v2
    v_lshl_add_u32 v8, v9, 4, v8
    s_add_u32 m0, s30, 0
    s_nop 0
    buffer_load_dwordx4 v8, s[4:7], s29 offen lds
    s_add_u32 m0, s30, 1024
    s_add_u32 s29, s29, 16384
    buffer_load_dwordx4 v8, s[4:7], s29 offen lds
    s_add_u32 m0, s30, 2048
    s_add_u32 s29, s29, 16384
    buffer_load_dwordx4 v8, s[4:7], s29 offen lds
    s_add_u32 m0, s30, 3072
    s_add_u32 s29, s29, 16384
    buffer_load_dwordx4 v8, s[4:7], s29 offen lds
    s_add_u32 m0, s30, 4096
    s_add_u32 s29, s29, 16384
    buffer_load_dwordx4 v8, s[4:7], s29 offen lds
    s_add_u32 m0, s30, 5120
    s_add_u32 s29, s29, 16384
    buffer_load_dwordx4 v8, s[4:7], s29 offen lds
    s_add_u32 m0, s30, 6144
    s_add_u32 s29, s29, 16384
    buffer_load_dwordx4 v8, s[4:7], s29 offen lds
    s_add_u32 m0, s30, 7168
    s_add_u32 s29, s29, 16384
    buffer_load_dwordx4 v8, s[4:7], s29 offen lds
    s_add_u32 m0, s30, 8192
    s_add_u32 s29, s29, 16384
    buffer_load_dwordx4 v8, s[4:7], s29 offen lds
    s_add_u32 m0, s30, 9216
    s_add_u32 s29, s29, 16384
    buffer_load_dwordx4 v8, s[4:7], s29 offen lds
    s_add_u32 m0, s30, 10240
    s_add_u32 s29, s29, 16384
    buffer_load_dwordx4 v8, s[4:7], s29 offen lds
    s_add_u32 m0, s30, 11264
    s_add_u32 s29, s29, 16384
    buffer_load_dwordx4 v8, s[4:7], s29 offen lds
    s_add_u32 m0, s30, 12288
    s_add_u32 s29, s29, 16384
    buffer_load_dwordx4 v8, s[4:7], s29 offen lds
    s_add_u32 m0, s30, 13312
    s_add_u32 s29, s29, 16384
    buffer_load_dwordx4 v8, s[4:7], s29 offen lds
    s_add_u32 m0, s30, 14336
    s_add_u32 s29, s29, 16384
    buffer_load_dwordx4 v8, s[4:7], s29 offen lds
    s_add_u32 m0, s30, 15360
    s_add_u32 s29, s29, 16384
    buffer_load_dwordx4 v8, s[4:7], s29 offen lds
    s_add_u32 m0, s30, 16384
    s_add_u32 s29, s29, 16384
    buffer_load_dwordx4 v8, s[4:7], s29 offen lds
    s_add_u32 m0, s30, 17408
    s_add_u32 s29, s29, 16384
    buffer_load_dwordx4 v8, s[4:7], s29 offen lds
    s_add_u32 m0, s30, 18432
    s_add_u32 s29, s29, 16384
    buffer_load_dwordx4 v8, s[4:7], s29 offen lds
    s_add_u32 m0, s30, 19456
    s_add_u32 s29, s29, 16384
    buffer_load_dwordx4 v8, s[4:7], s29 offen lds
    s_add_u32 m0, s30, 20480
    s_add_u32 s29, s29, 16384
    buffer_load_dwordx4 v8, s[4:7], s29 offen lds
    s_add_u32 m0, s30, 21504
    s_add_u32 s29, s29, 16384
    buffer_load_dwordx4 v8, s[4:7], s29 offen lds
    s_add_u32 m0, s30, 22528
    s_add_u32 s29, s29, 16384
    buffer_load_dwordx4 v8, s[4:7], s29 offen lds
    s_add_u32 m0, s30, 23552
    s_add_u32 s29, s29, 16384
    buffer_load_dwordx4 v8, s[4:7], s29 offen lds
    s_add_u32 m0, s30, 24576
    s_add_u32 s29, s29, 16384
    buffer_load_dwordx4 v8, s[4:7], s29 offen lds
    s_add_u32 m0, s30, 25600
    s_add_u32 s29, s29, 16384
    buffer_load_dwordx4 v8, s[4:7], s29 offen lds
    s_add_u32 m0, s30, 26624
    s_add_u32 s29, s29, 16384
    buffer_load_dwordx4 v8, s[4:7], s29 offen lds
    s_add_u32 m0, s30, 27648
    s_add_u32 s29, s29, 16384
    buffer_load_dwordx4 v8, s[4:7], s29 offen lds
    s_add_u32 m0, s30, 28672
    s_add_u32 s29, s29, 16384
    buffer_load_dwordx4 v8, s[4:7], s29 offen lds
    s_add_u32 m0, s30, 29696
    s_add_u32 s29, s29, 16384
    buffer_load_dwordx4 v8, s[4:7], s29 offen lds
    s_add_u32 m0, s30, 30720
    s_add_u32 s29, s29, 16384
    buffer_load_dwordx4 v8, s[4:7], s29 offen lds
    s_add_u32 m0, s30, 31744
    s_add_u32 s29, s29, 16384
    buffer_load_dwordx4 v8, s[4:7], s29 offen lds
    v_lshrrev_b32 v8, 5, v2
    v_lshlrev_b32 v8, 3, v8
    v_bfe_u32 v9, v2, 2, 2
    v_add_u32 v8, v8, v9
    v_lshlrev_b32 v8, 6, v8
    v_bfe_u32 v9, v2, 4, 1
    v_lshl_add_u32 v8, v9, 5, v8
    v_and_b32 v9, 3, v2
    v_lshl_add_u32 v8, v9, 3, v8
    v_add_u32 v8, s30, v8
    s_waitcnt vmcnt(28)
    ds_read_b64_tr_b16 a[0:1], v8 offset:0
    ds_read_b64_tr_b16 a[2:3], v8 offset:256
    ds_read_b64_tr_b16 a[4:5], v8 offset:1024
    ds_read_b64_tr_b16 a[6:7], v8 offset:1280
    ds_read_b64_tr_b16 a[8:9], v8 offset:2048
    ds_read_b64_tr_b16 a[10:11], v8 offset:2304
    ds_read_b64_tr_b16 a[12:13], v8 offset:3072
    ds_read_b64_tr_b16 a[14:15], v8 offset:3328
    s_waitcnt lgkmcnt(0)
    s_waitcnt vmcnt(24)
    ds_read_b64_tr_b16 a[16:17], v8 offset:4096
    ds_read_b64_tr_b16 a[18:19], v8 offset:4352
    ds_read_b64_tr_b16 a[20:21], v8 offset:5120
    ds_read_b64_tr_b16 a[22:23], v8 offset:5376
    ds_read_b64_tr_b16 a[24:25], v8 offset:6144
    ds_read_b64_tr_b16 a[26:27], v8 offset:6400
    ds_read_b64_tr_b16 a[28:29], v8 offset:7168
    ds_read_b64_tr_b16 a[30:31], v8 offset:7424
    s_waitcnt lgkmcnt(0)
    s_waitcnt vmcnt(20)
    ds_read_b64_tr_b16 a[32:33], v8 offset:8192
    ds_read_b64_tr_b16 a[34:35], v8 offset:8448
    ds_read_b64_tr_b16 a[36:37], v8 offset:9216
    ds_read_b64_tr_b16 a[38:39], v8 offset:9472
    ds_read_b64_tr_b16 a[40:41], v8 offset:10240
    ds_read_b64_tr_b16 a[42:43], v8 offset:10496
    ds_read_b64_tr_b16 a[44:45], v8 offset:11264
    ds_read_b64_tr_b16 a[46:47], v8 offset:11520
    s_waitcnt lgkmcnt(0)
    s_waitcnt vmcnt(16)
    ds_read_b64_tr_b16 a[48:49], v8 offset:12288
    ds_read_b64_tr_b16 a[50:51], v8 offset:12544
    ds_read_b64_tr_b16 a[52:53], v8 offset:13312
    ds_read_b64_tr_b16 a[54:55], v8 offset:13568
    ds_read_b64_tr_b16 a[56:57], v8 offset:14336
    ds_read_b64_tr_b16 a[58:59], v8 offset:14592
    ds_read_b64_tr_b16 a[60:61], v8 offset:15360
    ds_read_b64_tr_b16 a[62:63], v8 offset:15616
    s_waitcnt lgkmcnt(0)
    s_waitcnt vmcnt(12)
    ds_read_b64_tr_b16 a[64:65], v8 offset:16384
    ds_read_b64_tr_b16 a[66:67], v8 offset:16640
    ds_read_b64_tr_b16 a[68:69], v8 offset:17408
    ds_read_b64_tr_b16 a[70:71], v8 offset:17664
    ds_read_b64_tr_b16 a[72:73], v8 offset:18432
    ds_read_b64_tr_b16 a[74:75], v8 offset:18688
    ds_read_b64_tr_b16 a[76:77], v8 offset:19456
    ds_read_b64_tr_b16 a[78:79], v8 offset:19712
    s_waitcnt lgkmcnt(0)
    s_waitcnt vmcnt(8)
    ds_read_b64_tr_b16 a[80:81], v8 offset:20480
    ds_read_b64_tr_b16 a[82:83], v8 offset:20736
    ds_read_b64_tr_b16 a[84:85], v8 offset:21504
    ds_read_b64_tr_b16 a[86:87], v8 offset:21760
    ds_read_b64_tr_b16 a[88:89], v8 offset:22528
    ds_read_b64_tr_b16 a[90:91], v8 offset:22784
    ds_read_b64_tr_b16 a[92:93], v8 offset:23552
    ds_read_b64_tr_b16 a[94:95], v8 offset:23808
    s_waitcnt lgkmcnt(0)
    s_waitcnt vmcnt(4)
    ds_read_b64_tr_b16 a[96:97], v8 offset:24576
    ds_read_b64_tr_b16 a[98:99], v8 offset:24832
    ds_read_b64_tr_b16 a[100:101], v8 offset:25600
    ds_read_b64_tr_b16 a[102:103], v8 offset:25856
    ds_read_b64_tr_b16 a[104:105], v8 offset:26624
    ds_read_b64_tr_b16 a[106:107], v8 offset:26880
    ds_read_b64_tr_b16 a[108:109], v8 offset:27648
    ds_read_b64_tr_b16 a[110:111], v8 offset:27904
    s_waitcnt lgkmcnt(0)
    s_waitcnt vmcnt(0)
    ds_read_b64_tr_b16 a[112:113], v8 offset:28672
    ds_read_b64_tr_b16 a[114:115], v8 offset:28928
    ds_read_b64_tr_b16 a[116:117], v8 offset:29696
    ds_read_b64_tr_b16 a[118:119], v8 offset:29952
    ds_read_b64_tr_b16 a[120:121], v8 offset:30720
    ds_read_b64_tr_b16 a[122:123], v8 offset:30976
    ds_read_b64_tr_b16 a[124:125], v8 offset:31744
    ds_read_b64_tr_b16 a[126:127], v8 offset:32000
    s_waitcnt lgkmcnt(0)
    s_barrier
    v_lshlrev_b32 v3, 4, v2
    v_and_b32 v4, 31, v2
    s_movk_i32 s33, 2064
    v_mul_lo_u32 v4, v4, s33
    v_lshrrev_b32 v5, 5, v2
    v_lshl_add_u32 v4, v5, 4, v4
    s_lshl_b32 s33, s38, 10
    v_add_u32 v4, s33, v4
    v_and_b32 v6, 31, v2
    s_movk_i32 s33, 272
    v_mul_lo_u32 v6, v6, s33
    v_lshl_add_u32 v6, v5, 4, v6
    s_mul_i32 s33, s38, 8704
    s_lshl_b32 s34, s37, 7
    s_add_u32 s33, s33, s34
    s_add_u32 s33, s33, 132096
    v_add_u32 v6, s33, v6
    v_lshrrev_b32 v7, 4, v2
    s_lshl_b32 s33, s25, 3
    v_add_u32 v7, s33, v7
    v_and_b32 v8, 15, v2
    s_movk_i32 s33, 272
    v_mul_lo_u32 v9, v7, s33
    v_lshl_add_u32 v9, v8, 4, v9
    v_add_u32 v9, 132096, v9
    v_lshlrev_b32 v10, 11, v7
    v_lshl_add_u32 v10, v8, 4, v10
    s_mov_b32 s35, 0
    s_mov_b32 s31, s26
    s_mov_b32 s60, s31
    s_lshl_b32 s60, s60, 11
    s_add_u32 s60, s60, 0x410000
    s_mov_b32 s61, 0
Lw_20:
    buffer_load_dword v126, v124, s[20:23], s60 offen sc1
    s_add_u32 s61, s61, 1
    s_cmp_gt_u32 s61, 2000000
    s_cbranch_scc1 L_fail
    s_waitcnt vmcnt(0)
    v_cmp_eq_u32 vcc, 0, v126
    s_and_b32 vcc_lo, vcc_lo, 0xff
    s_cbranch_scc0 Lw_20_ok
    s_sleep 8
    s_branch Lw_20
Lw_20_ok:
    s_lshl_b32 s33, s31, 5
    s_lshl_b32 s34, s25, 3
    s_add_u32 s33, s33, s34
    s_lshl_b32 s33, s33, 13
    s_lshl_b32 s39, s27, 11
    s_add_u32 s33, s33, s39
    s_add_u32 s33, s33, 0x4000000
    s_mul_i32 s34, s34, 2064
    s_add_u32 s34, s34, s35
    s_add_u32 m0, s34, 0
    s_add_u32 s39, s33, 0
    buffer_load_dwordx4 v3, s[20:23], s39 offen sc1 lds
    s_add_u32 m0, s34, 1024
    s_add_u32 s39, s33, 1024
    buffer_load_dwordx4 v3, s[20:23], s39 offen sc1 lds
    s_add_u32 m0, s34, 2064
    s_add_u32 s39, s33, 8192
    buffer_load_dwordx4 v3, s[20:23], s39 offen sc1 lds
    s_add_u32 m0, s34, 3088
    s_add_u32 s39, s33, 9216
    buffer_load_dwordx4 v3, s[20:23], s39 offen sc1 lds
    s_add_u32 m0, s34, 4128
    s_add_u32 s39, s33, 16384
    buffer_load_dwordx4 v3, s[20:23], s39 offen sc1 lds
    s_add_u32 m0, s34, 5152
    s_add_u32 s39, s33, 17408
    buffer_load_dwordx4 v3, s[20:23], s39 offen sc1 lds
    s_add_u32 m0, s34, 6192
    s_add_u32 s39, s33, 24576
    buffer_load_dwordx4 v3, s[20:23], s39 offen sc1 lds
    s_add_u32 m0, s34, 7216
    s_add_u32 s39, s33, 25600
    buffer_load_dwordx4 v3, s[20:23], s39 offen sc1 lds
    s_add_u32 m0, s34, 8256
    s_add_u32 s39, s33, 32768
    buffer_load_dwordx4 v3, s[20:23], s39 offen sc1 lds
    s_add_u32 m0, s34, 9280
    s_add_u32 s39, s33, 33792
    buffer_load_dwordx4 v3, s[20:23], s39 offen sc1 lds
    s_add_u32 m0, s34, 10320
    s_add_u32 s39, s33, 40960
    buffer_load_dwordx4 v3, s[20:23], s39 offen sc1 lds
    s_add_u32 m0, s34, 11344
    s_add_u32 s39, s33, 41984
    buffer_load_dwordx4 v3, s[20:23], s39 offen sc1 lds
    s_add_u32 m0, s34, 12384
    s_add_u32 s39, s33, 49152
    buffer_load_dwordx4 v3, s[20:23], s39 offen sc1 lds
    s_add_u32 m0, s34, 13408
    s_add_u32 s39, s33, 50176
    buffer_load_dwordx4 v3, s[20:23], s39 offen sc1 lds
    s_add_u32 m0, s34, 14448
    s_add_u32 s39, s33, 57344
    buffer_load_dwordx4 v3, s[20:23], s39 offen sc1 lds
    s_add_u32 m0, s34, 15472
    s_add_u32 s39, s33, 58368
    buffer_load_dwordx4 v3, s[20:23], s39 offen sc1 lds
    s_mov_b32 s57, 1
LR1_loop:
    s_cmp_eq_u32 s57, 1
    s_cbranch_scc1 LR1_have
    s_mov_b32 s31, s26
    s_mov_b32 s60, s31
    s_lshl_b32 s60, s60, 11
    s_add_u32 s60, s60, 0x410000
    s_mov_b32 s61, 0
Lw_21:
    buffer_load_dword v126, v124, s[20:23], s60 offen sc1
    s_add_u32 s61, s61, 1
    s_cmp_gt_u32 s61, 2000000
    s_cbranch_scc1 L_fail
    s_waitcnt vmcnt(0)
    v_cmp_eq_u32 vcc, 0, v126
    s_and_b32 vcc_lo, vcc_lo, 0xff
    s_cbranch_scc0 Lw_21_ok
    s_sleep 8
    s_branch Lw_21
Lw_21_ok:
    s_lshl_b32 s33, s31, 5
    s_lshl_b32 s34, s25, 3
    s_add_u32 s33, s33, s34
    s_lshl_b32 s33, s33, 13
    s_lshl_b32 s39, s27, 11
    s_add_u32 s33, s33, s39
    s_add_u32 s33, s33, 0x4000000
    s_mul_i32 s34, s34, 2064
    s_add_u32 s34, s34, s35
    s_add_u32 m0, s34, 0
    s_add_u32 s39, s33, 0
    buffer_load_dwordx4 v3, s[20:23], s39 offen sc1 lds
    s_add_u32 m0, s34, 1024
    s_add_u32 s39, s33, 1024
    buffer_load_dwordx4 v3, s[20:23], s39 offen sc1 lds
    s_add_u32 m0, s34, 2064
    s_add_u32 s39, s33, 8192
    buffer_load_dwordx4 v3, s[20:23], s39 offen sc1 lds
    s_add_u32 m0, s34, 3088
    s_add_u32 s39, s33, 9216
    buffer_load_dwordx4 v3, s[20:23], s39 offen sc1 lds
    s_add_u32 m0, s34, 4128
    s_add_u32 s39, s33, 16384
    buffer_load_dwordx4 v3, s[20:23], s39 offen sc1 lds
    s_add_u32 m0, s34, 5152
    s_add_u32 s39, s33, 17408
    buffer_load_dwordx4 v3, s[20:23], s39 offen sc1 lds
    s_add_u32 m0, s34, 6192
    s_add_u32 s39, s33, 24576
    buffer_load_dwordx4 v3, s[20:23], s39 offen sc1 lds
    s_add_u32 m0, s34, 7216
    s_add_u32 s39, s33, 25600
    buffer_load_dwordx4 v3, s[20:23], s39 offen sc1 lds
    s_add_u32 m0, s34, 8256
    s_add_u32 s39, s33, 32768
    buffer_load_dwordx4 v3, s[20:23], s39 offen sc1 lds
    s_add_u32 m0, s34, 9280
    s_add_u32 s39, s33, 33792
    buffer_load_dwordx4 v3, s[20:23], s39 offen sc1 lds
    s_add_u32 m0, s34, 10320
    s_add_u32 s39, s33, 40960
    buffer_load_dwordx4 v3, s[20:23], s39 offen sc1 lds
    s_add_u32 m0, s34, 11344
    s_add_u32 s39, s33, 41984
    buffer_load_dwordx4 v3, s[20:23], s39 offen sc1 lds
    s_add_u32 m0, s34, 12384
    s_add_u32 s39, s33, 49152
    buffer_load_dwordx4 v3, s[20:23], s39 offen sc1 lds
    s_add_u32 m0, s34, 13408
    s_add_u32 s39, s33, 50176
    buffer_load_dwordx4 v3, s[20:23], s39 offen sc1 lds
    s_add_u32 m0, s34, 14448
    s_add_u32 s39, s33, 57344
    buffer_load_dwordx4 v3, s[20:23], s39 offen sc1 lds
    s_add_u32 m0, s34, 15472
    s_add_u32 s39, s33, 58368
    buffer_load_dwordx4 v3, s[20:23], s39 offen sc1 lds
LR1_have:
    s_waitcnt vmcnt(0)
    s_barrier
    s_xor_b32 s36, s35, 66048
    s_cmp_ge_u32 s26, 44
    s_cselect_b32 s56, 2, 1
    s_add_u32 s31, s26, s56
    s_mov_b32 s57, 0
    s_min_u32 s60, s31, 63
    s_lshl_b32 s60, s60, 11
    s_add_u32 s60, s60, 0x410000
    buffer_load_dword v122, v124, s[20:23], s60 offen sc1
    v_add_u32 v11, s35, v4
    ds_read_b128 v[32:35], v11 offset:0
    ds_read_b128 v[36:39], v11 offset:32
    ds_read_b128 v[40:43], v11 offset:64
    ds_read_b128 v[44:47], v11 offset:96
    s_waitcnt lgkmcnt(3)
    v_mfma_f32_32x32x16_bf16 v[16:31], a[0:3], v[32:35], 0
    ds_read_b128 v[48:51], v11 offset:128
    s_waitcnt lgkmcnt(3)
    v_mfma_f32_32x32x16_bf16 v[16:31], a[4:7], v[36:39], v[16:31]
    ds_read_b128 v[32:35], v11 offset:160
    s_waitcnt lgkmcnt(3)
    v_mfma_f32_32x32x16_bf16 v[16:31], a[8:11], v[40:43], v[16:31]
    ds_read_b128 v[36:39], v11 offset:192
    s_waitcnt lgkmcnt(3)
    v_mfma_f32_32x32x16_bf16 v[16:31], a[12:15], v[44:47], v[16:31]
    ds_read_b128 v[40:43], v11 offset:224
    s_waitcnt lgkmcnt(3)
    v_mfma_f32_32x32x16_bf16 v[16:31], a[16:19], v[48:51], v[16:31]
    ds_read_b128 v[44:47], v11 offset:256
    s_waitcnt lgkmcnt(3)
    v_mfma_f32_32x32x16_bf16 v[16:31], a[20:23], v[32:35], v[16:31]
    ds_read_b128 v[48:51], v11 offset:288
    s_waitcnt lgkmcnt(3)
    v_mfma_f32_32x32x16_bf16 v[16:31], a[24:27], v[36:39], v[16:31]
    ds_read_b128 v[32:35], v11 offset:320
    s_waitcnt lgkmcnt(3)
    v_mfma_f32_32x32x16_bf16 v[16:31], a[28:31], v[40:43], v[16:31]
    ds_read_b128 v[36:39], v11 offset:352
    s_waitcnt lgkmcnt(3)
    v_mfma_f32_32x32x16_bf16 v[16:31], a[32:35], v[44:47], v[16:31]
    ds_read_b128 v[40:43], v11 offset:384
    s_waitcnt lgkmcnt(3)
    v_mfma_f32_32x32x16_bf16 v[16:31], a[36:39], v[48:51], v[16:31]
    ds_read_b128 v[44:47], v11 offset:416
    s_waitcnt lgkmcnt(3)
    v_mfma_f32_32x32x16_bf16 v[16:31], a[40:43], v[32:35], v[16:31]
    ds_read_b128 v[48:51], v11 offset:448
    s_waitcnt lgkmcnt(3)
    v_mfma_f32_32x32x16_bf16 v[16:31], a[44:47], v[36:39], v[16:31]
    ds_read_b128 v[32:35], v11 offset:480
    s_waitcnt lgkmcnt(3)
    v_mfma_f32_32x32x16_bf16 v[16:31], a[48:51], v[40:43], v[16:31]
    ds_read_b128 v[36:39], v11 offset:512
    s_waitcnt lgkmcnt(3)
    v_mfma_f32_32x32x16_bf16 v[16:31], a[52:55], v[44:47], v[16:31]
    ds_read_b128 v[40:43], v11 offset:544
    s_waitcnt lgkmcnt(3)
    v_mfma_f32_32x32x16_bf16 v[16:31], a[56:59], v[48:51], v[16:31]
    ds_read_b128 v[44:47], v11 offset:576
    s_waitcnt lgkmcnt(3)
    v_mfma_f32_32x32x16_bf16 v[16:31], a[60:63], v[32:35], v[16:31]
    ds_read_b128 v[48:51], v11 offset:608
    s_waitcnt lgkmcnt(3)
    v_mfma_f32_32x32x16_bf16 v[16:31], a[64:67], v[36:39], v[16:31]
    ds_read_b128 v[32:35], v11 offset:640
    s_waitcnt lgkmcnt(3)
    v_mfma_f32_32x32x16_bf16 v[16:31], a[68:71], v[40:43], v[16:31]
    ds_read_b128 v[36:39], v11 offset:672
    s_waitcnt lgkmcnt(3)
    v_mfma_f32_32x32x16_bf16 v[16:31], a[72:75], v[44:47], v[16:31]
    ds_read_b128 v[40:43], v11 offset:704
    s_waitcnt lgkmcnt(3)
    v_mfma_f32_32x32x16_bf16 v[16:31], a[76:79], v[48:51], v[16:31]
    ds_read_b128 v[44:47], v11 offset:736
    s_waitcnt lgkmcnt(3)
    v_mfma_f32_32x32x16_bf16 v[16:31], a[80:83], v[32:35], v[16:31]
    ds_read_b128 v[48:51], v11 offset:768
    s_waitcnt lgkmcnt(3)
    v_mfma_f32_32x32x16_bf16 v[16:31], a[84:87], v[36:39], v[16:31]
    ds_read_b128 v[32:35], v11 offset:800
    s_waitcnt lgkmcnt(3)
    v_mfma_f32_32x32x16_bf16 v[16:31], a[88:91], v[40:43], v[16:31]
    ds_read_b128 v[36:39], v11 offset:832
    s_waitcnt lgkmcnt(3)
    v_mfma_f32_32x32x16_bf16 v[16:31], a[92:95], v[44:47], v[16:31]
    ds_read_b128 v[40:43], v11 offset:864
    s_waitcnt lgkmcnt(3)
    v_mfma_f32_32x32x16_bf16 v[16:31], a[96:99], v[48:51], v[16:31]
    ds_read_b128 v[44:47], v11 offset:896
    s_waitcnt lgkmcnt(3)
    v_mfma_f32_32x32x16_bf16 v[16:31], a[100:103], v[32:35], v[16:31]
    ds_read_b128 v[48:51], v11 offset:928
    s_waitcnt lgkmcnt(3)
    v_mfma_f32_32x32x16_bf16 v[16:31], a[104:107], v[36:39], v[16:31]
    ds_read_b128 v[32:35], v11 offset:960
    s_waitcnt lgkmcnt(3)
    v_mfma_f32_32x32x16_bf16 v[16:31], a[108:111], v[40:43], v[16:31]
    ds_read_b128 v[36:39], v11 offset:992
    s_waitcnt lgkmcnt(3)
    v_mfma_f32_32x32x16_bf16 v[16:31], a[112:115], v[44:47], v[16:31]
    s_waitcnt lgkmcnt(2)
    v_mfma_f32_32x32x16_bf16 v[16:31], a[116:119], v[48:51], v[16:31]
    s_waitcnt lgkmcnt(1)
    v_mfma_f32_32x32x16_bf16 v[16:31], a[120:123], v[32:35], v[16:31]
    s_waitcnt lgkmcnt(0)
    v_mfma_f32_32x32x16_bf16 v[16:31], a[124:127], v[36:39], v[16:31]
    s_nop 7
    s_nop 4
    ds_write_b128 v6, v[16:19] offset:0
    ds_write_b128 v6, v[20:23] offset:32
    ds_write_b128 v6, v[24:27] offset:64
    ds_write_b128 v6, v[28:31] offset:96
    s_waitcnt lgkmcnt(0)
    s_barrier
    ds_read_b128 v[32:35], v9
    ds_read_b128 v[36:39], v9 offset:8704
    ds_read_b128 v[40:43], v9 offset:1088
    ds_read_b128 v[44:47], v9 offset:9792
    s_lshl_b32 s33, s27, 22
    s_lshl_b32 s34, s26, 16
    s_add_u32 s33, s33, s34
    s_lshl_b32 s34, s28, 8
    s_add_u32 s33, s33, s34
    s_add_u32 s33, s33, 0x6000000
    s_add_u32 s34, s33, 8192
    s_waitcnt lgkmcnt(0)
    v_pk_add_f32 v[32:33], v[32:33], v[36:37]
    v_pk_add_f32 v[34:35], v[34:35], v[38:39]
    v_pk_add_f32 v[40:41], v[40:41], v[44:45]
    v_pk_add_f32 v[42:43], v[42:43], v[46:47]
    buffer_store_dwordx4 v[32:35], v10, s[20:23], s33 offen sc1
    buffer_store_dwordx4 v[40:43], v10, s[20:23], s34 offen sc1
    s_cmp_ge_u32 s31, 64
    s_cbranch_scc1 LR1_nodma
    s_waitcnt vmcnt(2)
    v_cmp_eq_u32 vcc, 0, v122
    s_and_b32 vcc_lo, vcc_lo, 0xff
    s_cselect_b32 s61, 0, 1
    s_cmp_eq_u32 s61, 1
    s_cbranch_scc0 LR1_nodma
    s_mov_b32 s57, 1
    s_lshl_b32 s33, s31, 5
    s_lshl_b32 s34, s25, 3
    s_add_u32 s33, s33, s34
    s_lshl_b32 s33, s33, 13
    s_lshl_b32 s39, s27, 11
    s_add_u32 s33, s33, s39
    s_add_u32 s33, s33, 0x4000000
    s_mul_i32 s34, s34, 2064
    s_add_u32 s34, s34, s36
    s_add_u32 m0, s34, 0
    s_add_u32 s39, s33, 0
    buffer_load_dwordx4 v3, s[20:23], s39 offen sc1 lds
    s_add_u32 m0, s34, 1024
    s_add_u32 s39, s33, 1024
    buffer_load_dwordx4 v3, s[20:23], s39 offen sc1 lds
    s_add_u32 m0, s34, 2064
    s_add_u32 s39, s33, 8192
    buffer_load_dwordx4 v3, s[20:23], s39 offen sc1 lds
    s_add_u32 m0, s34, 3088
    s_add_u32 s39, s33, 9216
    buffer_load_dwordx4 v3, s[20:23], s39 offen sc1 lds
    s_add_u32 m0, s34, 4128
    s_add_u32 s39, s33, 16384
    buffer_load_dwordx4 v3, s[20:23], s39 offen sc1 lds
    s_add_u32 m0, s34, 5152
    s_add_u32 s39, s33, 17408
    buffer_load_dwordx4 v3, s[20:23], s39 offen sc1 lds
    s_add_u32 m0, s34, 6192
    s_add_u32 s39, s33, 24576
    buffer_load_dwordx4 v3, s[20:23], s39 offen sc1 lds
    s_add_u32 m0, s34, 7216
    s_add_u32 s39, s33, 25600
    buffer_load_dwordx4 v3, s[20:23], s39 offen sc1 lds
    s_add_u32 m0, s34, 8256
    s_add_u32 s39, s33, 32768
    buffer_load_dwordx4 v3, s[20:23], s39 offen sc1 lds
    s_add_u32 m0, s34, 9280
    s_add_u32 s39, s33, 33792
    buffer_load_dwordx4 v3, s[20:23], s39 offen sc1 lds
    s_add_u32 m0, s34, 10320
    s_add_u32 s39, s33, 40960
    buffer_load_dwordx4 v3, s[20:23], s39 offen sc1 lds
    s_add_u32 m0, s34, 11344
    s_add_u32 s39, s33, 41984
    buffer_load_dwordx4 v3, s[20:23], s39 offen sc1 lds
    s_add_u32 m0, s34, 12384
    s_add_u32 s39, s33, 49152
    buffer_load_dwordx4 v3, s[20:23], s39 offen sc1 lds
    s_add_u32 m0, s34, 13408
    s_add_u32 s39, s33, 50176
    buffer_load_dwordx4 v3, s[20:23], s39 offen sc1 lds
    s_add_u32 m0, s34, 14448
    s_add_u32 s39, s33, 57344
    buffer_load_dwordx4 v3, s[20:23], s39 offen sc1 lds
    s_add_u32 m0, s34, 15472
    s_add_u32 s39, s33, 58368
    buffer_load_dwordx4 v3, s[20:23], s39 offen sc1 lds
    s_waitcnt vmcnt(16)
LR1_nodma:
    s_cmp_eq_u32 s57, 1
    s_cbranch_scc1 Ls_22_w
    s_waitcnt vmcnt(0)
Ls_22_w:
    s_barrier
    s_cmp_lg_u32 s25, 0
    s_cbranch_scc1 Lf_23
    s_mov_b32 s60, s26
    s_lshl_b32 s60, s60, 11
    s_lshl_b32 s61, s59, 2
    s_add_u32 s60, s60, s61
    s_add_u32 s60, s60, 0x410200
    v_mov_b32 v127, 0
    v_mov_b32 v125, 1
    s_mov_b64 exec, 1
    buffer_store_dword v125, v127, s[20:23], s60 offen sc1
    s_mov_b64 exec, -1
Lf_23:
    s_mov_b32 s35, s36
    s_cmp_ge_u32 s26, 44
    s_cselect_b32 s56, 2, 1
    s_add_u32 s26, s26, s56
    s_cmp_lt_u32 s26, 64
    s_cbranch_scc1 LR1_loop
    s_waitcnt vmcnt(0)
LR1_exit:
    s_branch L_exit
LR2:
    s_sub_u32 s63, s62, 64
LB_attn:
    s_and_b32 s24, s63, 31
    s_lshr_b32 s26, s63, 5
    s_lshl_b32 s33, s24, 3
    v_lshlrev_b32 v124, 2, v2
    v_add_u32 v124, s33, v124
    s_lshl_b32 s33, s24, 2
    s_add_u32 s33, s33, 256
    v_mov_b32 v123, s33
    v_cmp_eq_u32 vcc, 2, v2
    s_nop 1
    v_cndmask_b32 v124, v124, v123, vcc
    s_lshl_b32 s33, s24, 4
    s_add_u32 s33, s33, 1024
    v_lshlrev_b32 v123, 2, v2
    v_add_u32 v123, s33, v123
    s_mov_b32 s59, s24
    s_cmp_ge_u32 s26, 64
    s_cbranch_scc1 LR2_exit
    s_and_b32 s27, s25, 1
    s_lshr_b32 s28, s25, 1
    s_load_dwordx2 s[64:65], s[0:1], 88
    v_mov_b32 v125, 0
    s_mov_b32 s61, 0
    s_waitcnt lgkmcnt(0)
Lwi_24:
    global_load_dword v126, v125, s[64:65] offset:40 sc1
    s_add_u32 s61, s61, 1
    s_cmp_gt_u32 s61, 2000000
    s_cbranch_scc1 L_fail
    s_waitcnt vmcnt(0)
    v_cmp_gt_u32 vcc, 64, v126
    s_cbranch_vccz Lwi_24_ok
    s_sleep 4
    s_branch Lwi_24
Lwi_24_ok:
    v_and_b32 v3, 15, v2
    v_lshrrev_b32 v4, 4, v2
    v_bfe_u32 v5, v2, 2, 2
    v_and_b32 v6, 3, v2
    v_lshlrev_b32 v7, 4, v2
    v_lshlrev_b32 v8, 8, v3
    v_lshl_add_u32 v8, v4, 4, v8
    s_lshl_b32 s33, s25, 5
    v_add_u32 v9, s33, v3
    v_lshlrev_b32 v9, 5, v9
    v_lshrrev_b32 v10, 1, v9
    v_and_b32 v10, 128, v10
    v_xor_b32 v9, v9, v10
    v_lshl_add_u32 v9, v4, 3, v9
    v_add_u32 v9, 16384, v9
    v_lshlrev_b32 v10, 3, v4
    v_add_u32 v10, v10, v5
    v_lshlrev_b32 v10, 5, v10
    v_lshrrev_b32 v11, 1, v10
    v_and_b32 v11, 128, v11
    v_xor_b32 v10, v10, v11
    v_lshl_add_u32 v10, v6, 3, v10
    v_add_u32 v10, 16384, v10
    v_xor_b32 v11, 128, v10
    v_lshlrev_b32 v12, 2, v4
    v_add_u32 v12, v12, v5
    v_and_b32 v13, 7, v12
    s_lshl_b32 s33, s28, 2
    v_xor_b32 v13, s33, v13
    v_lshlrev_b32 v13, 5, v13
    v_lshl_add_u32 v12, v12, 8, v13
    v_lshl_add_u32 v12, v6, 3, v12
    v_add_u32 v12, 0, v12
    v_lshrrev_b32 v13, 1, v3
    v_xor_b32 v13, v13, v4
    v_lshlrev_b32 v13, 5, v13
    v_lshl_add_u32 v13, v4, 8, v13
    v_and_b32 v14, 1, v2
    v_lshl_add_u32 v13, v14, 4, v13
    v_xor_b32 v14, 128, v13
    s_lshl_b32 s33, s27, 4
    v_add_u32 v15, s33, v3
    s_movk_i32 s33, 272
    v_mul_lo_u32 v15, v15, s33
    v_lshl_add_u32 v15, v4, 3, v15
    s_lshl_b32 s33, s28, 7
    s_add_u32 s33, s33, 20480
    v_add_u32 v15, s33, v15
    s_lshl_b32 s33, s25, 3
    v_add_u32 v17, s33, v4
    s_movk_i32 s33, 272
    v_mul_lo_u32 v16, v17, s33
    v_lshl_add_u32 v16, v3, 4, v16
    v_add_u32 v16, 20480, v16
    v_lshlrev_b32 v17, 13, v17
    v_lshl_add_u32 v17, v3, 4, v17
    s_lshl_b32 s33, s27, 4
    v_add_u32 v18, s33, v3
    v_lshlrev_b32 v19, 2, v4
    v_sub_u32 v18, v18, v19
    v_cmp_le_i32 s[40:41], 0, v18
    v_cmp_le_i32 s[42:43], 1, v18
    v_cmp_le_i32 s[44:45], 2, v18
    v_cmp_le_i32 s[46:47], 3, v18
    v_cmp_le_i32 s[48:49], 16, v18
    v_cmp_le_i32 s[50:51], 17, v18
    v_cmp_le_i32 s[52:53], 18, v18
    v_cmp_le_i32 s[54:55], 19, v18
    s_mov_b32 s56, 0x3e0293ee
    s_mov_b32 s57, 0x3e0293ee
    v_mov_b32 v18, 0xf149f2ca
    v_mov_b32 v21, 0
    v_mov_b32 v22, 0
    s_mov_b32 s29, 0
    s_cmp_lg_u32 s25, 0
    s_cbranch_scc1 Lw_25_ok
    s_mov_b32 s60, s26
    s_lshl_b32 s60, s60, 11
    s_add_u32 s60, s60, 0x410000
    s_mov_b32 s61, 0
Lw_25:
    buffer_load_dword v126, v124, s[20:23], s60 offen sc1
    s_add_u32 s61, s61, 1
    s_cmp_gt_u32 s61, 2000000
    s_cbranch_scc1 L_fail
    s_waitcnt vmcnt(0)
    v_cmp_eq_u32 vcc, 0, v126
    s_and_b32 vcc_lo, vcc_lo, 0x7
    s_cbranch_scc0 Lw_25_ok
    s_sleep 4
    s_branch Lw_25
Lw_25_ok:
    s_barrier
    s_lshl_b32 s33, s26, 5
    s_add_u32 s33, s33, s24
    s_lshl_b32 s34, s33, 13
    s_add_u32 s35, s34, 0x1000000
    s_add_u32 s36, s35, 4096
    buffer_load_dwordx4 v[128:131], v8, s[20:23], s35 offen offset:0 sc1
    buffer_load_dwordx4 v[132:135], v8, s[20:23], s35 offen offset:64 sc1
    buffer_load_dwordx4 v[136:139], v8, s[20:23], s35 offen offset:128 sc1
    buffer_load_dwordx4 v[140:143], v8, s[20:23], s35 offen offset:192 sc1
    buffer_load_dwordx4 v[144:147], v8, s[20:23], s36 offen offset:0 sc1
    buffer_load_dwordx4 v[148:151], v8, s[20:23], s36 offen offset:64 sc1
    buffer_load_dwordx4 v[152:155], v8, s[20:23], s36 offen offset:128 sc1
    buffer_load_dwordx4 v[156:159], v8, s[20:23], s36 offen offset:192 sc1
    s_lshl_b32 s37, s27, 12
    s_add_u32 s37, s37, s34
    s_add_u32 s37, s37, 0x3000000
    buffer_load_dwordx4 v[160:163], v8, s[20:23], s37 offen offset:0 sc1
    buffer_load_dwordx4 v[164:167], v8, s[20:23], s37 offen offset:64 sc1
    buffer_load_dwordx4 v[168:171], v8, s[20:23], s37 offen offset:128 sc1
    buffer_load_dwordx4 v[172:175], v8, s[20:23], s37 offen offset:192 sc1
    s_lshl_b32 s39, s25, 11
    s_add_u32 s35, s34, s39
    s_add_u32 s35, s35, 0x2000000
    s_add_u32 s39, s39, s29
    s_mov_b32 m0, s39
    s_nop 0
    buffer_load_dwordx4 v13, s[20:23], s35 offen sc1 lds
    s_add_u32 s35, s35, 1024
    s_add_u32 m0, s39, 1024
    s_nop 0
    buffer_load_dwordx4 v14, s[20:23], s35 offen sc1 lds
LR2_loop:
    s_waitcnt vmcnt(0)
    v_mfma_f32_16x16x32_bf16 v[96:99], v[128:131], v[160:163], 0
    v_mfma_f32_16x16x32_bf16 v[100:103], v[144:147], v[160:163], 0
    v_mfma_f32_16x16x32_bf16 v[96:99], v[132:135], v[164:167], v[96:99]
    v_mfma_f32_16x16x32_bf16 v[100:103], v[148:151], v[164:167], v[100:103]
    v_mfma_f32_16x16x32_bf16 v[96:99], v[136:139], v[168:171], v[96:99]
    v_mfma_f32_16x16x32_bf16 v[100:103], v[152:155], v[168:171], v[100:103]
    v_mfma_f32_16x16x32_bf16 v[96:99], v[140:143], v[172:175], v[96:99]
    v_mfma_f32_16x16x32_bf16 v[100:103], v[156:159], v[172:175], v[100:103]
    v_mov_b64 v[64:65], v[160:161]
    v_mov_b64 v[66:67], v[162:163]
    v_mov_b64 v[68:69], v[164:165]
    v_mov_b64 v[70:71], v[166:167]
    v_mov_b64 v[72:73], v[168:169]
    v_mov_b64 v[74:75], v[170:171]
    v_mov_b64 v[76:77], v[172:173]
    v_mov_b64 v[78:79], v[174:175]
    s_add_u32 s31, s26, 2
    s_cmp_ge_u32 s31, 64
    s_cbranch_scc1 LR2_nopre
    s_cmp_lg_u32 s25, 0
    s_cbranch_scc1 Lw_26_ok
    s_mov_b32 s60, s31
    s_lshl_b32 s60, s60, 11
    s_add_u32 s60, s60, 0x410000
    s_mov_b32 s61, 0
Lw_26:
    buffer_load_dword v126, v124, s[20:23], s60 offen sc1
    s_add_u32 s61, s61, 1
    s_cmp_gt_u32 s61, 2000000
    s_cbranch_scc1 L_fail
    s_waitcnt vmcnt(0)
    v_cmp_eq_u32 vcc, 0, v126
    s_and_b32 vcc_lo, vcc_lo, 0x7
    s_cbranch_scc0 Lw_26_ok
    s_sleep 4
    s_branch Lw_26
Lw_26_ok:
    s_barrier
    s_xor_b32 s30, s29, 8192
    s_lshl_b32 s33, s31, 5
    s_add_u32 s33, s33, s24
    s_lshl_b32 s34, s33, 13
    s_add_u32 s35, s34, 0x1000000
    s_add_u32 s36, s35, 4096
    buffer_load_dwordx4 v[128:131], v8, s[20:23], s35 offen offset:0 sc1
    buffer_load_dwordx4 v[132:135], v8, s[20:23], s35 offen offset:64 sc1
    buffer_load_dwordx4 v[136:139], v8, s[20:23], s35 offen offset:128 sc1
    buffer_load_dwordx4 v[140:143], v8, s[20:23], s35 offen offset:192 sc1
    buffer_load_dwordx4 v[144:147], v8, s[20:23], s36 offen offset:0 sc1
    buffer_load_dwordx4 v[148:151], v8, s[20:23], s36 offen offset:64 sc1
    buffer_load_dwordx4 v[152:155], v8, s[20:23], s36 offen offset:128 sc1
    buffer_load_dwordx4 v[156:159], v8, s[20:23], s36 offen offset:192 sc1
    s_lshl_b32 s37, s27, 12
    s_add_u32 s37, s37, s34
    s_add_u32 s37, s37, 0x3000000
    buffer_load_dwordx4 v[160:163], v8, s[20:23], s37 offen offset:0 sc1
    buffer_load_dwordx4 v[164:167], v8, s[20:23], s37 offen offset:64 sc1
    buffer_load_dwordx4 v[168:171], v8, s[20:23], s37 offen offset:128 sc1
    buffer_load_dwordx4 v[172:175], v8, s[20:23], s37 offen offset:192 sc1
    s_lshl_b32 s39, s25, 11
    s_add_u32 s35, s34, s39
    s_add_u32 s35, s35, 0x2000000
    s_add_u32 s39, s39, s30
    s_mov_b32 m0, s39
    s_nop 0
    buffer_load_dwordx4 v13, s[20:23], s35 offen sc1 lds
    s_add_u32 s35, s35, 1024
    s_add_u32 m0, s39, 1024
    s_nop 0
    buffer_load_dwordx4 v14, s[20:23], s35 offen sc1 lds
LR2_nopre:
    s_cmp_lg_u32 s25, 0
    s_cbranch_scc1 Lw_27_ok
    s_mov_b32 s60, s26
    s_lshl_b32 s60, s60, 11
    s_add_u32 s60, s60, 0x410000
    s_mov_b32 s61, 0
Lw_27:
    buffer_load_dword v126, v123, s[20:23], s60 offen sc1
    s_add_u32 s61, s61, 1
    s_cmp_gt_u32 s61, 2000000
    s_cbranch_scc1 L_fail
    s_waitcnt vmcnt(0)
    v_cmp_eq_u32 vcc, 0, v126
    s_and_b32 vcc_lo, vcc_lo, 0xf
    s_cbranch_scc0 Lw_27_ok
    s_sleep 4
    s_branch Lw_27
Lw_27_ok:
    s_barrier
    s_lshl_b32 s33, s26, 5
    s_add_u32 s33, s33, s24
    s_lshl_b32 s38, s33, 12
    s_add_u32 s38, s38, 0x800000
    s_lshl_b32 s39, s25, 10
    s_add_u32 s39, s39, s38
    buffer_load_dwordx2 v[24:25], v7, s[20:23], s39 offen sc1
    s_lshl_b32 s39, s28, 11
    s_add_u32 s39, s39, s38
    buffer_load_dwordx2 v[26:27], v7, s[20:23], s39 offen offset:8 sc1
    buffer_load_dwordx2 v[28:29], v7, s[20:23], s39 offen offset:1032 sc1
    v_cndmask_b32 v96, v18, v96, s[40:41]
    v_cndmask_b32 v97, v18, v97, s[42:43]
    v_cndmask_b32 v98, v18, v98, s[44:45]
    v_cndmask_b32 v99, v18, v99, s[46:47]
    v_cndmask_b32 v100, v18, v100, s[48:49]
    v_cndmask_b32 v101, v18, v101, s[50:51]
    v_cndmask_b32 v102, v18, v102, s[52:53]
    v_cndmask_b32 v103, v18, v103, s[54:55]
    s_waitcnt vmcnt(2)
    ds_write2st64_b32 v9, v24, v25 offset0:0 offset1:2
    s_waitcnt lgkmcnt(0)
    s_barrier
    ds_read_b64_tr_b16 v[80:81], v10 offset:0
    ds_read_b64_tr_b16 v[82:83], v11 offset:0
    ds_read_b64_tr_b16 v[84:85], v10 offset:1024
    ds_read_b64_tr_b16 v[86:87], v11 offset:1024
    ds_read_b64_tr_b16 v[88:89], v10 offset:2048
    ds_read_b64_tr_b16 v[90:91], v11 offset:2048
    ds_read_b64_tr_b16 v[92:93], v10 offset:3072
    ds_read_b64_tr_b16 v[94:95], v11 offset:3072
    v_add_u32 v19, s29, v12
    ds_read_b64_tr_b16 v[32:33], v19 offset:0
    ds_read_b64_tr_b16 v[34:35], v19 offset:4096
    v_xor_b32 v30, 32, v19
    ds_read_b64_tr_b16 v[36:37], v30 offset:0
    ds_read_b64_tr_b16 v[38:39], v30 offset:4096
    v_xor_b32 v30, 64, v19
    ds_read_b64_tr_b16 v[40:41], v30 offset:0
    ds_read_b64_tr_b16 v[42:43], v30 offset:4096
    v_xor_b32 v30, 96, v19
    s_waitcnt lgkmcnt(6)
    ds_read_b64_tr_b16 v[44:45], v30 offset:0
    ds_read_b64_tr_b16 v[46:47], v30 offset:4096
    s_waitcnt lgkmcnt(8)
    v_mfma_f32_16x16x32_bf16 v[104:107], v[80:83], v[64:67], 0
    v_mfma_f32_16x16x32_bf16 v[104:107], v[84:87], v[68:71], v[104:107]
    v_mfma_f32_16x16x32_bf16 v[104:107], v[88:91], v[72:75], v[104:107]
    v_mfma_f32_16x16x32_bf16 v[104:107], v[92:95], v[76:79], v[104:107]
    s_nop 7
    v_max3_f32 v48, v96, v97, v98
    v_max3_f32 v49, v99, v100, v101
    v_max3_f32 v48, v48, v102, v103
    v_max3_f32 v49, v49, v104, v105
    v_max_f32 v50, v48, v49
    v_max_f32 v51, v48, v49
    s_nop 1
    v_permlane32_swap_b32 v50, v51
    v_max_f32 v48, v50, v51
    v_max_f32 v49, v50, v51
    s_nop 1
    v_permlane16_swap_b32 v48, v49
    v_max_f32 v48, v48, v49
    v_mul_f32 v48, s56, v48
    v_pk_fma_f32 v[96:97], v[96:97], s[56:57], v[48:49] op_sel_hi:[1,1,0] neg_lo:[0,0,1] neg_hi:[0,0,1]
    v_pk_fma_f32 v[98:99], v[98:99], s[56:57], v[48:49] op_sel_hi:[1,1,0] neg_lo:[0,0,1] neg_hi:[0,0,1]
    v_pk_fma_f32 v[100:101], v[100:101], s[56:57], v[48:49] op_sel_hi:[1,1,0] neg_lo:[0,0,1] neg_hi:[0,0,1]
    v_pk_fma_f32 v[102:103], v[102:103], s[56:57], v[48:49] op_sel_hi:[1,1,0] neg_lo:[0,0,1] neg_hi:[0,0,1]
    v_pk_fma_f32 v[104:105], v[104:105], s[56:57], v[48:49] op_sel_hi:[1,1,0] neg_lo:[0,0,1] neg_hi:[0,0,1]
    v_exp_f32 v96, v96
    v_exp_f32 v97, v97
    v_exp_f32 v98, v98
    v_exp_f32 v99, v99
    v_exp_f32 v100, v100
    v_exp_f32 v101, v101
    v_exp_f32 v102, v102
    v_exp_f32 v103, v103
    v_exp_f32 v104, v104
    v_exp_f32 v105, v105
    s_nop 0
    v_cvt_pk_bf16_f32 v48, v96, v97
    v_cvt_pk_bf16_f32 v49, v98, v99
    v_cvt_pk_bf16_f32 v50, v100, v101
    v_cvt_pk_bf16_f32 v51, v102, v103
    v_cvt_pk_bf16_f32 v20, v104, v105
    v_cvt_pk_bf16_f32 v23, v104, v105
    s_waitcnt vmcnt(0) lgkmcnt(0)
    s_nop 0
    v_mfma_f32_16x16x32_bf16 v[64:67], v[32:35], v[48:51], 0
    v_mfma_f32_16x16x32_bf16 v[68:71], v[36:39], v[48:51], 0
    v_mfma_f32_16x16x32_bf16 v[72:75], v[40:43], v[48:51], 0
    v_mfma_f32_16x16x32_bf16 v[76:79], v[44:47], v[48:51], 0
    v_mfma_f32_16x16x16_bf16 v[64:67], v[26:27], v[20:21], v[64:67]
    v_mfma_f32_16x16x16_bf16 v[68:71], v[26:27], v[22:23], v[68:71]
    v_mfma_f32_16x16x16_bf16 v[72:75], v[28:29], v[20:21], v[72:75]
    v_mfma_f32_16x16x16_bf16 v[76:79], v[28:29], v[22:23], v[76:79]
    v_pk_add_f32 v[52:53], v[96:97], v[98:99]
    v_pk_add_f32 v[54:55], v[100:101], v[102:103]
    v_pk_add_f32 v[52:53], v[52:53], v[104:105]
    v_pk_add_f32 v[52:53], v[52:53], v[54:55]
    v_add_f32 v54, v52, v53
    v_add_f32 v55, v52, v53
    s_nop 1
    v_permlane32_swap_b32 v54, v55
    v_add_f32 v52, v54, v55
    v_add_f32 v53, v54, v55
    s_nop 1
    v_permlane16_swap_b32 v52, v53
    v_add_f32 v52, v52, v53
    v_rcp_f32 v52, v52
    s_nop 3
    v_pk_mul_f32 v[64:65], v[64:65], v[52:53] op_sel_hi:[1,0]
    v_pk_mul_f32 v[66:67], v[66:67], v[52:53] op_sel_hi:[1,0]
    v_pk_mul_f32 v[68:69], v[68:69], v[52:53] op_sel_hi:[1,0]
    v_pk_mul_f32 v[70:71], v[70:71], v[52:53] op_sel_hi:[1,0]
    v_pk_mul_f32 v[72:73], v[72:73], v[52:53] op_sel_hi:[1,0]
    v_pk_mul_f32 v[74:75], v[74:75], v[52:53] op_sel_hi:[1,0]
    v_pk_mul_f32 v[76:77], v[76:77], v[52:53] op_sel_hi:[1,0]
    v_pk_mul_f32 v[78:79], v[78:79], v[52:53] op_sel_hi:[1,0]
    v_cvt_pk_bf16_f32 v80, v64, v65
    v_cvt_pk_bf16_f32 v81, v66, v67
    v_cvt_pk_bf16_f32 v82, v68, v69
    v_cvt_pk_bf16_f32 v83, v70, v71
    v_cvt_pk_bf16_f32 v84, v72, v73
    v_cvt_pk_bf16_f32 v85, v74, v75
    v_cvt_pk_bf16_f32 v86, v76, v77
    v_cvt_pk_bf16_f32 v87, v78, v79
    ds_write_b64 v15, v[80:81] offset:0
    ds_write_b64 v15, v[82:83] offset:32
    ds_write_b64 v15, v[84:85] offset:64
    ds_write_b64 v15, v[86:87] offset:96
    s_waitcnt lgkmcnt(0)
    s_barrier
    ds_read_b128 v[32:35], v16
    ds_read_b128 v[36:39], v16 offset:1088
    s_lshl_b32 s33, s26, 18
    s_lshl_b32 s34, s24, 8
    s_add_u32 s33, s33, s34
    s_add_u32 s33, s33, 0x4000000
    s_add_u32 s34, s33, 0x8000
    s_waitcnt lgkmcnt(0)
    buffer_store_dwordx4 v[32:35], v17, s[20:23], s33 offen sc1
    buffer_store_dwordx4 v[36:39], v17, s[20:23], s34 offen sc1
    s_waitcnt vmcnt(0)
    s_barrier
    s_cmp_lg_u32 s25, 0
    s_cbranch_scc1 Ls_28
    s_mov_b32 s60, s26
    s_lshl_b32 s60, s60, 11
    s_lshl_b32 s61, s59, 2
    s_add_u32 s60, s60, s61
    s_add_u32 s60, s60, 0x410180
    v_mov_b32 v127, 0
    v_mov_b32 v125, 1
    s_mov_b64 exec, 1
    buffer_store_dword v125, v127, s[20:23], s60 offen sc1
    s_mov_b64 exec, -1
Ls_28:
    s_xor_b32 s29, s29, 8192
    s_add_u32 s26, s26, 2
    s_cmp_lt_u32 s26, 64
    s_cbranch_scc1 LR2_loop
    s_waitcnt vmcnt(0)
LR2_exit:
    s_branch L_exit
LR3:
    s_sub_u32 s63, s62, 128
LB_q2:
    s_and_b32 s27, s63, 15
    s_lshr_b32 s26, s63, 4
    s_load_dwordx2 s[4:5], s[0:1], 16
    s_load_dwordx2 s[8:9], s[0:1], 16
    s_waitcnt lgkmcnt(0)
    s_lshl_b32 s44, s27, 1
    s_add_u32 s45, s44, 1
    s_lshl_b32 s40, s44, 8
    s_lshl_b32 s41, s45, 8
    s_lshl_b32 s42, s44, 13
    s_add_u32 s42, s42, 0x3000000
    s_lshl_b32 s43, s45, 13
    s_add_u32 s43, s43, 0x3000000
    s_mov_b32 s6, 0x400000
    s_mov_b32 s7, 0x00020000
    s_mov_b32 s10, 0x400000
    s_mov_b32 s11, 0x00020000
    s_cmp_ge_u32 s26, 64
    s_cbranch_scc1 LR3_exit
    v_and_b32 v9, 15, v2
    v_lshrrev_b32 v10, 4, v2
    v_lshrrev_b32 v8, 1, v9
    v_lshlrev_b32 v11, 1, v10
    v_xor_b32 v8, v8, v11
    v_lshlrev_b32 v8, 5, v8
    s_mov_b32 s33, 8192
    v_mul_lo_u32 v11, v10, s33
    v_add_u32 v8, v8, v11
    v_and_b32 v11, 1, v2
    v_lshl_add_u32 v8, v11, 4, v8
    v_lshrrev_b32 v9, 5, v2
    v_bfe_u32 v10, v2, 2, 2
    v_lshl_add_u32 v9, v9, 3, v10
    v_lshlrev_b32 v9, 8, v9
    v_bfe_u32 v11, v2, 4, 1
    s_lshl_b32 s33, s25, 1
    v_add_u32 v11, s33, v11
    v_lshlrev_b32 v10, 1, v10
    v_xor_b32 v11, v11, v10
    v_lshl_add_u32 v9, v11, 5, v9
    v_and_b32 v11, 3, v2
    v_lshl_add_u32 v9, v11, 3, v9
    s_mul_i32 s30, s25, 131072
    s_lshl_b32 s29, s25, 12
    s_add_u32 m0, s29, 0
    s_add_u32 s33, s30, s40
    s_add_u32 s33, s33, 0
    buffer_load_dwordx4 v8, s[4:7], s33 offen lds
    s_add_u32 m0, s29, 1024
    s_add_u32 s33, s30, s40
    s_add_u32 s33, s33, 32768
    buffer_load_dwordx4 v8, s[4:7], s33 offen lds
    s_add_u32 m0, s29, 2048
    s_add_u32 s33, s30, s40
    s_add_u32 s33, s33, 65536
    buffer_load_dwordx4 v8, s[4:7], s33 offen lds
    s_add_u32 m0, s29, 3072
    s_add_u32 s33, s30, s40
    s_add_u32 s33, s33, 98304
    buffer_load_dwordx4 v8, s[4:7], s33 offen lds
    s_add_u32 m0, s29, 16384
    s_add_u32 s33, s30, s40
    s_add_u32 s33, s33, 524288
    buffer_load_dwordx4 v8, s[4:7], s33 offen lds
    s_add_u32 m0, s29, 17408
    s_add_u32 s33, s30, s40
    s_add_u32 s33, s33, 557056
    buffer_load_dwordx4 v8, s[4:7], s33 offen lds
    s_add_u32 m0, s29, 18432
    s_add_u32 s33, s30, s40
    s_add_u32 s33, s33, 589824
    buffer_load_dwordx4 v8, s[4:7], s33 offen lds
    s_add_u32 m0, s29, 19456
    s_add_u32 s33, s30, s40
    s_add_u32 s33, s33, 622592
    buffer_load_dwordx4 v8, s[4:7], s33 offen lds
    s_add_u32 m0, s29, 32768
    s_add_u32 s33, s30, s40
    s_add_u32 s33, s33, 1048576
    buffer_load_dwordx4 v8, s[4:7], s33 offen lds
    s_add_u32 m0, s29, 33792
    s_add_u32 s33, s30, s40
    s_add_u32 s33, s33, 1081344
    buffer_load_dwordx4 v8, s[4:7], s33 offen lds
    s_add_u32 m0, s29, 34816
    s_add_u32 s33, s30, s40
    s_add_u32 s33, s33, 1114112
    buffer_load_dwordx4 v8, s[4:7], s33 offen lds
    s_add_u32 m0, s29, 35840
    s_add_u32 s33, s30, s40
    s_add_u32 s33, s33, 1146880
    buffer_load_dwordx4 v8, s[4:7], s33 offen lds
    s_add_u32 m0, s29, 49152
    s_add_u32 s33, s30, s40
    s_add_u32 s33, s33, 1572864
    buffer_load_dwordx4 v8, s[4:7], s33 offen lds
    s_add_u32 m0, s29, 50176
    s_add_u32 s33, s30, s40
    s_add_u32 s33, s33, 1605632
    buffer_load_dwordx4 v8, s[4:7], s33 offen lds
    s_add_u32 m0, s29, 51200
    s_add_u32 s33, s30, s40
    s_add_u32 s33, s33, 1638400
    buffer_load_dwordx4 v8, s[4:7], s33 offen lds
    s_add_u32 m0, s29, 52224
    s_add_u32 s33, s30, s40
    s_add_u32 s33, s33, 1671168
    buffer_load_dwordx4 v8, s[4:7], s33 offen lds
    s_add_u32 m0, s29, 65536
    s_add_u32 s33, s30, s40
    s_add_u32 s33, s33, 2097152
    buffer_load_dwordx4 v8, s[4:7], s33 offen lds
    s_add_u32 m0, s29, 66560
    s_add_u32 s33, s30, s40
    s_add_u32 s33, s33, 2129920
    buffer_load_dwordx4 v8, s[4:7], s33 offen lds
    s_add_u32 m0, s29, 67584
    s_add_u32 s33, s30, s40
    s_add_u32 s33, s33, 2162688
    buffer_load_dwordx4 v8, s[4:7], s33 offen lds
    s_add_u32 m0, s29, 68608
    s_add_u32 s33, s30, s40
    s_add_u32 s33, s33, 2195456
    buffer_load_dwordx4 v8, s[4:7], s33 offen lds
    s_add_u32 m0, s29, 81920
    s_add_u32 s33, s30, s40
    s_add_u32 s33, s33, 2621440
    buffer_load_dwordx4 v8, s[4:7], s33 offen lds
    s_add_u32 m0, s29, 82944
    s_add_u32 s33, s30, s40
    s_add_u32 s33, s33, 2654208
    buffer_load_dwordx4 v8, s[4:7], s33 offen lds
    s_add_u32 m0, s29, 83968
    s_add_u32 s33, s30, s40
    s_add_u32 s33, s33, 2686976
    buffer_load_dwordx4 v8, s[4:7], s33 offen lds
    s_add_u32 m0, s29, 84992
    s_add_u32 s33, s30, s40
    s_add_u32 s33, s33, 2719744
    buffer_load_dwordx4 v8, s[4:7], s33 offen lds
    s_add_u32 m0, s29, 98304
    s_add_u32 s33, s30, s40
    s_add_u32 s33, s33, 3145728
    buffer_load_dwordx4 v8, s[4:7], s33 offen lds
    s_add_u32 m0, s29, 99328
    s_add_u32 s33, s30, s40
    s_add_u32 s33, s33, 3178496
    buffer_load_dwordx4 v8, s[4:7], s33 offen lds
    s_add_u32 m0, s29, 100352
    s_add_u32 s33, s30, s40
    s_add_u32 s33, s33, 3211264
    buffer_load_dwordx4 v8, s[4:7], s33 offen lds
    s_add_u32 m0, s29, 101376
    s_add_u32 s33, s30, s40
    s_add_u32 s33, s33, 3244032
    buffer_load_dwordx4 v8, s[4:7], s33 offen lds
    s_add_u32 m0, s29, 114688
    s_add_u32 s33, s30, s40
    s_add_u32 s33, s33, 3670016
    buffer_load_dwordx4 v8, s[4:7], s33 offen lds
    s_add_u32 m0, s29, 115712
    s_add_u32 s33, s30, s40
    s_add_u32 s33, s33, 3702784
    buffer_load_dwordx4 v8, s[4:7], s33 offen lds
    s_add_u32 m0, s29, 116736
    s_add_u32 s33, s30, s40
    s_add_u32 s33, s33, 3735552
    buffer_load_dwordx4 v8, s[4:7], s33 offen lds
    s_add_u32 m0, s29, 117760
    s_add_u32 s33, s30, s40
    s_add_u32 s33, s33, 3768320
    buffer_load_dwordx4 v8, s[4:7], s33 offen lds
    s_waitcnt vmcnt(28)
    s_barrier
    s_add_u32 m0, s29, 131072
    s_add_u32 s33, s30, s41
    s_add_u32 s33, s33, 0
    buffer_load_dwordx4 v8, s[8:11], s33 offen lds
    s_add_u32 m0, s29, 132096
    s_add_u32 s33, s30, s41
    s_add_u32 s33, s33, 32768
    buffer_load_dwordx4 v8, s[8:11], s33 offen lds
    s_add_u32 m0, s29, 133120
    s_add_u32 s33, s30, s41
    s_add_u32 s33, s33, 65536
    buffer_load_dwordx4 v8, s[8:11], s33 offen lds
    s_add_u32 m0, s29, 134144
    s_add_u32 s33, s30, s41
    s_add_u32 s33, s33, 98304
    buffer_load_dwordx4 v8, s[8:11], s33 offen lds
    v_add_u32 v10, 0, v9
    ds_read_b64_tr_b16 a[0:1], v10 offset:0
    ds_read_b64_tr_b16 a[2:3], v10 offset:1024
    ds_read_b64_tr_b16 a[4:5], v10 offset:4096
    ds_read_b64_tr_b16 a[6:7], v10 offset:5120
    ds_read_b64_tr_b16 a[8:9], v10 offset:8192
    ds_read_b64_tr_b16 a[10:11], v10 offset:9216
    ds_read_b64_tr_b16 a[12:13], v10 offset:12288
    ds_read_b64_tr_b16 a[14:15], v10 offset:13312
    s_waitcnt lgkmcnt(0)
    s_waitcnt vmcnt(28)
    s_barrier
    s_add_u32 m0, s29, 0
    s_add_u32 s33, s30, s41
    s_add_u32 s33, s33, 524288
    buffer_load_dwordx4 v8, s[8:11], s33 offen lds
    s_add_u32 m0, s29, 1024
    s_add_u32 s33, s30, s41
    s_add_u32 s33, s33, 557056
    buffer_load_dwordx4 v8, s[8:11], s33 offen lds
    s_add_u32 m0, s29, 2048
    s_add_u32 s33, s30, s41
    s_add_u32 s33, s33, 589824
    buffer_load_dwordx4 v8, s[8:11], s33 offen lds
    s_add_u32 m0, s29, 3072
    s_add_u32 s33, s30, s41
    s_add_u32 s33, s33, 622592
    buffer_load_dwordx4 v8, s[8:11], s33 offen lds
    v_add_u32 v10, 16384, v9
    ds_read_b64_tr_b16 a[16:17], v10 offset:0
    ds_read_b64_tr_b16 a[18:19], v10 offset:1024
    ds_read_b64_tr_b16 a[20:21], v10 offset:4096
    ds_read_b64_tr_b16 a[22:23], v10 offset:5120
    ds_read_b64_tr_b16 a[24:25], v10 offset:8192
    ds_read_b64_tr_b16 a[26:27], v10 offset:9216
    ds_read_b64_tr_b16 a[28:29], v10 offset:12288
    ds_read_b64_tr_b16 a[30:31], v10 offset:13312
    s_waitcnt lgkmcnt(0)
    s_waitcnt vmcnt(28)
    s_barrier
    s_add_u32 m0, s29, 16384
    s_add_u32 s33, s30, s41
    s_add_u32 s33, s33, 1048576
    buffer_load_dwordx4 v8, s[8:11], s33 offen lds
    s_add_u32 m0, s29, 17408
    s_add_u32 s33, s30, s41
    s_add_u32 s33, s33, 1081344
    buffer_load_dwordx4 v8, s[8:11], s33 offen lds
    s_add_u32 m0, s29, 18432
    s_add_u32 s33, s30, s41
    s_add_u32 s33, s33, 1114112
    buffer_load_dwordx4 v8, s[8:11], s33 offen lds
    s_add_u32 m0, s29, 19456
    s_add_u32 s33, s30, s41
    s_add_u32 s33, s33, 1146880
    buffer_load_dwordx4 v8, s[8:11], s33 offen lds
    v_add_u32 v10, 32768, v9
    ds_read_b64_tr_b16 a[32:33], v10 offset:0
    ds_read_b64_tr_b16 a[34:35], v10 offset:1024
    ds_read_b64_tr_b16 a[36:37], v10 offset:4096
    ds_read_b64_tr_b16 a[38:39], v10 offset:5120
    ds_read_b64_tr_b16 a[40:41], v10 offset:8192
    ds_read_b64_tr_b16 a[42:43], v10 offset:9216
    ds_read_b64_tr_b16 a[44:45], v10 offset:12288
    ds_read_b64_tr_b16 a[46:47], v10 offset:13312
    s_waitcnt lgkmcnt(0)
    s_waitcnt vmcnt(28)
    s_barrier
    s_add_u32 m0, s29, 32768
    s_add_u32 s33, s30, s41
    s_add_u32 s33, s33, 1572864
    buffer_load_dwordx4 v8, s[8:11], s33 offen lds
    s_add_u32 m0, s29, 33792
    s_add_u32 s33, s30, s41
    s_add_u32 s33, s33, 1605632
    buffer_load_dwordx4 v8, s[8:11], s33 offen lds
    s_add_u32 m0, s29, 34816
    s_add_u32 s33, s30, s41
    s_add_u32 s33, s33, 1638400
    buffer_load_dwordx4 v8, s[8:11], s33 offen lds
    s_add_u32 m0, s29, 35840
    s_add_u32 s33, s30, s41
    s_add_u32 s33, s33, 1671168
    buffer_load_dwordx4 v8, s[8:11], s33 offen lds
    v_add_u32 v10, 49152, v9
    ds_read_b64_tr_b16 a[48:49], v10 offset:0
    ds_read_b64_tr_b16 a[50:51], v10 offset:1024
    ds_read_b64_tr_b16 a[52:53], v10 offset:4096
    ds_read_b64_tr_b16 a[54:55], v10 offset:5120
    ds_read_b64_tr_b16 a[56:57], v10 offset:8192
    ds_read_b64_tr_b16 a[58:59], v10 offset:9216
    ds_read_b64_tr_b16 a[60:61], v10 offset:12288
    ds_read_b64_tr_b16 a[62:63], v10 offset:13312
    s_waitcnt lgkmcnt(0)
    s_waitcnt vmcnt(28)
    s_barrier
    s_add_u32 m0, s29, 49152
    s_add_u32 s33, s30, s41
    s_add_u32 s33, s33, 2097152
    buffer_load_dwordx4 v8, s[8:11], s33 offen lds
    s_add_u32 m0, s29, 50176
    s_add_u32 s33, s30, s41
    s_add_u32 s33, s33, 2129920
    buffer_load_dwordx4 v8, s[8:11], s33 offen lds
    s_add_u32 m0, s29, 51200
    s_add_u32 s33, s30, s41
    s_add_u32 s33, s33, 2162688
    buffer_load_dwordx4 v8, s[8:11], s33 offen lds
    s_add_u32 m0, s29, 52224
    s_add_u32 s33, s30, s41
    s_add_u32 s33, s33, 2195456
    buffer_load_dwordx4 v8, s[8:11], s33 offen lds
    v_add_u32 v10, 65536, v9
    ds_read_b64_tr_b16 a[64:65], v10 offset:0
    ds_read_b64_tr_b16 a[66:67], v10 offset:1024
    ds_read_b64_tr_b16 a[68:69], v10 offset:4096
    ds_read_b64_tr_b16 a[70:71], v10 offset:5120
    ds_read_b64_tr_b16 a[72:73], v10 offset:8192
    ds_read_b64_tr_b16 a[74:75], v10 offset:9216
    ds_read_b64_tr_b16 a[76:77], v10 offset:12288
    ds_read_b64_tr_b16 a[78:79], v10 offset:13312
    s_waitcnt lgkmcnt(0)
    s_waitcnt vmcnt(28)
    s_barrier
    s_add_u32 m0, s29, 65536
    s_add_u32 s33, s30, s41
    s_add_u32 s33, s33, 2621440
    buffer_load_dwordx4 v8, s[8:11], s33 offen lds
    s_add_u32 m0, s29, 66560
    s_add_u32 s33, s30, s41
    s_add_u32 s33, s33, 2654208
    buffer_load_dwordx4 v8, s[8:11], s33 offen lds
    s_add_u32 m0, s29, 67584
    s_add_u32 s33, s30, s41
    s_add_u32 s33, s33, 2686976
    buffer_load_dwordx4 v8, s[8:11], s33 offen lds
    s_add_u32 m0, s29, 68608
    s_add_u32 s33, s30, s41
    s_add_u32 s33, s33, 2719744
    buffer_load_dwordx4 v8, s[8:11], s33 offen lds
    v_add_u32 v10, 81920, v9
    ds_read_b64_tr_b16 a[80:81], v10 offset:0
    ds_read_b64_tr_b16 a[82:83], v10 offset:1024
    ds_read_b64_tr_b16 a[84:85], v10 offset:4096
    ds_read_b64_tr_b16 a[86:87], v10 offset:5120
    ds_read_b64_tr_b16 a[88:89], v10 offset:8192
    ds_read_b64_tr_b16 a[90:91], v10 offset:9216
    ds_read_b64_tr_b16 a[92:93], v10 offset:12288
    ds_read_b64_tr_b16 a[94:95], v10 offset:13312
    s_waitcnt lgkmcnt(0)
    s_waitcnt vmcnt(28)
    s_barrier
    s_add_u32 m0, s29, 81920
    s_add_u32 s33, s30, s41
    s_add_u32 s33, s33, 3145728
    buffer_load_dwordx4 v8, s[8:11], s33 offen lds
    s_add_u32 m0, s29, 82944
    s_add_u32 s33, s30, s41
    s_add_u32 s33, s33, 3178496
    buffer_load_dwordx4 v8, s[8:11], s33 offen lds
    s_add_u32 m0, s29, 83968
    s_add_u32 s33, s30, s41
    s_add_u32 s33, s33, 3211264
    buffer_load_dwordx4 v8, s[8:11], s33 offen lds
    s_add_u32 m0, s29, 84992
    s_add_u32 s33, s30, s41
    s_add_u32 s33, s33, 3244032
    buffer_load_dwordx4 v8, s[8:11], s33 offen lds
    v_add_u32 v10, 98304, v9
    ds_read_b64_tr_b16 a[96:97], v10 offset:0
    ds_read_b64_tr_b16 a[98:99], v10 offset:1024
    ds_read_b64_tr_b16 a[100:101], v10 offset:4096
    ds_read_b64_tr_b16 a[102:103], v10 offset:5120
    ds_read_b64_tr_b16 a[104:105], v10 offset:8192
    ds_read_b64_tr_b16 a[106:107], v10 offset:9216
    ds_read_b64_tr_b16 a[108:109], v10 offset:12288
    ds_read_b64_tr_b16 a[110:111], v10 offset:13312
    s_waitcnt lgkmcnt(0)
    s_waitcnt vmcnt(28)
    s_barrier
    s_add_u32 m0, s29, 98304
    s_add_u32 s33, s30, s41
    s_add_u32 s33, s33, 3670016
    buffer_load_dwordx4 v8, s[8:11], s33 offen lds
    s_add_u32 m0, s29, 99328
    s_add_u32 s33, s30, s41
    s_add_u32 s33, s33, 3702784
    buffer_load_dwordx4 v8, s[8:11], s33 offen lds
    s_add_u32 m0, s29, 100352
    s_add_u32 s33, s30, s41
    s_add_u32 s33, s33, 3735552
    buffer_load_dwordx4 v8, s[8:11], s33 offen lds
    s_add_u32 m0, s29, 101376
    s_add_u32 s33, s30, s41
    s_add_u32 s33, s33, 3768320
    buffer_load_dwordx4 v8, s[8:11], s33 offen lds
    v_add_u32 v10, 114688, v9
    ds_read_b64_tr_b16 a[112:113], v10 offset:0
    ds_read_b64_tr_b16 a[114:115], v10 offset:1024
    ds_read_b64_tr_b16 a[116:117], v10 offset:4096
    ds_read_b64_tr_b16 a[118:119], v10 offset:5120
    ds_read_b64_tr_b16 a[120:121], v10 offset:8192
    ds_read_b64_tr_b16 a[122:123], v10 offset:9216
    ds_read_b64_tr_b16 a[124:125], v10 offset:12288
    ds_read_b64_tr_b16 a[126:127], v10 offset:13312
    s_waitcnt lgkmcnt(0)
    s_waitcnt vmcnt(28)
    s_barrier
    v_add_u32 v10, 131072, v9
    ds_read_b64_tr_b16 a[128:129], v10 offset:0
    ds_read_b64_tr_b16 a[130:131], v10 offset:1024
    ds_read_b64_tr_b16 a[132:133], v10 offset:4096
    ds_read_b64_tr_b16 a[134:135], v10 offset:5120
    ds_read_b64_tr_b16 a[136:137], v10 offset:8192
    ds_read_b64_tr_b16 a[138:139], v10 offset:9216
    ds_read_b64_tr_b16 a[140:141], v10 offset:12288
    ds_read_b64_tr_b16 a[142:143], v10 offset:13312
    s_waitcnt lgkmcnt(0)
    s_waitcnt vmcnt(24)
    s_barrier
    v_add_u32 v10, 0, v9
    ds_read_b64_tr_b16 a[144:145], v10 offset:0
    ds_read_b64_tr_b16 a[146:147], v10 offset:1024
    ds_read_b64_tr_b16 a[148:149], v10 offset:4096
    ds_read_b64_tr_b16 a[150:151], v10 offset:5120
    ds_read_b64_tr_b16 a[152:153], v10 offset:8192
    ds_read_b64_tr_b16 a[154:155], v10 offset:9216
    ds_read_b64_tr_b16 a[156:157], v10 offset:12288
    ds_read_b64_tr_b16 a[158:159], v10 offset:13312
    s_waitcnt lgkmcnt(0)
    s_waitcnt vmcnt(20)
    s_barrier
    v_add_u32 v10, 16384, v9
    ds_read_b64_tr_b16 a[160:161], v10 offset:0
    ds_read_b64_tr_b16 a[162:163], v10 offset:1024
    ds_read_b64_tr_b16 a[164:165], v10 offset:4096
    ds_read_b64_tr_b16 a[166:167], v10 offset:5120
    ds_read_b64_tr_b16 a[168:169], v10 offset:8192
    ds_read_b64_tr_b16 a[170:171], v10 offset:9216
    ds_read_b64_tr_b16 a[172:173], v10 offset:12288
    ds_read_b64_tr_b16 a[174:175], v10 offset:13312
    s_waitcnt lgkmcnt(0)
    s_waitcnt vmcnt(16)
    s_barrier
    v_add_u32 v10, 32768, v9
    ds_read_b64_tr_b16 a[176:177], v10 offset:0
    ds_read_b64_tr_b16 a[178:179], v10 offset:1024
    ds_read_b64_tr_b16 a[180:181], v10 offset:4096
    ds_read_b64_tr_b16 a[182:183], v10 offset:5120
    ds_read_b64_tr_b16 a[184:185], v10 offset:8192
    ds_read_b64_tr_b16 a[186:187], v10 offset:9216
    ds_read_b64_tr_b16 a[188:189], v10 offset:12288
    ds_read_b64_tr_b16 a[190:191], v10 offset:13312
    s_waitcnt lgkmcnt(0)
    s_waitcnt vmcnt(12)
    s_barrier
    v_add_u32 v10, 49152, v9
    ds_read_b64_tr_b16 a[192:193], v10 offset:0
    ds_read_b64_tr_b16 a[194:195], v10 offset:1024
    ds_read_b64_tr_b16 a[196:197], v10 offset:4096
    ds_read_b64_tr_b16 a[198:199], v10 offset:5120
    ds_read_b64_tr_b16 a[200:201], v10 offset:8192
    ds_read_b64_tr_b16 a[202:203], v10 offset:9216
    ds_read_b64_tr_b16 a[204:205], v10 offset:12288
    ds_read_b64_tr_b16 a[206:207], v10 offset:13312
    s_waitcnt lgkmcnt(0)
    s_waitcnt vmcnt(8)
    s_barrier
    v_add_u32 v10, 65536, v9
    ds_read_b64_tr_b16 a[208:209], v10 offset:0
    ds_read_b64_tr_b16 a[210:211], v10 offset:1024
    ds_read_b64_tr_b16 a[212:213], v10 offset:4096
    ds_read_b64_tr_b16 a[214:215], v10 offset:5120
    ds_read_b64_tr_b16 a[216:217], v10 offset:8192
    ds_read_b64_tr_b16 a[218:219], v10 offset:9216
    ds_read_b64_tr_b16 a[220:221], v10 offset:12288
    ds_read_b64_tr_b16 a[222:223], v10 offset:13312
    s_waitcnt lgkmcnt(0)
    s_waitcnt vmcnt(4)
    s_barrier
    v_add_u32 v10, 81920, v9
    ds_read_b64_tr_b16 a[224:225], v10 offset:0
    ds_read_b64_tr_b16 a[226:227], v10 offset:1024
    ds_read_b64_tr_b16 a[228:229], v10 offset:4096
    ds_read_b64_tr_b16 a[230:231], v10 offset:5120
    ds_read_b64_tr_b16 a[232:233], v10 offset:8192
    ds_read_b64_tr_b16 a[234:235], v10 offset:9216
    ds_read_b64_tr_b16 a[236:237], v10 offset:12288
    ds_read_b64_tr_b16 a[238:239], v10 offset:13312
    s_waitcnt lgkmcnt(0)
    s_waitcnt vmcnt(0)
    s_barrier
    v_add_u32 v10, 98304, v9
    ds_read_b64_tr_b16 a[240:241], v10 offset:0
    ds_read_b64_tr_b16 a[242:243], v10 offset:1024
    ds_read_b64_tr_b16 a[244:245], v10 offset:4096
    ds_read_b64_tr_b16 a[246:247], v10 offset:5120
    ds_read_b64_tr_b16 a[248:249], v10 offset:8192
    ds_read_b64_tr_b16 a[250:251], v10 offset:9216
    ds_read_b64_tr_b16 a[252:253], v10 offset:12288
    ds_read_b64_tr_b16 a[254:255], v10 offset:13312
    s_waitcnt lgkmcnt(0)
    s_load_dwordx2 s[64:65], s[0:1], 88
    v_mov_b32 v125, 0
    s_mov_b32 s61, 0
    s_waitcnt lgkmcnt(0)
Lwi_29:
    global_load_dword v126, v125, s[64:65] offset:40 sc1
    s_add_u32 s61, s61, 1
    s_cmp_gt_u32 s61, 2000000
    s_cbranch_scc1 L_fail
    s_waitcnt vmcnt(0)
    v_cmp_gt_u32 vcc, 64, v126
    s_cbranch_vccz Lwi_29_ok
    s_sleep 4
    s_branch Lwi_29
Lwi_29_ok:
    s_barrier
    v_lshlrev_b32 v3, 4, v2
    v_and_b32 v4, 31, v2
    s_movk_i32 s33, 1040
    v_mul_lo_u32 v4, v4, s33
    v_lshrrev_b32 v5, 5, v2
    v_lshl_add_u32 v4, v5, 4, v4
    v_and_b32 v6, 31, v2
    s_movk_i32 s33, 272
    v_mul_lo_u32 v6, v6, s33
    v_lshl_add_u32 v6, v5, 3, v6
    s_lshl_b32 s33, s25, 6
    s_add_u32 s33, s33, 66560
    v_add_u32 v6, s33, v6
    v_lshrrev_b32 v7, 4, v2
    s_lshl_b32 s33, s25, 3
    v_add_u32 v7, s33, v7
    v_and_b32 v8, 15, v2
    s_movk_i32 s33, 272
    v_mul_lo_u32 v9, v7, s33
    v_lshl_add_u32 v9, v8, 4, v9
    v_add_u32 v9, 66560, v9
    s_mov_b32 s33, 256
    v_mul_lo_u32 v10, v7, s33
    v_lshl_add_u32 v10, v8, 4, v10
    s_mov_b32 s67, 0
    s_mov_b32 s66, 0
    s_mov_b32 s35, 0
    s_mov_b32 s38, 0
    s_mov_b32 s31, s26
    s_mov_b32 s37, -1
    s_mov_b32 s39, -1
    s_lshr_b32 s60, s31, 4
    s_lshl_b32 s60, s60, 2
    s_add_u32 s60, s60, 48
    v_mov_b32 v125, s60
    s_and_b32 s60, s31, 15
    s_lshl_b32 s60, s60, 1
    s_lshl_b32 s60, 3, s60
    s_mov_b32 s61, 0
Lwx_30:
    global_load_dword v126, v125, s[64:65] sc1
    s_add_u32 s61, s61, 1
    s_cmp_gt_u32 s61, 2000000
    s_cbranch_scc1 L_fail
    s_waitcnt vmcnt(0)
    v_and_b32 v126, s60, v126
    v_cmp_ne_u32 vcc, s60, v126
    s_cbranch_vccz Lwx_30_ok
    s_sleep 2
    s_branch Lwx_30
Lwx_30_ok:
    s_lshl_b32 s33, s31, 5
    s_lshl_b32 s34, s25, 3
    s_add_u32 s33, s33, s34
    s_lshl_b32 s33, s33, 10
    s_add_u32 s33, s33, 0x0
    s_mul_i32 s34, s34, 1040
    s_add_u32 s34, s34, s35
    s_add_u32 m0, s34, 0
    s_nop 0
    buffer_load_dwordx4 v3, s[20:23], s33 offen sc1 lds
    s_add_u32 m0, s34, 1040
    s_add_u32 s33, s33, 1024
    buffer_load_dwordx4 v3, s[20:23], s33 offen sc1 lds
    s_add_u32 m0, s34, 2080
    s_add_u32 s33, s33, 1024
    buffer_load_dwordx4 v3, s[20:23], s33 offen sc1 lds
    s_add_u32 m0, s34, 3120
    s_add_u32 s33, s33, 1024
    buffer_load_dwordx4 v3, s[20:23], s33 offen sc1 lds
    s_add_u32 m0, s34, 4160
    s_add_u32 s33, s33, 1024
    buffer_load_dwordx4 v3, s[20:23], s33 offen sc1 lds
    s_add_u32 m0, s34, 5200
    s_add_u32 s33, s33, 1024
    buffer_load_dwordx4 v3, s[20:23], s33 offen sc1 lds
    s_add_u32 m0, s34, 6240
    s_add_u32 s33, s33, 1024
    buffer_load_dwordx4 v3, s[20:23], s33 offen sc1 lds
    s_add_u32 m0, s34, 7280
    s_add_u32 s33, s33, 1024
    buffer_load_dwordx4 v3, s[20:23], s33 offen sc1 lds
LR3_loop:
    s_waitcnt vmcnt(0) lgkmcnt(0)
    s_barrier
    s_xor_b32 s36, s35, 33280
    s_add_u32 s31, s26, 1
    s_min_u32 s31, s31, 63
    s_cmp_eq_u32 s67, 1
    s_cbranch_scc1 Lx_31
    s_lshr_b32 s60, s31, 4
    s_lshl_b32 s60, s60, 2
    s_add_u32 s60, s60, 48
    v_mov_b32 v125, s60
    s_and_b32 s60, s31, 15
    s_lshl_b32 s60, s60, 1
    s_lshl_b32 s60, 3, s60
    s_mov_b32 s61, 0
Lwx_32:
    global_load_dword v126, v125, s[64:65] sc1
    s_add_u32 s61, s61, 1
    s_cmp_gt_u32 s61, 2000000
    s_cbranch_scc1 L_fail
    s_waitcnt vmcnt(0)
    v_and_b32 v126, s60, v126
    v_cmp_ne_u32 vcc, s60, v126
    s_cbranch_vccz Lwx_32_ok
    s_sleep 2
    s_branch Lwx_32
Lwx_32_ok:
    s_cmp_ge_u32 s31, 2
    s_cselect_b32 s67, 1, 0
    s_cbranch_scc0 Lx_31
    v_lshlrev_b32 v125, 2, v2
    v_add_u32 v125, 48, v125
    s_mov_b32 s61, 0
Lwa_33:
    global_load_dword v126, v125, s[64:65] sc1
    s_add_u32 s61, s61, 1
    s_cmp_gt_u32 s61, 2000000
    s_cbranch_scc1 L_fail
    s_waitcnt vmcnt(0)
    v_cmp_ne_u32 vcc, -1, v126
    s_and_b32 vcc_lo, vcc_lo, 15
    s_cbranch_scc0 Lwa_33_ok
    s_sleep 2
    s_branch Lwa_33
Lwa_33_ok:
Lx_31:
    v_add_u32 v11, s35, v4
    ds_read_b128 v[32:35], v11 offset:0
    ds_read_b128 v[36:39], v11 offset:32
    ds_read_b128 v[40:43], v11 offset:64
    ds_read_b128 v[44:47], v11 offset:96
    s_xor_b32 s56, s38, 17408
    v_add_u32 v12, s56, v9
    s_cmp_eq_u32 s39, -1
    s_cbranch_scc1 Lp_34
    s_cmp_lg_u32 s25, 0
    s_cbranch_scc1 Lf_35
    s_mov_b32 s60, s39
    s_lshl_b32 s60, s60, 11
    s_lshl_b32 s61, s44, 2
    s_add_u32 s60, s60, s61
    s_add_u32 s60, s60, 0x410100
    v_mov_b32 v127, 0
    v_mov_b32 v125, 1
    s_mov_b64 exec, 1
    buffer_store_dword v125, v127, s[20:23], s60 offen sc1
    s_mov_b64 exec, -1
Lf_35:
    s_cmp_lg_u32 s25, 0
    s_cbranch_scc1 Lf_36
    s_mov_b32 s60, s39
    s_lshl_b32 s60, s60, 11
    s_lshl_b32 s61, s45, 2
    s_add_u32 s60, s60, s61
    s_add_u32 s60, s60, 0x410100
    v_mov_b32 v127, 0
    v_mov_b32 v125, 1
    s_mov_b64 exec, 1
    buffer_store_dword v125, v127, s[20:23], s60 offen sc1
    s_mov_b64 exec, -1
Lf_36:
Lp_34:
    s_waitcnt lgkmcnt(3)
    v_mfma_f32_32x32x16_bf16 v[64:79], a[0:3], v[32:35], 0
    ds_read_b128 v[48:51], v11 offset:128
    s_lshl_b32 s33, s31, 5
    s_lshl_b32 s34, s25, 3
    s_add_u32 s33, s33, s34
    v_mfma_f32_32x32x16_bf16 v[80:95], a[128:131], v[32:35], 0
    s_lshl_b32 s33, s33, 10
    s_add_u32 s33, s33, 0x0
    s_mul_i32 s34, s34, 1040
    s_waitcnt lgkmcnt(3)
    v_mfma_f32_32x32x16_bf16 v[64:79], a[4:7], v[36:39], v[64:79]
    ds_read_b128 v[32:35], v11 offset:160
    s_add_u32 s34, s34, s36
    s_add_u32 m0, s34, 0
    s_nop 0
    v_mfma_f32_32x32x16_bf16 v[80:95], a[132:135], v[36:39], v[80:95]
    buffer_load_dwordx4 v3, s[20:23], s33 offen sc1 lds
    s_add_u32 m0, s34, 1040
    s_add_u32 s33, s33, 1024
    s_waitcnt lgkmcnt(3)
    v_mfma_f32_32x32x16_bf16 v[64:79], a[8:11], v[40:43], v[64:79]
    ds_read_b128 v[36:39], v11 offset:192
    buffer_load_dwordx4 v3, s[20:23], s33 offen sc1 lds
    s_add_u32 m0, s34, 2080
    s_add_u32 s33, s33, 1024
    v_mfma_f32_32x32x16_bf16 v[80:95], a[136:139], v[40:43], v[80:95]
    buffer_load_dwordx4 v3, s[20:23], s33 offen sc1 lds
    s_add_u32 m0, s34, 3120
    s_add_u32 s33, s33, 1024
    s_waitcnt lgkmcnt(3)
    v_mfma_f32_32x32x16_bf16 v[64:79], a[12:15], v[44:47], v[64:79]
    ds_read_b128 v[40:43], v11 offset:224
    buffer_load_dwordx4 v3, s[20:23], s33 offen sc1 lds
    s_add_u32 m0, s34, 4160
    s_add_u32 s33, s33, 1024
    v_mfma_f32_32x32x16_bf16 v[80:95], a[140:143], v[44:47], v[80:95]
    buffer_load_dwordx4 v3, s[20:23], s33 offen sc1 lds
    s_add_u32 m0, s34, 5200
    s_add_u32 s33, s33, 1024
    s_waitcnt lgkmcnt(3)
    v_mfma_f32_32x32x16_bf16 v[64:79], a[16:19], v[48:51], v[64:79]
    ds_read_b128 v[44:47], v11 offset:256
    buffer_load_dwordx4 v3, s[20:23], s33 offen sc1 lds
    s_add_u32 m0, s34, 6240
    s_add_u32 s33, s33, 1024
    v_mfma_f32_32x32x16_bf16 v[80:95], a[144:147], v[48:51], v[80:95]
    buffer_load_dwordx4 v3, s[20:23], s33 offen sc1 lds
    s_add_u32 m0, s34, 7280
    s_add_u32 s33, s33, 1024
    s_waitcnt lgkmcnt(3)
    v_mfma_f32_32x32x16_bf16 v[64:79], a[20:23], v[32:35], v[64:79]
    ds_read_b128 v[48:51], v11 offset:288
    buffer_load_dwordx4 v3, s[20:23], s33 offen sc1 lds
    v_mfma_f32_32x32x16_bf16 v[80:95], a[148:151], v[32:35], v[80:95]
    s_waitcnt lgkmcnt(3)
    v_mfma_f32_32x32x16_bf16 v[64:79], a[24:27], v[36:39], v[64:79]
    ds_read_b128 v[32:35], v11 offset:320
    v_mfma_f32_32x32x16_bf16 v[80:95], a[152:155], v[36:39], v[80:95]
    ds_read_b128 v[112:115], v12 offset:0
    ds_read_b128 v[116:119], v12 offset:1088
    ds_read_b128 v[120:123], v12 offset:8704
    ds_read_b128 v[124:127], v12 offset:9792
    s_waitcnt lgkmcnt(7)
    v_mfma_f32_32x32x16_bf16 v[64:79], a[28:31], v[40:43], v[64:79]
    ds_read_b128 v[36:39], v11 offset:352
    v_mfma_f32_32x32x16_bf16 v[80:95], a[156:159], v[40:43], v[80:95]
    s_waitcnt lgkmcnt(7)
    v_mfma_f32_32x32x16_bf16 v[64:79], a[32:35], v[44:47], v[64:79]
    ds_read_b128 v[40:43], v11 offset:384
    v_mfma_f32_32x32x16_bf16 v[80:95], a[160:163], v[44:47], v[80:95]
    s_waitcnt lgkmcnt(7)
    v_mfma_f32_32x32x16_bf16 v[64:79], a[36:39], v[48:51], v[64:79]
    ds_read_b128 v[44:47], v11 offset:416
    v_mfma_f32_32x32x16_bf16 v[80:95], a[164:167], v[48:51], v[80:95]
    s_waitcnt lgkmcnt(7)
    v_mfma_f32_32x32x16_bf16 v[64:79], a[40:43], v[32:35], v[64:79]
    ds_read_b128 v[48:51], v11 offset:448
    v_mfma_f32_32x32x16_bf16 v[80:95], a[168:171], v[32:35], v[80:95]
    s_waitcnt lgkmcnt(3)
    v_mfma_f32_32x32x16_bf16 v[64:79], a[44:47], v[36:39], v[64:79]
    ds_read_b128 v[32:35], v11 offset:480
    v_mfma_f32_32x32x16_bf16 v[80:95], a[172:175], v[36:39], v[80:95]
    s_waitcnt lgkmcnt(3)
    v_mfma_f32_32x32x16_bf16 v[64:79], a[48:51], v[40:43], v[64:79]
    ds_read_b128 v[36:39], v11 offset:512
    v_mfma_f32_32x32x16_bf16 v[80:95], a[176:179], v[40:43], v[80:95]
    s_cmp_eq_u32 s37, -1
    s_cbranch_scc1 Ls_37
    s_mul_i32 s57, s37, 262144
    s_add_u32 s57, s57, s42
    buffer_store_dwordx4 v[112:115], v10, s[20:23], s57 offen sc1
    s_add_u32 s57, s57, 1024
    buffer_store_dwordx4 v[116:119], v10, s[20:23], s57 offen sc1
    s_mul_i32 s57, s37, 262144
    s_add_u32 s57, s57, s43
    buffer_store_dwordx4 v[120:123], v10, s[20:23], s57 offen sc1
    s_add_u32 s57, s57, 1024
    buffer_store_dwordx4 v[124:127], v10, s[20:23], s57 offen sc1
Ls_37:
    s_waitcnt lgkmcnt(3)
    v_mfma_f32_32x32x16_bf16 v[64:79], a[52:55], v[44:47], v[64:79]
    ds_read_b128 v[40:43], v11 offset:544
    v_mfma_f32_32x32x16_bf16 v[80:95], a[180:183], v[44:47], v[80:95]
    s_waitcnt lgkmcnt(3)
    v_mfma_f32_32x32x16_bf16 v[64:79], a[56:59], v[48:51], v[64:79]
    ds_read_b128 v[44:47], v11 offset:576
    v_mfma_f32_32x32x16_bf16 v[80:95], a[184:187], v[48:51], v[80:95]
    s_waitcnt lgkmcnt(3)
    v_mfma_f32_32x32x16_bf16 v[64:79], a[60:63], v[32:35], v[64:79]
    ds_read_b128 v[48:51], v11 offset:608
    v_mfma_f32_32x32x16_bf16 v[80:95], a[188:191], v[32:35], v[80:95]
    s_waitcnt lgkmcnt(3)
    v_mfma_f32_32x32x16_bf16 v[64:79], a[64:67], v[36:39], v[64:79]
    ds_read_b128 v[32:35], v11 offset:640
    v_mfma_f32_32x32x16_bf16 v[80:95], a[192:195], v[36:39], v[80:95]
    s_waitcnt lgkmcnt(3)
    v_mfma_f32_32x32x16_bf16 v[64:79], a[68:71], v[40:43], v[64:79]
    ds_read_b128 v[36:39], v11 offset:672
    v_mfma_f32_32x32x16_bf16 v[80:95], a[196:199], v[40:43], v[80:95]
    s_waitcnt lgkmcnt(3)
    v_mfma_f32_32x32x16_bf16 v[64:79], a[72:75], v[44:47], v[64:79]
    ds_read_b128 v[40:43], v11 offset:704
    v_mfma_f32_32x32x16_bf16 v[80:95], a[200:203], v[44:47], v[80:95]
    s_waitcnt lgkmcnt(3)
    v_mfma_f32_32x32x16_bf16 v[64:79], a[76:79], v[48:51], v[64:79]
    ds_read_b128 v[44:47], v11 offset:736
    v_mfma_f32_32x32x16_bf16 v[80:95], a[204:207], v[48:51], v[80:95]
    s_waitcnt lgkmcnt(3)
    v_mfma_f32_32x32x16_bf16 v[64:79], a[80:83], v[32:35], v[64:79]
    ds_read_b128 v[48:51], v11 offset:768
    v_mfma_f32_32x32x16_bf16 v[80:95], a[208:211], v[32:35], v[80:95]
    s_waitcnt lgkmcnt(3)
    v_mfma_f32_32x32x16_bf16 v[64:79], a[84:87], v[36:39], v[64:79]
    ds_read_b128 v[32:35], v11 offset:800
    v_mfma_f32_32x32x16_bf16 v[80:95], a[212:215], v[36:39], v[80:95]
    s_waitcnt lgkmcnt(3)
    v_mfma_f32_32x32x16_bf16 v[64:79], a[88:91], v[40:43], v[64:79]
    ds_read_b128 v[36:39], v11 offset:832
    v_mfma_f32_32x32x16_bf16 v[80:95], a[216:219], v[40:43], v[80:95]
    s_waitcnt lgkmcnt(3)
    v_mfma_f32_32x32x16_bf16 v[64:79], a[92:95], v[44:47], v[64:79]
    ds_read_b128 v[40:43], v11 offset:864
    v_mfma_f32_32x32x16_bf16 v[80:95], a[220:223], v[44:47], v[80:95]
    s_waitcnt lgkmcnt(3)
    v_mfma_f32_32x32x16_bf16 v[64:79], a[96:99], v[48:51], v[64:79]
    ds_read_b128 v[44:47], v11 offset:896
    v_mfma_f32_32x32x16_bf16 v[80:95], a[224:227], v[48:51], v[80:95]
    s_waitcnt lgkmcnt(3)
    v_mfma_f32_32x32x16_bf16 v[64:79], a[100:103], v[32:35], v[64:79]
    ds_read_b128 v[48:51], v11 offset:928
    v_mfma_f32_32x32x16_bf16 v[80:95], a[228:231], v[32:35], v[80:95]
    s_waitcnt lgkmcnt(3)
    v_mfma_f32_32x32x16_bf16 v[64:79], a[104:107], v[36:39], v[64:79]
    ds_read_b128 v[32:35], v11 offset:960
    v_mfma_f32_32x32x16_bf16 v[80:95], a[232:235], v[36:39], v[80:95]
    s_waitcnt lgkmcnt(3)
    v_mfma_f32_32x32x16_bf16 v[64:79], a[108:111], v[40:43], v[64:79]
    ds_read_b128 v[36:39], v11 offset:992
    v_mfma_f32_32x32x16_bf16 v[80:95], a[236:239], v[40:43], v[80:95]
    s_waitcnt lgkmcnt(3)
    v_mfma_f32_32x32x16_bf16 v[64:79], a[112:115], v[44:47], v[64:79]
    v_mfma_f32_32x32x16_bf16 v[80:95], a[240:243], v[44:47], v[80:95]
    s_waitcnt lgkmcnt(2)
    v_mfma_f32_32x32x16_bf16 v[64:79], a[116:119], v[48:51], v[64:79]
    v_mfma_f32_32x32x16_bf16 v[80:95], a[244:247], v[48:51], v[80:95]
    s_waitcnt lgkmcnt(1)
    v_mfma_f32_32x32x16_bf16 v[64:79], a[120:123], v[32:35], v[64:79]
    v_mfma_f32_32x32x16_bf16 v[80:95], a[248:251], v[32:35], v[80:95]
    s_waitcnt lgkmcnt(0)
    v_mfma_f32_32x32x16_bf16 v[64:79], a[124:127], v[36:39], v[64:79]
    v_mfma_f32_32x32x16_bf16 v[80:95], a[252:255], v[36:39], v[80:95]
    s_nop 7
    s_nop 3
    v_add_u32 v12, s38, v6
    v_cvt_pk_bf16_f32 v96, v64, v65
    v_cvt_pk_bf16_f32 v97, v66, v67
    v_cvt_pk_bf16_f32 v98, v68, v69
    v_cvt_pk_bf16_f32 v99, v70, v71
    v_cvt_pk_bf16_f32 v100, v72, v73
    v_cvt_pk_bf16_f32 v101, v74, v75
    v_cvt_pk_bf16_f32 v102, v76, v77
    v_cvt_pk_bf16_f32 v103, v78, v79
    ds_write_b64 v12, v[96:97] offset:0
    ds_write_b64 v12, v[98:99] offset:16
    ds_write_b64 v12, v[100:101] offset:32
    ds_write_b64 v12, v[102:103] offset:48
    v_cvt_pk_bf16_f32 v104, v80, v81
    v_cvt_pk_bf16_f32 v105, v82, v83
    v_cvt_pk_bf16_f32 v106, v84, v85
    v_cvt_pk_bf16_f32 v107, v86, v87
    v_cvt_pk_bf16_f32 v108, v88, v89
    v_cvt_pk_bf16_f32 v109, v90, v91
    v_cvt_pk_bf16_f32 v110, v92, v93
    v_cvt_pk_bf16_f32 v111, v94, v95
    ds_write_b64 v12, v[104:105] offset:8704
    ds_write_b64 v12, v[106:107] offset:8720
    ds_write_b64 v12, v[108:109] offset:8736
    ds_write_b64 v12, v[110:111] offset:8752
    s_mov_b32 s39, s37
    s_mov_b32 s37, s26
    s_cmp_ge_u32 s66, 0
    s_cbranch_scc1 Lq_38
    s_waitcnt lgkmcnt(0)
    s_barrier
    v_add_u32 v12, s38, v9
    ds_read_b128 v[112:115], v12 offset:0
    ds_read_b128 v[116:119], v12 offset:1088
    ds_read_b128 v[120:123], v12 offset:8704
    ds_read_b128 v[124:127], v12 offset:9792
    s_waitcnt lgkmcnt(0)
    s_mul_i32 s57, s26, 262144
    s_add_u32 s57, s57, s42
    buffer_store_dwordx4 v[112:115], v10, s[20:23], s57 offen sc1
    s_add_u32 s57, s57, 1024
    buffer_store_dwordx4 v[116:119], v10, s[20:23], s57 offen sc1
    s_mul_i32 s57, s26, 262144
    s_add_u32 s57, s57, s43
    buffer_store_dwordx4 v[120:123], v10, s[20:23], s57 offen sc1
    s_add_u32 s57, s57, 1024
    buffer_store_dwordx4 v[124:127], v10, s[20:23], s57 offen sc1
    s_waitcnt vmcnt(0)
    s_barrier
    s_cmp_lg_u32 s25, 0
    s_cbranch_scc1 Lf_39
    s_mov_b32 s60, s26
    s_lshl_b32 s60, s60, 11
    s_lshl_b32 s61, s44, 2
    s_add_u32 s60, s60, s61
    s_add_u32 s60, s60, 0x410100
    v_mov_b32 v127, 0
    v_mov_b32 v125, 1
    s_mov_b64 exec, 1
    buffer_store_dword v125, v127, s[20:23], s60 offen sc1
    s_mov_b64 exec, -1
Lf_39:
    s_cmp_lg_u32 s25, 0
    s_cbranch_scc1 Lf_40
    s_mov_b32 s60, s26
    s_lshl_b32 s60, s60, 11
    s_lshl_b32 s61, s45, 2
    s_add_u32 s60, s60, s61
    s_add_u32 s60, s60, 0x410100
    v_mov_b32 v127, 0
    v_mov_b32 v125, 1
    s_mov_b64 exec, 1
    buffer_store_dword v125, v127, s[20:23], s60 offen sc1
    s_mov_b64 exec, -1
Lf_40:
    s_mov_b32 s37, -1
    s_mov_b32 s39, -1
Lq_38:
    s_add_u32 s66, s66, 1
    s_mov_b32 s35, s36
    s_xor_b32 s38, s38, 17408
    s_add_u32 s26, s26, 1
    s_cmp_lt_u32 s26, 64
    s_cbranch_scc1 LR3_loop
    s_xor_b32 s38, s38, 17408
    s_waitcnt lgkmcnt(0)
    s_barrier
    v_add_u32 v12, s38, v9
    ds_read_b128 v[112:115], v12 offset:0
    ds_read_b128 v[116:119], v12 offset:1088
    ds_read_b128 v[120:123], v12 offset:8704
    ds_read_b128 v[124:127], v12 offset:9792
    s_waitcnt lgkmcnt(0)
    s_mul_i32 s57, s37, 262144
    s_add_u32 s57, s57, s42
    buffer_store_dwordx4 v[112:115], v10, s[20:23], s57 offen sc1
    s_add_u32 s57, s57, 1024
    buffer_store_dwordx4 v[116:119], v10, s[20:23], s57 offen sc1
    s_mul_i32 s57, s37, 262144
    s_add_u32 s57, s57, s43
    buffer_store_dwordx4 v[120:123], v10, s[20:23], s57 offen sc1
    s_add_u32 s57, s57, 1024
    buffer_store_dwordx4 v[124:127], v10, s[20:23], s57 offen sc1
    s_waitcnt vmcnt(0)
    s_barrier
    s_cmp_lg_u32 s25, 0
    s_cbranch_scc1 Lf_41
    s_mov_b32 s60, s37
    s_lshl_b32 s60, s60, 11
    s_lshl_b32 s61, s44, 2
    s_add_u32 s60, s60, s61
    s_add_u32 s60, s60, 0x410100
    v_mov_b32 v127, 0
    v_mov_b32 v125, 1
    s_mov_b64 exec, 1
    buffer_store_dword v125, v127, s[20:23], s60 offen sc1
    s_mov_b64 exec, -1
Lf_41:
    s_cmp_lg_u32 s25, 0
    s_cbranch_scc1 Lf_42
    s_mov_b32 s60, s37
    s_lshl_b32 s60, s60, 11
    s_lshl_b32 s61, s45, 2
    s_add_u32 s60, s60, s61
    s_add_u32 s60, s60, 0x410100
    v_mov_b32 v127, 0
    v_mov_b32 v125, 1
    s_mov_b64 exec, 1
    buffer_store_dword v125, v127, s[20:23], s60 offen sc1
    s_mov_b64 exec, -1
Lf_42:
    s_cmp_eq_u32 s39, -1
    s_cbranch_scc1 Lz_43
    s_cmp_lg_u32 s25, 0
    s_cbranch_scc1 Lf_44
    s_mov_b32 s60, s39
    s_lshl_b32 s60, s60, 11
    s_lshl_b32 s61, s44, 2
    s_add_u32 s60, s60, s61
    s_add_u32 s60, s60, 0x410100
    v_mov_b32 v127, 0
    v_mov_b32 v125, 1
    s_mov_b64 exec, 1
    buffer_store_dword v125, v127, s[20:23], s60 offen sc1
    s_mov_b64 exec, -1
Lf_44:
    s_cmp_lg_u32 s25, 0
    s_cbranch_scc1 Lf_45
    s_mov_b32 s60, s39
    s_lshl_b32 s60, s60, 11
    s_lshl_b32 s61, s45, 2
    s_add_u32 s60, s60, s61
    s_add_u32 s60, s60, 0x410100
    v_mov_b32 v127, 0
    v_mov_b32 v125, 1
    s_mov_b64 exec, 1
    buffer_store_dword v125, v127, s[20:23], s60 offen sc1
    s_mov_b64 exec, -1
Lf_45:
Lz_43:
    s_waitcnt vmcnt(0)
LR3_exit:
    s_branch L_exit
LR4:
    s_sub_u32 s63, s62, 144
LB_ffn2:
    s_lshr_b32 s26, s63, 4
L_ffn2_entry:
    s_load_dwordx2 s[4:5], s[0:1], 72
    s_load_dwordx2 s[8:9], s[0:1], 80
    s_waitcnt lgkmcnt(0)
    s_mov_b32 s6, 0x1c0000
    s_mov_b32 s7, 0x00020000
    s_mov_b32 s10, 0x200000
    s_mov_b32 s11, 0x00020000
    s_and_b32 s24, s63, 15
    v_lshlrev_b32 v124, 2, v2
    v_add_u32 v124, 672, v124
    s_cmp_ge_u32 s26, 64
    s_cbranch_scc1 LR4_exit
    s_mul_i32 s29, s25, 458752
    s_lshl_b32 s33, s24, 6
    s_add_u32 s29, s29, s33
    s_mul_i32 s30, s25, 29184
    s_load_dwordx2 s[64:65], s[0:1], 88
    v_mov_b32 v125, 0
    s_mov_b32 s61, 0
    s_waitcnt lgkmcnt(0)
Lwi_46:
    global_load_dword v126, v125, s[64:65] offset:40 sc1
    s_add_u32 s61, s61, 1
    s_cmp_gt_u32 s61, 2000000
    s_cbranch_scc1 L_fail
    s_waitcnt vmcnt(0)
    v_cmp_gt_u32 vcc, 64, v126
    s_cbranch_vccz Lwi_46_ok
    s_sleep 4
    s_branch Lwi_46
Lwi_46_ok:
    v_lshrrev_b32 v8, 2, v2
    s_mov_b32 s33, 1024
    v_mul_lo_u32 v8, v8, s33
    v_and_b32 v9, 3, v2
    v_lshl_add_u32 v8, v9, 4, v8
    s_add_u32 m0, s30, 0
    s_nop 0
    buffer_load_dwordx4 v8, s[4:7], s29 offen lds
    s_add_u32 m0, s30, 1024
    s_add_u32 s29, s29, 16384
    buffer_load_dwordx4 v8, s[4:7], s29 offen lds
    s_add_u32 m0, s30, 2048
    s_add_u32 s29, s29, 16384
    buffer_load_dwordx4 v8, s[4:7], s29 offen lds
    s_add_u32 m0, s30, 3072
    s_add_u32 s29, s29, 16384
    buffer_load_dwordx4 v8, s[4:7], s29 offen lds
    s_add_u32 m0, s30, 4096
    s_add_u32 s29, s29, 16384
    buffer_load_dwordx4 v8, s[4:7], s29 offen lds
    s_add_u32 m0, s30, 5120
    s_add_u32 s29, s29, 16384
    buffer_load_dwordx4 v8, s[4:7], s29 offen lds
    s_add_u32 m0, s30, 6144
    s_add_u32 s29, s29, 16384
    buffer_load_dwordx4 v8, s[4:7], s29 offen lds
    s_add_u32 m0, s30, 7168
    s_add_u32 s29, s29, 16384
    buffer_load_dwordx4 v8, s[4:7], s29 offen lds
    s_add_u32 m0, s30, 8192
    s_add_u32 s29, s29, 16384
    buffer_load_dwordx4 v8, s[4:7], s29 offen lds
    s_add_u32 m0, s30, 9216
    s_add_u32 s29, s29, 16384
    buffer_load_dwordx4 v8, s[4:7], s29 offen lds
    s_add_u32 m0, s30, 10240
    s_add_u32 s29, s29, 16384
    buffer_load_dwordx4 v8, s[4:7], s29 offen lds
    s_add_u32 m0, s30, 11264
    s_add_u32 s29, s29, 16384
    buffer_load_dwordx4 v8, s[4:7], s29 offen lds
    s_add_u32 m0, s30, 12288
    s_add_u32 s29, s29, 16384
    buffer_load_dwordx4 v8, s[4:7], s29 offen lds
    s_add_u32 m0, s30, 13312
    s_add_u32 s29, s29, 16384
    buffer_load_dwordx4 v8, s[4:7], s29 offen lds
    s_add_u32 m0, s30, 14336
    s_add_u32 s29, s29, 16384
    buffer_load_dwordx4 v8, s[4:7], s29 offen lds
    s_add_u32 m0, s30, 15360
    s_add_u32 s29, s29, 16384
    buffer_load_dwordx4 v8, s[4:7], s29 offen lds
    s_add_u32 m0, s30, 16384
    s_add_u32 s29, s29, 16384
    buffer_load_dwordx4 v8, s[4:7], s29 offen lds
    s_add_u32 m0, s30, 17408
    s_add_u32 s29, s29, 16384
    buffer_load_dwordx4 v8, s[4:7], s29 offen lds
    s_add_u32 m0, s30, 18432
    s_add_u32 s29, s29, 16384
    buffer_load_dwordx4 v8, s[4:7], s29 offen lds
    s_add_u32 m0, s30, 19456
    s_add_u32 s29, s29, 16384
    buffer_load_dwordx4 v8, s[4:7], s29 offen lds
    s_add_u32 m0, s30, 20480
    s_add_u32 s29, s29, 16384
    buffer_load_dwordx4 v8, s[4:7], s29 offen lds
    s_add_u32 m0, s30, 21504
    s_add_u32 s29, s29, 16384
    buffer_load_dwordx4 v8, s[4:7], s29 offen lds
    s_add_u32 m0, s30, 22528
    s_add_u32 s29, s29, 16384
    buffer_load_dwordx4 v8, s[4:7], s29 offen lds
    s_add_u32 m0, s30, 23552
    s_add_u32 s29, s29, 16384
    buffer_load_dwordx4 v8, s[4:7], s29 offen lds
    s_add_u32 m0, s30, 24576
    s_add_u32 s29, s29, 16384
    buffer_load_dwordx4 v8, s[4:7], s29 offen lds
    s_add_u32 m0, s30, 25600
    s_add_u32 s29, s29, 16384
    buffer_load_dwordx4 v8, s[4:7], s29 offen lds
    s_add_u32 m0, s30, 26624
    s_add_u32 s29, s29, 16384
    buffer_load_dwordx4 v8, s[4:7], s29 offen lds
    s_add_u32 m0, s30, 27648
    s_add_u32 s29, s29, 16384
    buffer_load_dwordx4 v8, s[4:7], s29 offen lds
    v_lshrrev_b32 v8, 5, v2
    v_lshlrev_b32 v8, 3, v8
    v_bfe_u32 v9, v2, 2, 2
    v_add_u32 v8, v8, v9
    v_lshlrev_b32 v8, 6, v8
    v_bfe_u32 v9, v2, 4, 1
    v_lshl_add_u32 v8, v9, 5, v8
    v_and_b32 v9, 3, v2
    v_lshl_add_u32 v8, v9, 3, v8
    v_add_u32 v8, s30, v8
    s_waitcnt vmcnt(24)
    ds_read_b64_tr_b16 a[0:1], v8 offset:0
    ds_read_b64_tr_b16 a[2:3], v8 offset:256
    ds_read_b64_tr_b16 a[4:5], v8 offset:1024
    ds_read_b64_tr_b16 a[6:7], v8 offset:1280
    ds_read_b64_tr_b16 a[8:9], v8 offset:2048
    ds_read_b64_tr_b16 a[10:11], v8 offset:2304
    ds_read_b64_tr_b16 a[12:13], v8 offset:3072
    ds_read_b64_tr_b16 a[14:15], v8 offset:3328
    s_waitcnt lgkmcnt(0)
    s_waitcnt vmcnt(20)
    ds_read_b64_tr_b16 a[16:17], v8 offset:4096
    ds_read_b64_tr_b16 a[18:19], v8 offset:4352
    ds_read_b64_tr_b16 a[20:21], v8 offset:5120
    ds_read_b64_tr_b16 a[22:23], v8 offset:5376
    ds_read_b64_tr_b16 a[24:25], v8 offset:6144
    ds_read_b64_tr_b16 a[26:27], v8 offset:6400
    ds_read_b64_tr_b16 a[28:29], v8 offset:7168
    ds_read_b64_tr_b16 a[30:31], v8 offset:7424
    s_waitcnt lgkmcnt(0)
    s_waitcnt vmcnt(16)
    ds_read_b64_tr_b16 a[32:33], v8 offset:8192
    ds_read_b64_tr_b16 a[34:35], v8 offset:8448
    ds_read_b64_tr_b16 a[36:37], v8 offset:9216
    ds_read_b64_tr_b16 a[38:39], v8 offset:9472
    ds_read_b64_tr_b16 a[40:41], v8 offset:10240
    ds_read_b64_tr_b16 a[42:43], v8 offset:10496
    ds_read_b64_tr_b16 a[44:45], v8 offset:11264
    ds_read_b64_tr_b16 a[46:47], v8 offset:11520
    s_waitcnt lgkmcnt(0)
    s_waitcnt vmcnt(12)
    ds_read_b64_tr_b16 a[48:49], v8 offset:12288
    ds_read_b64_tr_b16 a[50:51], v8 offset:12544
    ds_read_b64_tr_b16 a[52:53], v8 offset:13312
    ds_read_b64_tr_b16 a[54:55], v8 offset:13568
    ds_read_b64_tr_b16 a[56:57], v8 offset:14336
    ds_read_b64_tr_b16 a[58:59], v8 offset:14592
    ds_read_b64_tr_b16 a[60:61], v8 offset:15360
    ds_read_b64_tr_b16 a[62:63], v8 offset:15616
    s_waitcnt lgkmcnt(0)
    s_waitcnt vmcnt(8)
    ds_read_b64_tr_b16 a[64:65], v8 offset:16384
    ds_read_b64_tr_b16 a[66:67], v8 offset:16640
    ds_read_b64_tr_b16 a[68:69], v8 offset:17408
    ds_read_b64_tr_b16 a[70:71], v8 offset:17664
    ds_read_b64_tr_b16 a[72:73], v8 offset:18432
    ds_read_b64_tr_b16 a[74:75], v8 offset:18688
    ds_read_b64_tr_b16 a[76:77], v8 offset:19456
    ds_read_b64_tr_b16 a[78:79], v8 offset:19712
    s_waitcnt lgkmcnt(0)
    s_waitcnt vmcnt(4)
    ds_read_b64_tr_b16 a[80:81], v8 offset:20480
    ds_read_b64_tr_b16 a[82:83], v8 offset:20736
    ds_read_b64_tr_b16 a[84:85], v8 offset:21504
    ds_read_b64_tr_b16 a[86:87], v8 offset:21760
    ds_read_b64_tr_b16 a[88:89], v8 offset:22528
    ds_read_b64_tr_b16 a[90:91], v8 offset:22784
    ds_read_b64_tr_b16 a[92:93], v8 offset:23552
    ds_read_b64_tr_b16 a[94:95], v8 offset:23808
    s_waitcnt lgkmcnt(0)
    s_waitcnt vmcnt(0)
    ds_read_b64_tr_b16 a[96:97], v8 offset:24576
    ds_read_b64_tr_b16 a[98:99], v8 offset:24832
    ds_read_b64_tr_b16 a[100:101], v8 offset:25600
    ds_read_b64_tr_b16 a[102:103], v8 offset:25856
    ds_read_b64_tr_b16 a[104:105], v8 offset:26624
    ds_read_b64_tr_b16 a[106:107], v8 offset:26880
    ds_read_b64_tr_b16 a[108:109], v8 offset:27648
    ds_read_b64_tr_b16 a[110:111], v8 offset:27904
    s_waitcnt lgkmcnt(0)
    s_barrier
    v_lshlrev_b32 v3, 4, v2
    v_and_b32 v4, 31, v2
    s_movk_i32 s33, 912
    v_mul_lo_u32 v4, v4, s33
    v_lshrrev_b32 v5, 5, v2
    v_lshl_add_u32 v4, v5, 4, v4
    v_add_u32 v4, s30, v4
    v_and_b32 v6, 31, v2
    s_movk_i32 s33, 144
    v_mul_lo_u32 v6, v6, s33
    v_lshl_add_u32 v6, v5, 4, v6
    s_mul_i32 s33, s25, 4608
    s_add_u32 s33, s33, 116736
    v_add_u32 v6, s33, v6
    v_lshrrev_b32 v7, 3, v0
    v_and_b32 v8, 7, v0
    s_movk_i32 s33, 144
    v_mul_lo_u32 v9, v7, s33
    v_lshl_add_u32 v9, v8, 4, v9
    v_add_u32 v9, 116736, v9
    v_lshlrev_b32 v10, 10, v7
    v_lshl_add_u32 v10, v8, 3, v10
LR4_loop:
    s_cmp_lg_u32 s25, 0
    s_cbranch_scc1 Lw_47_ok
    s_mov_b32 s60, s26
    s_lshl_b32 s60, s60, 11
    s_add_u32 s60, s60, 0x410000
    s_mov_b32 s61, 0
Lw_47:
    buffer_load_dword v126, v124, s[20:23], s60 offen sc1
    s_add_u32 s61, s61, 1
    s_cmp_gt_u32 s61, 2000000
    s_cbranch_scc1 L_fail
    s_waitcnt vmcnt(0)
    v_cmp_eq_u32 vcc, 0, v126
    s_and_b32 vcc_lo, vcc_lo, 0x3fff
    s_cbranch_scc0 Lw_47_ok
    s_sleep 4
    s_branch Lw_47
Lw_47_ok:
    s_barrier
    s_mul_i32 s33, s26, 114688
    s_mul_i32 s34, s25, 896
    s_add_u32 s33, s33, s34
    s_add_u32 s33, s33, 0x5000000
    s_mov_b32 exec_hi, 0x00ffffff
    s_add_u32 m0, s30, 0
    s_nop 0
    buffer_load_dwordx4 v3, s[20:23], s33 offen sc1 lds
    s_add_u32 m0, s30, 912
    s_add_u32 s33, s33, 3584
    buffer_load_dwordx4 v3, s[20:23], s33 offen sc1 lds
    s_add_u32 m0, s30, 1824
    s_add_u32 s33, s33, 3584
    buffer_load_dwordx4 v3, s[20:23], s33 offen sc1 lds
    s_add_u32 m0, s30, 2736
    s_add_u32 s33, s33, 3584
    buffer_load_dwordx4 v3, s[20:23], s33 offen sc1 lds
    s_add_u32 m0, s30, 3648
    s_add_u32 s33, s33, 3584
    buffer_load_dwordx4 v3, s[20:23], s33 offen sc1 lds
    s_add_u32 m0, s30, 4560
    s_add_u32 s33, s33, 3584
    buffer_load_dwordx4 v3, s[20:23], s33 offen sc1 lds
    s_add_u32 m0, s30, 5472
    s_add_u32 s33, s33, 3584
    buffer_load_dwordx4 v3, s[20:23], s33 offen sc1 lds
    s_add_u32 m0, s30, 6384
    s_add_u32 s33, s33, 3584
    buffer_load_dwordx4 v3, s[20:23], s33 offen sc1 lds
    s_add_u32 m0, s30, 7296
    s_add_u32 s33, s33, 3584
    buffer_load_dwordx4 v3, s[20:23], s33 offen sc1 lds
    s_add_u32 m0, s30, 8208
    s_add_u32 s33, s33, 3584
    buffer_load_dwordx4 v3, s[20:23], s33 offen sc1 lds
    s_add_u32 m0, s30, 9120
    s_add_u32 s33, s33, 3584
    buffer_load_dwordx4 v3, s[20:23], s33 offen sc1 lds
    s_add_u32 m0, s30, 10032
    s_add_u32 s33, s33, 3584
    buffer_load_dwordx4 v3, s[20:23], s33 offen sc1 lds
    s_add_u32 m0, s30, 10944
    s_add_u32 s33, s33, 3584
    buffer_load_dwordx4 v3, s[20:23], s33 offen sc1 lds
    s_add_u32 m0, s30, 11856
    s_add_u32 s33, s33, 3584
    buffer_load_dwordx4 v3, s[20:23], s33 offen sc1 lds
    s_add_u32 m0, s30, 12768
    s_add_u32 s33, s33, 3584
    buffer_load_dwordx4 v3, s[20:23], s33 offen sc1 lds
    s_add_u32 m0, s30, 13680
    s_add_u32 s33, s33, 3584
    buffer_load_dwordx4 v3, s[20:23], s33 offen sc1 lds
    s_add_u32 m0, s30, 14592
    s_add_u32 s33, s33, 3584
    buffer_load_dwordx4 v3, s[20:23], s33 offen sc1 lds
    s_add_u32 m0, s30, 15504
    s_add_u32 s33, s33, 3584
    buffer_load_dwordx4 v3, s[20:23], s33 offen sc1 lds
    s_add_u32 m0, s30, 16416
    s_add_u32 s33, s33, 3584
    buffer_load_dwordx4 v3, s[20:23], s33 offen sc1 lds
    s_add_u32 m0, s30, 17328
    s_add_u32 s33, s33, 3584
    buffer_load_dwordx4 v3, s[20:23], s33 offen sc1 lds
    s_add_u32 m0, s30, 18240
    s_add_u32 s33, s33, 3584
    buffer_load_dwordx4 v3, s[20:23], s33 offen sc1 lds
    s_add_u32 m0, s30, 19152
    s_add_u32 s33, s33, 3584
    buffer_load_dwordx4 v3, s[20:23], s33 offen sc1 lds
    s_add_u32 m0, s30, 20064
    s_add_u32 s33, s33, 3584
    buffer_load_dwordx4 v3, s[20:23], s33 offen sc1 lds
    s_add_u32 m0, s30, 20976
    s_add_u32 s33, s33, 3584
    buffer_load_dwordx4 v3, s[20:23], s33 offen sc1 lds
    s_add_u32 m0, s30, 21888
    s_add_u32 s33, s33, 3584
    buffer_load_dwordx4 v3, s[20:23], s33 offen sc1 lds
    s_add_u32 m0, s30, 22800
    s_add_u32 s33, s33, 3584
    buffer_load_dwordx4 v3, s[20:23], s33 offen sc1 lds
    s_add_u32 m0, s30, 23712
    s_add_u32 s33, s33, 3584
    buffer_load_dwordx4 v3, s[20:23], s33 offen sc1 lds
    s_add_u32 m0, s30, 24624
    s_add_u32 s33, s33, 3584
    buffer_load_dwordx4 v3, s[20:23], s33 offen sc1 lds
    s_add_u32 m0, s30, 25536
    s_add_u32 s33, s33, 3584
    buffer_load_dwordx4 v3, s[20:23], s33 offen sc1 lds
    s_add_u32 m0, s30, 26448
    s_add_u32 s33, s33, 3584
    buffer_load_dwordx4 v3, s[20:23], s33 offen sc1 lds
    s_add_u32 m0, s30, 27360
    s_add_u32 s33, s33, 3584
    buffer_load_dwordx4 v3, s[20:23], s33 offen sc1 lds
    s_add_u32 m0, s30, 28272
    s_add_u32 s33, s33, 3584
    buffer_load_dwordx4 v3, s[20:23], s33 offen sc1 lds
    s_mov_b32 exec_hi, -1
    s_lshl_b32 s34, s26, 15
    s_lshl_b32 s35, s24, 6
    s_add_u32 s34, s34, s35
    s_add_u32 s35, s34, 0x200000
    buffer_load_dwordx2 v[12:13], v10, s[20:23], s35 offen sc1
    s_waitcnt vmcnt(0)
    ds_read_b128 v[32:35], v4 offset:0
    ds_read_b128 v[36:39], v4 offset:32
    ds_read_b128 v[40:43], v4 offset:64
    ds_read_b128 v[44:47], v4 offset:96
    s_waitcnt lgkmcnt(3)
    v_mfma_f32_32x32x16_bf16 v[16:31], a[0:3], v[32:35], 0
    ds_read_b128 v[48:51], v4 offset:128
    s_waitcnt lgkmcnt(3)
    v_mfma_f32_32x32x16_bf16 v[16:31], a[4:7], v[36:39], v[16:31]
    ds_read_b128 v[32:35], v4 offset:160
    s_waitcnt lgkmcnt(3)
    v_mfma_f32_32x32x16_bf16 v[16:31], a[8:11], v[40:43], v[16:31]
    ds_read_b128 v[36:39], v4 offset:192
    s_waitcnt lgkmcnt(3)
    v_mfma_f32_32x32x16_bf16 v[16:31], a[12:15], v[44:47], v[16:31]
    ds_read_b128 v[40:43], v4 offset:224
    s_waitcnt lgkmcnt(3)
    v_mfma_f32_32x32x16_bf16 v[16:31], a[16:19], v[48:51], v[16:31]
    ds_read_b128 v[44:47], v4 offset:256
    s_waitcnt lgkmcnt(3)
    v_mfma_f32_32x32x16_bf16 v[16:31], a[20:23], v[32:35], v[16:31]
    ds_read_b128 v[48:51], v4 offset:288
    s_waitcnt lgkmcnt(3)
    v_mfma_f32_32x32x16_bf16 v[16:31], a[24:27], v[36:39], v[16:31]
    ds_read_b128 v[32:35], v4 offset:320
    s_waitcnt lgkmcnt(3)
    v_mfma_f32_32x32x16_bf16 v[16:31], a[28:31], v[40:43], v[16:31]
    ds_read_b128 v[36:39], v4 offset:352
    s_waitcnt lgkmcnt(3)
    v_mfma_f32_32x32x16_bf16 v[16:31], a[32:35], v[44:47], v[16:31]
    ds_read_b128 v[40:43], v4 offset:384
    s_waitcnt lgkmcnt(3)
    v_mfma_f32_32x32x16_bf16 v[16:31], a[36:39], v[48:51], v[16:31]
    ds_read_b128 v[44:47], v4 offset:416
    s_waitcnt lgkmcnt(3)
    v_mfma_f32_32x32x16_bf16 v[16:31], a[40:43], v[32:35], v[16:31]
    ds_read_b128 v[48:51], v4 offset:448
    s_waitcnt lgkmcnt(3)
    v_mfma_f32_32x32x16_bf16 v[16:31], a[44:47], v[36:39], v[16:31]
    ds_read_b128 v[32:35], v4 offset:480
    s_waitcnt lgkmcnt(3)
    v_mfma_f32_32x32x16_bf16 v[16:31], a[48:51], v[40:43], v[16:31]
    ds_read_b128 v[36:39], v4 offset:512
    s_waitcnt lgkmcnt(3)
    v_mfma_f32_32x32x16_bf16 v[16:31], a[52:55], v[44:47], v[16:31]
    ds_read_b128 v[40:43], v4 offset:544
    s_waitcnt lgkmcnt(3)
    v_mfma_f32_32x32x16_bf16 v[16:31], a[56:59], v[48:51], v[16:31]
    ds_read_b128 v[44:47], v4 offset:576
    s_waitcnt lgkmcnt(3)
    v_mfma_f32_32x32x16_bf16 v[16:31], a[60:63], v[32:35], v[16:31]
    ds_read_b128 v[48:51], v4 offset:608
    s_waitcnt lgkmcnt(3)
    v_mfma_f32_32x32x16_bf16 v[16:31], a[64:67], v[36:39], v[16:31]
    ds_read_b128 v[32:35], v4 offset:640
    s_waitcnt lgkmcnt(3)
    v_mfma_f32_32x32x16_bf16 v[16:31], a[68:71], v[40:43], v[16:31]
    ds_read_b128 v[36:39], v4 offset:672
    s_waitcnt lgkmcnt(3)
    v_mfma_f32_32x32x16_bf16 v[16:31], a[72:75], v[44:47], v[16:31]
    ds_read_b128 v[40:43], v4 offset:704
    s_waitcnt lgkmcnt(3)
    v_mfma_f32_32x32x16_bf16 v[16:31], a[76:79], v[48:51], v[16:31]
    ds_read_b128 v[44:47], v4 offset:736
    s_waitcnt lgkmcnt(3)
    v_mfma_f32_32x32x16_bf16 v[16:31], a[80:83], v[32:35], v[16:31]
    ds_read_b128 v[48:51], v4 offset:768
    s_waitcnt lgkmcnt(3)
    v_mfma_f32_32x32x16_bf16 v[16:31], a[84:87], v[36:39], v[16:31]
    ds_read_b128 v[32:35], v4 offset:800
    s_waitcnt lgkmcnt(3)
    v_mfma_f32_32x32x16_bf16 v[16:31], a[88:91], v[40:43], v[16:31]
    ds_read_b128 v[36:39], v4 offset:832
    s_waitcnt lgkmcnt(3)
    v_mfma_f32_32x32x16_bf16 v[16:31], a[92:95], v[44:47], v[16:31]
    ds_read_b128 v[40:43], v4 offset:864
    s_waitcnt lgkmcnt(3)
    v_mfma_f32_32x32x16_bf16 v[16:31], a[96:99], v[48:51], v[16:31]
    s_waitcnt lgkmcnt(2)
    v_mfma_f32_32x32x16_bf16 v[16:31], a[100:103], v[32:35], v[16:31]
    s_waitcnt lgkmcnt(1)
    v_mfma_f32_32x32x16_bf16 v[16:31], a[104:107], v[36:39], v[16:31]
    s_waitcnt lgkmcnt(0)
    v_mfma_f32_32x32x16_bf16 v[16:31], a[108:111], v[40:43], v[16:31]
    s_nop 7
    s_nop 4
    ds_write_b128 v6, v[16:19] offset:0
    ds_write_b128 v6, v[20:23] offset:32
    ds_write_b128 v6, v[24:27] offset:64
    ds_write_b128 v6, v[28:31] offset:96
    s_waitcnt lgkmcnt(0)
    s_barrier
    ds_read_b128 v[32:35], v9 offset:0
    ds_read_b128 v[36:39], v9 offset:4608
    ds_read_b128 v[40:43], v9 offset:9216
    ds_read_b128 v[44:47], v9 offset:13824
    s_waitcnt lgkmcnt(0)
    v_pk_add_f32 v[32:33], v[32:33], v[36:37]
    v_pk_add_f32 v[40:41], v[40:41], v[44:45]
    v_pk_add_f32 v[34:35], v[34:35], v[38:39]
    v_pk_add_f32 v[42:43], v[42:43], v[46:47]
    v_pk_add_f32 v[32:33], v[32:33], v[40:41]
    v_pk_add_f32 v[34:35], v[34:35], v[42:43]
    v_cvt_pk_bf16_f32 v36, v32, v33
    v_cvt_pk_bf16_f32 v37, v34, v35
    v_lshlrev_b32 v32, 16, v36
    v_and_b32 v33, 0xffff0000, v36
    v_lshlrev_b32 v40, 16, v12
    v_and_b32 v41, 0xffff0000, v12
    v_lshlrev_b32 v34, 16, v37
    v_and_b32 v35, 0xffff0000, v37
    v_lshlrev_b32 v42, 16, v13
    v_and_b32 v43, 0xffff0000, v13
    v_pk_add_f32 v[32:33], v[32:33], v[40:41]
    v_pk_add_f32 v[34:35], v[34:35], v[42:43]
    v_cvt_pk_bf16_f32 v36, v32, v33
    v_cvt_pk_bf16_f32 v37, v34, v35
    buffer_store_dwordx2 v[36:37], v10, s[8:11], s34 offen
    s_barrier
    s_add_u32 s26, s26, 2
    s_cmp_lt_u32 s26, 64
    s_cbranch_scc1 LR4_loop
    s_waitcnt vmcnt(0)
LR4_exit:
    s_branch L_exit
LR5:
    s_sub_u32 s63, s62, 160
LB_red:
    s_load_dwordx2 s[4:5], s[0:1], 0
    s_waitcnt lgkmcnt(0)
    s_mov_b32 s6, 0x200000
    s_mov_b32 s7, 0x00020000
    s_mov_b32 s26, s63
    v_lshlrev_b32 v124, 2, v2
    v_add_u32 v124, 512, v124
    s_cmp_ge_u32 s26, 512
    s_cbranch_scc1 LR5_exit
    s_load_dwordx2 s[64:65], s[0:1], 88
    v_mov_b32 v125, 0
    s_mov_b32 s61, 0
    s_waitcnt lgkmcnt(0)
Lwi_48:
    global_load_dword v126, v125, s[64:65] offset:40 sc1
    s_add_u32 s61, s61, 1
    s_cmp_gt_u32 s61, 2000000
    s_cbranch_scc1 L_fail
    s_waitcnt vmcnt(0)
    v_cmp_gt_u32 vcc, 64, v126
    s_cbranch_vccz Lwi_48_ok
    s_sleep 4
    s_branch Lwi_48
Lwi_48_ok:
    v_lshlrev_b32 v3, 4, v2
    v_lshlrev_b32 v4, 5, v2
LR5_loop:
    s_cmp_lg_u32 s25, 0
    s_cbranch_scc1 Lw_49_ok
    s_lshr_b32 s60, s26, 3
    s_lshl_b32 s60, s60, 11
    s_add_u32 s60, s60, 0x410000
    s_mov_b32 s61, 0
Lw_49:
    buffer_load_dword v126, v124, s[20:23], s60 offen sc1
    s_add_u32 s61, s61, 1
    s_cmp_gt_u32 s61, 2000000
    s_cbranch_scc1 L_fail
    s_waitcnt vmcnt(0)
    v_cmp_eq_u32 vcc, 0, v126
    s_and_b32 vcc_lo, vcc_lo, 0xffffffff
    s_cbranch_scc0 Lw_49_ok
    s_sleep 4
    s_branch Lw_49
Lw_49_ok:
    s_barrier
    s_lshl_b32 s27, s26, 2
    s_add_u32 s27, s27, s25
    s_lshl_b32 s28, s27, 10
    buffer_load_dwordx4 v[8:11], v3, s[4:7], s28 offen
    s_lshl_b32 s29, s27, 11
    s_add_u32 s29, s29, 0x6000000
    buffer_load_dwordx4 v[16:19], v4, s[20:23], s29 offen sc1
    buffer_load_dwordx4 v[20:23], v4, s[20:23], s29 offen offset:16 sc1
    s_add_u32 s29, s29, 0x400000
    buffer_load_dwordx4 v[24:27], v4, s[20:23], s29 offen sc1
    buffer_load_dwordx4 v[28:31], v4, s[20:23], s29 offen offset:16 sc1
    s_add_u32 s29, s29, 0x400000
    buffer_load_dwordx4 v[32:35], v4, s[20:23], s29 offen sc1
    buffer_load_dwordx4 v[36:39], v4, s[20:23], s29 offen offset:16 sc1
    s_add_u32 s29, s29, 0x400000
    buffer_load_dwordx4 v[40:43], v4, s[20:23], s29 offen sc1
    buffer_load_dwordx4 v[44:47], v4, s[20:23], s29 offen offset:16 sc1
    s_waitcnt vmcnt(0)
    v_pk_add_f32 v[16:17], v[16:17], v[24:25]
    v_pk_add_f32 v[32:33], v[32:33], v[40:41]
    v_pk_add_f32 v[18:19], v[18:19], v[26:27]
    v_pk_add_f32 v[34:35], v[34:35], v[42:43]
    v_pk_add_f32 v[20:21], v[20:21], v[28:29]
    v_pk_add_f32 v[36:37], v[36:37], v[44:45]
    v_pk_add_f32 v[22:23], v[22:23], v[30:31]
    v_pk_add_f32 v[38:39], v[38:39], v[46:47]
    v_pk_add_f32 v[16:17], v[16:17], v[32:33]
    v_pk_add_f32 v[18:19], v[18:19], v[34:35]
    v_pk_add_f32 v[20:21], v[20:21], v[36:37]
    v_pk_add_f32 v[22:23], v[22:23], v[38:39]
    v_cvt_pk_bf16_f32 v24, v16, v17
    v_cvt_pk_bf16_f32 v25, v18, v19
    v_cvt_pk_bf16_f32 v26, v20, v21
    v_cvt_pk_bf16_f32 v27, v22, v23
    v_lshlrev_b32 v32, 16, v24
    v_and_b32 v33, 0xffff0000, v24
    v_lshlrev_b32 v34, 16, v25
    v_and_b32 v35, 0xffff0000, v25
    v_lshlrev_b32 v36, 16, v26
    v_and_b32 v37, 0xffff0000, v26
    v_lshlrev_b32 v38, 16, v27
    v_and_b32 v39, 0xffff0000, v27
    v_lshlrev_b32 v40, 16, v8
    v_and_b32 v41, 0xffff0000, v8
    v_lshlrev_b32 v42, 16, v9
    v_and_b32 v43, 0xffff0000, v9
    v_lshlrev_b32 v44, 16, v10
    v_and_b32 v45, 0xffff0000, v10
    v_lshlrev_b32 v46, 16, v11
    v_and_b32 v47, 0xffff0000, v11
    v_pk_add_f32 v[32:33], v[32:33], v[40:41]
    v_pk_add_f32 v[34:35], v[34:35], v[42:43]
    v_pk_add_f32 v[36:37], v[36:37], v[44:45]
    v_pk_add_f32 v[38:39], v[38:39], v[46:47]
    v_cvt_pk_bf16_f32 v24, v32, v33
    v_cvt_pk_bf16_f32 v25, v34, v35
    v_cvt_pk_bf16_f32 v26, v36, v37
    v_cvt_pk_bf16_f32 v27, v38, v39
    s_add_u32 s29, s28, 0x200000
    buffer_store_dwordx4 v[24:27], v3, s[20:23], s29 offen sc1
    v_lshlrev_b32 v32, 16, v24
    v_and_b32 v33, 0xffff0000, v24
    v_lshlrev_b32 v34, 16, v25
    v_and_b32 v35, 0xffff0000, v25
    v_lshlrev_b32 v36, 16, v26
    v_and_b32 v37, 0xffff0000, v26
    v_lshlrev_b32 v38, 16, v27
    v_and_b32 v39, 0xffff0000, v27
    v_pk_add_f32 v[48:49], v[32:33], v[34:35]
    v_pk_add_f32 v[50:51], v[36:37], v[38:39]
    v_pk_add_f32 v[48:49], v[48:49], v[50:51]
    v_add_f32 v48, v48, v49
    s_nop 1
    v_add_f32_dpp v48, v48, v48 quad_perm:[1,0,3,2] row_mask:0xf bank_mask:0xf
    s_nop 1
    v_add_f32_dpp v48, v48, v48 quad_perm:[2,3,0,1] row_mask:0xf bank_mask:0xf
    s_nop 1
    v_add_f32_dpp v48, v48, v48 row_half_mirror row_mask:0xf bank_mask:0xf
    s_nop 1
    v_add_f32_dpp v48, v48, v48 row_mirror row_mask:0xf bank_mask:0xf
    v_mov_b32 v49, v48
    s_nop 1
    v_permlane16_swap_b32 v48, v49
    v_add_f32 v48, v48, v49
    v_mov_b32 v49, v48
    s_nop 1
    v_permlane32_swap_b32 v48, v49
    v_add_f32 v48, v48, v49
    v_mul_f32 v48, 0x3b000000, v48
    v_sub_f32 v52, v32, v48
    v_sub_f32 v53, v33, v48
    v_sub_f32 v54, v34, v48
    v_sub_f32 v55, v35, v48
    v_sub_f32 v56, v36, v48
    v_sub_f32 v57, v37, v48
    v_sub_f32 v58, v38, v48
    v_sub_f32 v59, v39, v48
    v_mul_f32 v50, v52, v52
    v_fmac_f32 v50, v53, v53
    v_fmac_f32 v50, v54, v54
    v_fmac_f32 v50, v55, v55
    v_fmac_f32 v50, v56, v56
    v_fmac_f32 v50, v57, v57
    v_fmac_f32 v50, v58, v58
    v_fmac_f32 v50, v59, v59
    s_nop 1
    v_add_f32_dpp v50, v50, v50 quad_perm:[1,0,3,2] row_mask:0xf bank_mask:0xf
    s_nop 1
    v_add_f32_dpp v50, v50, v50 quad_perm:[2,3,0,1] row_mask:0xf bank_mask:0xf
    s_nop 1
    v_add_f32_dpp v50, v50, v50 row_half_mirror row_mask:0xf bank_mask:0xf
    s_nop 1
    v_add_f32_dpp v50, v50, v50 row_mirror row_mask:0xf bank_mask:0xf
    v_mov_b32 v51, v50
    s_nop 1
    v_permlane16_swap_b32 v50, v51
    v_add_f32 v50, v50, v51
    v_mov_b32 v51, v50
    s_nop 1
    v_permlane32_swap_b32 v50, v51
    v_add_f32 v50, v50, v51
    v_mul_f32 v50, 0x3b000000, v50
    v_cvt_pk_bf16_f32 v50, v50, v50
    v_lshlrev_b32 v50, 16, v50
    v_add_f32 v50, 0x3727c5ac, v50
    v_cvt_pk_bf16_f32 v50, v50, v50
    v_lshlrev_b32 v50, 16, v50
    v_sqrt_f32 v50, v50
    s_nop 0
    v_cvt_pk_bf16_f32 v50, v50, v50
    v_lshlrev_b32 v50, 16, v50
    v_rcp_f32 v50, v50
    v_cvt_pk_bf16_f32 v48, v48, v48
    v_lshlrev_b32 v48, 16, v48
    v_sub_f32 v52, v32, v48
    v_sub_f32 v53, v33, v48
    v_sub_f32 v54, v34, v48
    v_sub_f32 v55, v35, v48
    v_sub_f32 v56, v36, v48
    v_sub_f32 v57, v37, v48
    v_sub_f32 v58, v38, v48
    v_sub_f32 v59, v39, v48
    v_cvt_pk_bf16_f32 v49, v52, v53
    v_lshlrev_b32 v52, 16, v49
    v_and_b32 v53, 0xffff0000, v49
    v_cvt_pk_bf16_f32 v49, v54, v55
    v_lshlrev_b32 v54, 16, v49
    v_and_b32 v55, 0xffff0000, v49
    v_cvt_pk_bf16_f32 v49, v56, v57
    v_lshlrev_b32 v56, 16, v49
    v_and_b32 v57, 0xffff0000, v49
    v_cvt_pk_bf16_f32 v49, v58, v59
    v_lshlrev_b32 v58, 16, v49
    v_and_b32 v59, 0xffff0000, v49
    v_mul_f32 v52, v52, v50
    v_mul_f32 v53, v53, v50
    v_mul_f32 v54, v54, v50
    v_mul_f32 v55, v55, v50
    v_mul_f32 v56, v56, v50
    v_mul_f32 v57, v57, v50
    v_mul_f32 v58, v58, v50
    v_mul_f32 v59, v59, v50
    v_cvt_pk_bf16_f32 v12, v52, v53
    v_cvt_pk_bf16_f32 v13, v54, v55
    v_cvt_pk_bf16_f32 v14, v56, v57
    v_cvt_pk_bf16_f32 v15, v58, v59
    s_add_u32 s29, s28, 0x7000000
    buffer_store_dwordx4 v[12:15], v3, s[20:23], s29 offen sc1
    s_and_b32 s59, s26, 7
    s_waitcnt vmcnt(0)
    s_barrier
    s_cmp_lg_u32 s25, 0
    s_cbranch_scc1 Ls_50
    s_lshr_b32 s60, s26, 3
    s_lshl_b32 s60, s60, 11
    s_lshl_b32 s61, s59, 2
    s_add_u32 s60, s60, s61
    s_add_u32 s60, s60, 0x410280
    v_mov_b32 v127, 0
    v_mov_b32 v125, 1
    s_mov_b64 exec, 1
    buffer_store_dword v125, v127, s[20:23], s60 offen sc1
    s_mov_b64 exec, -1
Ls_50:
    s_add_u32 s26, s26, 16
    s_cmp_lt_u32 s26, 512
    s_cbranch_scc1 LR5_loop
    s_waitcnt vmcnt(0)
LR5_exit:
    s_branch L_exit
LR6:
    s_sub_u32 s63, s62, 160
    s_branch LB_ffn2
LR7:
    s_sub_u32 s63, s62, 192
LB_ffn1:
    s_load_dwordx2 s[4:5], s[0:1], 64
    s_waitcnt lgkmcnt(0)
    s_mov_b32 s6, 0x1c0000
    s_mov_b32 s7, 0x00020000
    s_mov_b32 s27, 0x12492493
    s_mul_hi_u32 s26, s63, s27
    s_mul_i32 s27, s26, 14
    s_sub_u32 s27, s63, s27
    s_lshl_b32 s24, s27, 8
    s_add_u32 s28, s24, 0x5000000
    s_mov_b32 s59, s27
    v_lshlrev_b32 v124, 2, v2
    v_add_u32 v124, 640, v124
    s_cmp_ge_u32 s26, 64
    s_cbranch_scc1 LR7_exit
    s_lshl_b32 s29, s25, 6
    s_add_u32 s29, s29, s24
    s_lshl_b32 s30, s25, 15
    s_load_dwordx2 s[64:65], s[0:1], 88
    v_mov_b32 v125, 0
    s_mov_b32 s61, 0
    s_waitcnt lgkmcnt(0)
Lwi_51:
    global_load_dword v126, v125, s[64:65] offset:40 sc1
    s_add_u32 s61, s61, 1
    s_cmp_gt_u32 s61, 2000000
    s_cbranch_scc1 L_fail
    s_waitcnt vmcnt(0)
    v_cmp_gt_u32 vcc, 64, v126
    s_cbranch_vccz Lwi_51_ok
    s_sleep 4
    s_branch Lwi_51
Lwi_51_ok:
    v_lshrrev_b32 v8, 2, v2
    s_mov_b32 s33, 3584
    v_mul_lo_u32 v8, v8, s33
    v_and_b32 v9, 3, v2
    v_lshl_add_u32 v8, v9, 4, v8
    s_add_u32 m0, s30, 0
    s_nop 0
    buffer_load_dwordx4 v8, s[4:7], s29 offen lds
    s_add_u32 m0, s30, 1024
    s_add_u32 s29, s29, 57344
    buffer_load_dwordx4 v8, s[4:7], s29 offen lds
    s_add_u32 m0, s30, 2048
    s_add_u32 s29, s29, 57344
    buffer_load_dwordx4 v8, s[4:7], s29 offen lds
    s_add_u32 m0, s30, 3072
    s_add_u32 s29, s29, 57344
    buffer_load_dwordx4 v8, s[4:7], s29 offen lds
    s_add_u32 m0, s30, 4096
    s_add_u32 s29, s29, 57344
    buffer_load_dwordx4 v8, s[4:7], s29 offen lds
    s_add_u32 m0, s30, 5120
    s_add_u32 s29, s29, 57344
    buffer_load_dwordx4 v8, s[4:7], s29 offen lds
    s_add_u32 m0, s30, 6144
    s_add_u32 s29, s29, 57344
    buffer_load_dwordx4 v8, s[4:7], s29 offen lds
    s_add_u32 m0, s30, 7168
    s_add_u32 s29, s29, 57344
    buffer_load_dwordx4 v8, s[4:7], s29 offen lds
    s_add_u32 m0, s30, 8192
    s_add_u32 s29, s29, 57344
    buffer_load_dwordx4 v8, s[4:7], s29 offen lds
    s_add_u32 m0, s30, 9216
    s_add_u32 s29, s29, 57344
    buffer_load_dwordx4 v8, s[4:7], s29 offen lds
    s_add_u32 m0, s30, 10240
    s_add_u32 s29, s29, 57344
    buffer_load_dwordx4 v8, s[4:7], s29 offen lds
    s_add_u32 m0, s30, 11264
    s_add_u32 s29, s29, 57344
    buffer_load_dwordx4 v8, s[4:7], s29 offen lds
    s_add_u32 m0, s30, 12288
    s_add_u32 s29, s29, 57344
    buffer_load_dwordx4 v8, s[4:7], s29 offen lds
    s_add_u32 m0, s30, 13312
    s_add_u32 s29, s29, 57344
    buffer_load_dwordx4 v8, s[4:7], s29 offen lds
    s_add_u32 m0, s30, 14336
    s_add_u32 s29, s29, 57344
    buffer_load_dwordx4 v8, s[4:7], s29 offen lds
    s_add_u32 m0, s30, 15360
    s_add_u32 s29, s29, 57344
    buffer_load_dwordx4 v8, s[4:7], s29 offen lds
    s_add_u32 m0, s30, 16384
    s_add_u32 s29, s29, 57344
    buffer_load_dwordx4 v8, s[4:7], s29 offen lds
    s_add_u32 m0, s30, 17408
    s_add_u32 s29, s29, 57344
    buffer_load_dwordx4 v8, s[4:7], s29 offen lds
    s_add_u32 m0, s30, 18432
    s_add_u32 s29, s29, 57344
    buffer_load_dwordx4 v8, s[4:7], s29 offen lds
    s_add_u32 m0, s30, 19456
    s_add_u32 s29, s29, 57344
    buffer_load_dwordx4 v8, s[4:7], s29 offen lds
    s_add_u32 m0, s30, 20480
    s_add_u32 s29, s29, 57344
    buffer_load_dwordx4 v8, s[4:7], s29 offen lds
    s_add_u32 m0, s30, 21504
    s_add_u32 s29, s29, 57344
    buffer_load_dwordx4 v8, s[4:7], s29 offen lds
    s_add_u32 m0, s30, 22528
    s_add_u32 s29, s29, 57344
    buffer_load_dwordx4 v8, s[4:7], s29 offen lds
    s_add_u32 m0, s30, 23552
    s_add_u32 s29, s29, 57344
    buffer_load_dwordx4 v8, s[4:7], s29 offen lds
    s_add_u32 m0, s30, 24576
    s_add_u32 s29, s29, 57344
    buffer_load_dwordx4 v8, s[4:7], s29 offen lds
    s_add_u32 m0, s30, 25600
    s_add_u32 s29, s29, 57344
    buffer_load_dwordx4 v8, s[4:7], s29 offen lds
    s_add_u32 m0, s30, 26624
    s_add_u32 s29, s29, 57344
    buffer_load_dwordx4 v8, s[4:7], s29 offen lds
    s_add_u32 m0, s30, 27648
    s_add_u32 s29, s29, 57344
    buffer_load_dwordx4 v8, s[4:7], s29 offen lds
    s_add_u32 m0, s30, 28672
    s_add_u32 s29, s29, 57344
    buffer_load_dwordx4 v8, s[4:7], s29 offen lds
    s_add_u32 m0, s30, 29696
    s_add_u32 s29, s29, 57344
    buffer_load_dwordx4 v8, s[4:7], s29 offen lds
    s_add_u32 m0, s30, 30720
    s_add_u32 s29, s29, 57344
    buffer_load_dwordx4 v8, s[4:7], s29 offen lds
    s_add_u32 m0, s30, 31744
    s_add_u32 s29, s29, 57344
    buffer_load_dwordx4 v8, s[4:7], s29 offen lds
    v_lshrrev_b32 v8, 5, v2
    v_lshlrev_b32 v8, 3, v8
    v_bfe_u32 v9, v2, 2, 2
    v_add_u32 v8, v8, v9
    v_lshlrev_b32 v8, 6, v8
    v_bfe_u32 v9, v2, 4, 1
    v_lshl_add_u32 v8, v9, 5, v8
    v_and_b32 v9, 3, v2
    v_lshl_add_u32 v8, v9, 3, v8
    v_add_u32 v8, s30, v8
    s_waitcnt vmcnt(28)
    ds_read_b64_tr_b16 a[0:1], v8 offset:0
    ds_read_b64_tr_b16 a[2:3], v8 offset:256
    ds_read_b64_tr_b16 a[4:5], v8 offset:1024
    ds_read_b64_tr_b16 a[6:7], v8 offset:1280
    ds_read_b64_tr_b16 a[8:9], v8 offset:2048
    ds_read_b64_tr_b16 a[10:11], v8 offset:2304
    ds_read_b64_tr_b16 a[12:13], v8 offset:3072
    ds_read_b64_tr_b16 a[14:15], v8 offset:3328
    s_waitcnt lgkmcnt(0)
    s_waitcnt vmcnt(24)
    ds_read_b64_tr_b16 a[16:17], v8 offset:4096
    ds_read_b64_tr_b16 a[18:19], v8 offset:4352
    ds_read_b64_tr_b16 a[20:21], v8 offset:5120
    ds_read_b64_tr_b16 a[22:23], v8 offset:5376
    ds_read_b64_tr_b16 a[24:25], v8 offset:6144
    ds_read_b64_tr_b16 a[26:27], v8 offset:6400
    ds_read_b64_tr_b16 a[28:29], v8 offset:7168
    ds_read_b64_tr_b16 a[30:31], v8 offset:7424
    s_waitcnt lgkmcnt(0)
    s_waitcnt vmcnt(20)
    ds_read_b64_tr_b16 a[32:33], v8 offset:8192
    ds_read_b64_tr_b16 a[34:35], v8 offset:8448
    ds_read_b64_tr_b16 a[36:37], v8 offset:9216
    ds_read_b64_tr_b16 a[38:39], v8 offset:9472
    ds_read_b64_tr_b16 a[40:41], v8 offset:10240
    ds_read_b64_tr_b16 a[42:43], v8 offset:10496
    ds_read_b64_tr_b16 a[44:45], v8 offset:11264
    ds_read_b64_tr_b16 a[46:47], v8 offset:11520
    s_waitcnt lgkmcnt(0)
    s_waitcnt vmcnt(16)
    ds_read_b64_tr_b16 a[48:49], v8 offset:12288
    ds_read_b64_tr_b16 a[50:51], v8 offset:12544
    ds_read_b64_tr_b16 a[52:53], v8 offset:13312
    ds_read_b64_tr_b16 a[54:55], v8 offset:13568
    ds_read_b64_tr_b16 a[56:57], v8 offset:14336
    ds_read_b64_tr_b16 a[58:59], v8 offset:14592
    ds_read_b64_tr_b16 a[60:61], v8 offset:15360
    ds_read_b64_tr_b16 a[62:63], v8 offset:15616
    s_waitcnt lgkmcnt(0)
    s_waitcnt vmcnt(12)
    ds_read_b64_tr_b16 a[64:65], v8 offset:16384
    ds_read_b64_tr_b16 a[66:67], v8 offset:16640
    ds_read_b64_tr_b16 a[68:69], v8 offset:17408
    ds_read_b64_tr_b16 a[70:71], v8 offset:17664
    ds_read_b64_tr_b16 a[72:73], v8 offset:18432
    ds_read_b64_tr_b16 a[74:75], v8 offset:18688
    ds_read_b64_tr_b16 a[76:77], v8 offset:19456
    ds_read_b64_tr_b16 a[78:79], v8 offset:19712
    s_waitcnt lgkmcnt(0)
    s_waitcnt vmcnt(8)
    ds_read_b64_tr_b16 a[80:81], v8 offset:20480
    ds_read_b64_tr_b16 a[82:83], v8 offset:20736
    ds_read_b64_tr_b16 a[84:85], v8 offset:21504
    ds_read_b64_tr_b16 a[86:87], v8 offset:21760
    ds_read_b64_tr_b16 a[88:89], v8 offset:22528
    ds_read_b64_tr_b16 a[90:91], v8 offset:22784
    ds_read_b64_tr_b16 a[92:93], v8 offset:23552
    ds_read_b64_tr_b16 a[94:95], v8 offset:23808
    s_waitcnt lgkmcnt(0)
    s_waitcnt vmcnt(4)
    ds_read_b64_tr_b16 a[96:97], v8 offset:24576
    ds_read_b64_tr_b16 a[98:99], v8 offset:24832
    ds_read_b64_tr_b16 a[100:101], v8 offset:25600
    ds_read_b64_tr_b16 a[102:103], v8 offset:25856
    ds_read_b64_tr_b16 a[104:105], v8 offset:26624
    ds_read_b64_tr_b16 a[106:107], v8 offset:26880
    ds_read_b64_tr_b16 a[108:109], v8 offset:27648
    ds_read_b64_tr_b16 a[110:111], v8 offset:27904
    s_waitcnt lgkmcnt(0)
    s_waitcnt vmcnt(0)
    ds_read_b64_tr_b16 a[112:113], v8 offset:28672
    ds_read_b64_tr_b16 a[114:115], v8 offset:28928
    ds_read_b64_tr_b16 a[116:117], v8 offset:29696
    ds_read_b64_tr_b16 a[118:119], v8 offset:29952
    ds_read_b64_tr_b16 a[120:121], v8 offset:30720
    ds_read_b64_tr_b16 a[122:123], v8 offset:30976
    ds_read_b64_tr_b16 a[124:125], v8 offset:31744
    ds_read_b64_tr_b16 a[126:127], v8 offset:32000
    s_waitcnt lgkmcnt(0)
    s_barrier
    v_lshlrev_b32 v3, 4, v2
    v_and_b32 v4, 31, v2
    s_movk_i32 s33, 1040
    v_mul_lo_u32 v4, v4, s33
    v_lshrrev_b32 v5, 5, v2
    v_lshl_add_u32 v4, v5, 4, v4
    v_and_b32 v6, 31, v2
    s_movk_i32 s33, 272
    v_mul_lo_u32 v6, v6, s33
    v_lshl_add_u32 v6, v5, 3, v6
    s_lshl_b32 s33, s25, 6
    s_add_u32 s33, s33, 66560
    v_add_u32 v6, s33, v6
    v_lshrrev_b32 v7, 4, v2
    s_lshl_b32 s33, s25, 3
    v_add_u32 v7, s33, v7
    v_and_b32 v8, 15, v2
    s_movk_i32 s33, 272
    v_mul_lo_u32 v9, v7, s33
    v_lshl_add_u32 v9, v8, 4, v9
    v_add_u32 v9, 66560, v9
    s_mov_b32 s33, 3584
    v_mul_lo_u32 v10, v7, s33
    v_lshl_add_u32 v10, v8, 4, v10
    s_mov_b32 s35, 0
    s_mov_b32 s31, s26
    s_mov_b32 s60, s31
    s_lshl_b32 s60, s60, 11
    s_add_u32 s60, s60, 0x410000
    s_mov_b32 s61, 0
Lw_52:
    buffer_load_dword v126, v124, s[20:23], s60 offen sc1
    s_add_u32 s61, s61, 1
    s_cmp_gt_u32 s61, 2000000
    s_cbranch_scc1 L_fail
    s_waitcnt vmcnt(0)
    v_cmp_eq_u32 vcc, 0, v126
    s_and_b32 vcc_lo, vcc_lo, 0xff
    s_cbranch_scc0 Lw_52_ok
    s_sleep 8
    s_branch Lw_52
Lw_52_ok:
    s_lshl_b32 s33, s31, 5
    s_lshl_b32 s34, s25, 3
    s_add_u32 s33, s33, s34
    s_lshl_b32 s33, s33, 10
    s_add_u32 s33, s33, 0x7000000
    s_mul_i32 s34, s34, 1040
    s_add_u32 s34, s34, s35
    s_add_u32 m0, s34, 0
    s_nop 0
    buffer_load_dwordx4 v3, s[20:23], s33 offen sc1 lds
    s_add_u32 m0, s34, 1040
    s_add_u32 s33, s33, 1024
    buffer_load_dwordx4 v3, s[20:23], s33 offen sc1 lds
    s_add_u32 m0, s34, 2080
    s_add_u32 s33, s33, 1024
    buffer_load_dwordx4 v3, s[20:23], s33 offen sc1 lds
    s_add_u32 m0, s34, 3120
    s_add_u32 s33, s33, 1024
    buffer_load_dwordx4 v3, s[20:23], s33 offen sc1 lds
    s_add_u32 m0, s34, 4160
    s_add_u32 s33, s33, 1024
    buffer_load_dwordx4 v3, s[20:23], s33 offen sc1 lds
    s_add_u32 m0, s34, 5200
    s_add_u32 s33, s33, 1024
    buffer_load_dwordx4 v3, s[20:23], s33 offen sc1 lds
    s_add_u32 m0, s34, 6240
    s_add_u32 s33, s33, 1024
    buffer_load_dwordx4 v3, s[20:23], s33 offen sc1 lds
    s_add_u32 m0, s34, 7280
    s_add_u32 s33, s33, 1024
    buffer_load_dwordx4 v3, s[20:23], s33 offen sc1 lds
    s_mov_b32 s57, 1
LR7_loop:
    s_cmp_eq_u32 s57, 1
    s_cbranch_scc1 LR7_have
    s_mov_b32 s31, s26
    s_mov_b32 s60, s31
    s_lshl_b32 s60, s60, 11
    s_add_u32 s60, s60, 0x410000
    s_mov_b32 s61, 0
Lw_53:
    buffer_load_dword v126, v124, s[20:23], s60 offen sc1
    s_add_u32 s61, s61, 1
    s_cmp_gt_u32 s61, 2000000
    s_cbranch_scc1 L_fail
    s_waitcnt vmcnt(0)
    v_cmp_eq_u32 vcc, 0, v126
    s_and_b32 vcc_lo, vcc_lo, 0xff
    s_cbranch_scc0 Lw_53_ok
    s_sleep 8
    s_branch Lw_53
Lw_53_ok:
    s_lshl_b32 s33, s31, 5
    s_lshl_b32 s34, s25, 3
    s_add_u32 s33, s33, s34
    s_lshl_b32 s33, s33, 10
    s_add_u32 s33, s33, 0x7000000
    s_mul_i32 s34, s34, 1040
    s_add_u32 s34, s34, s35
    s_add_u32 m0, s34, 0
    s_nop 0
    buffer_load_dwordx4 v3, s[20:23], s33 offen sc1 lds
    s_add_u32 m0, s34, 1040
    s_add_u32 s33, s33, 1024
    buffer_load_dwordx4 v3, s[20:23], s33 offen sc1 lds
    s_add_u32 m0, s34, 2080
    s_add_u32 s33, s33, 1024
    buffer_load_dwordx4 v3, s[20:23], s33 offen sc1 lds
    s_add_u32 m0, s34, 3120
    s_add_u32 s33, s33, 1024
    buffer_load_dwordx4 v3, s[20:23], s33 offen sc1 lds
    s_add_u32 m0, s34, 4160
    s_add_u32 s33, s33, 1024
    buffer_load_dwordx4 v3, s[20:23], s33 offen sc1 lds
    s_add_u32 m0, s34, 5200
    s_add_u32 s33, s33, 1024
    buffer_load_dwordx4 v3, s[20:23], s33 offen sc1 lds
    s_add_u32 m0, s34, 6240
    s_add_u32 s33, s33, 1024
    buffer_load_dwordx4 v3, s[20:23], s33 offen sc1 lds
    s_add_u32 m0, s34, 7280
    s_add_u32 s33, s33, 1024
    buffer_load_dwordx4 v3, s[20:23], s33 offen sc1 lds
LR7_have:
    s_waitcnt vmcnt(0)
    s_barrier
    s_xor_b32 s36, s35, 33280
    s_add_u32 s31, s26, 2
    s_mov_b32 s57, 0
    s_min_u32 s60, s31, 63
    s_lshl_b32 s60, s60, 11
    s_add_u32 s60, s60, 0x410000
    buffer_load_dword v122, v124, s[20:23], s60 offen sc1
    v_add_u32 v11, s35, v4
    ds_read_b128 v[32:35], v11 offset:0
    ds_read_b128 v[36:39], v11 offset:32
    ds_read_b128 v[40:43], v11 offset:64
    ds_read_b128 v[44:47], v11 offset:96
    s_waitcnt lgkmcnt(3)
    v_mfma_f32_32x32x16_bf16 v[16:31], a[0:3], v[32:35], 0
    ds_read_b128 v[48:51], v11 offset:128
    s_waitcnt lgkmcnt(3)
    v_mfma_f32_32x32x16_bf16 v[16:31], a[4:7], v[36:39], v[16:31]
    ds_read_b128 v[32:35], v11 offset:160
    s_waitcnt lgkmcnt(3)
    v_mfma_f32_32x32x16_bf16 v[16:31], a[8:11], v[40:43], v[16:31]
    ds_read_b128 v[36:39], v11 offset:192
    s_waitcnt lgkmcnt(3)
    v_mfma_f32_32x32x16_bf16 v[16:31], a[12:15], v[44:47], v[16:31]
    ds_read_b128 v[40:43], v11 offset:224
    s_waitcnt lgkmcnt(3)
    v_mfma_f32_32x32x16_bf16 v[16:31], a[16:19], v[48:51], v[16:31]
    ds_read_b128 v[44:47], v11 offset:256
    s_waitcnt lgkmcnt(3)
    v_mfma_f32_32x32x16_bf16 v[16:31], a[20:23], v[32:35], v[16:31]
    ds_read_b128 v[48:51], v11 offset:288
    s_waitcnt lgkmcnt(3)
    v_mfma_f32_32x32x16_bf16 v[16:31], a[24:27], v[36:39], v[16:31]
    ds_read_b128 v[32:35], v11 offset:320
    s_waitcnt lgkmcnt(3)
    v_mfma_f32_32x32x16_bf16 v[16:31], a[28:31], v[40:43], v[16:31]
    ds_read_b128 v[36:39], v11 offset:352
    s_waitcnt lgkmcnt(3)
    v_mfma_f32_32x32x16_bf16 v[16:31], a[32:35], v[44:47], v[16:31]
    ds_read_b128 v[40:43], v11 offset:384
    s_waitcnt lgkmcnt(3)
    v_mfma_f32_32x32x16_bf16 v[16:31], a[36:39], v[48:51], v[16:31]
    ds_read_b128 v[44:47], v11 offset:416
    s_waitcnt lgkmcnt(3)
    v_mfma_f32_32x32x16_bf16 v[16:31], a[40:43], v[32:35], v[16:31]
    ds_read_b128 v[48:51], v11 offset:448
    s_waitcnt lgkmcnt(3)
    v_mfma_f32_32x32x16_bf16 v[16:31], a[44:47], v[36:39], v[16:31]
    ds_read_b128 v[32:35], v11 offset:480
    s_waitcnt lgkmcnt(3)
    v_mfma_f32_32x32x16_bf16 v[16:31], a[48:51], v[40:43], v[16:31]
    ds_read_b128 v[36:39], v11 offset:512
    s_waitcnt lgkmcnt(3)
    v_mfma_f32_32x32x16_bf16 v[16:31], a[52:55], v[44:47], v[16:31]
    ds_read_b128 v[40:43], v11 offset:544
    s_waitcnt lgkmcnt(3)
    v_mfma_f32_32x32x16_bf16 v[16:31], a[56:59], v[48:51], v[16:31]
    ds_read_b128 v[44:47], v11 offset:576
    s_waitcnt lgkmcnt(3)
    v_mfma_f32_32x32x16_bf16 v[16:31], a[60:63], v[32:35], v[16:31]
    ds_read_b128 v[48:51], v11 offset:608
    s_waitcnt lgkmcnt(3)
    v_mfma_f32_32x32x16_bf16 v[16:31], a[64:67], v[36:39], v[16:31]
    ds_read_b128 v[32:35], v11 offset:640
    s_waitcnt lgkmcnt(3)
    v_mfma_f32_32x32x16_bf16 v[16:31], a[68:71], v[40:43], v[16:31]
    ds_read_b128 v[36:39], v11 offset:672
    s_waitcnt lgkmcnt(3)
    v_mfma_f32_32x32x16_bf16 v[16:31], a[72:75], v[44:47], v[16:31]
    ds_read_b128 v[40:43], v11 offset:704
    s_waitcnt lgkmcnt(3)
    v_mfma_f32_32x32x16_bf16 v[16:31], a[76:79], v[48:51], v[16:31]
    ds_read_b128 v[44:47], v11 offset:736
    s_waitcnt lgkmcnt(3)
    v_mfma_f32_32x32x16_bf16 v[16:31], a[80:83], v[32:35], v[16:31]
    ds_read_b128 v[48:51], v11 offset:768
    s_waitcnt lgkmcnt(3)
    v_mfma_f32_32x32x16_bf16 v[16:31], a[84:87], v[36:39], v[16:31]
    ds_read_b128 v[32:35], v11 offset:800
    s_waitcnt lgkmcnt(3)
    v_mfma_f32_32x32x16_bf16 v[16:31], a[88:91], v[40:43], v[16:31]
    ds_read_b128 v[36:39], v11 offset:832
    s_waitcnt lgkmcnt(3)
    v_mfma_f32_32x32x16_bf16 v[16:31], a[92:95], v[44:47], v[16:31]
    ds_read_b128 v[40:43], v11 offset:864
    s_waitcnt lgkmcnt(3)
    v_mfma_f32_32x32x16_bf16 v[16:31], a[96:99], v[48:51], v[16:31]
    ds_read_b128 v[44:47], v11 offset:896
    s_waitcnt lgkmcnt(3)
    v_mfma_f32_32x32x16_bf16 v[16:31], a[100:103], v[32:35], v[16:31]
    ds_read_b128 v[48:51], v11 offset:928
    s_waitcnt lgkmcnt(3)
    v_mfma_f32_32x32x16_bf16 v[16:31], a[104:107], v[36:39], v[16:31]
    ds_read_b128 v[32:35], v11 offset:960
    s_waitcnt lgkmcnt(3)
    v_mfma_f32_32x32x16_bf16 v[16:31], a[108:111], v[40:43], v[16:31]
    ds_read_b128 v[36:39], v11 offset:992
    s_waitcnt lgkmcnt(3)
    v_mfma_f32_32x32x16_bf16 v[16:31], a[112:115], v[44:47], v[16:31]
    s_waitcnt lgkmcnt(2)
    v_mfma_f32_32x32x16_bf16 v[16:31], a[116:119], v[48:51], v[16:31]
    s_waitcnt lgkmcnt(1)
    v_mfma_f32_32x32x16_bf16 v[16:31], a[120:123], v[32:35], v[16:31]
    s_waitcnt lgkmcnt(0)
    v_mfma_f32_32x32x16_bf16 v[16:31], a[124:127], v[36:39], v[16:31]
    s_nop 7
    s_nop 4
    v_cvt_pk_bf16_f32 v52, v16, v17
    v_cvt_pk_bf16_f32 v53, v18, v19
    v_cvt_pk_bf16_f32 v54, v20, v21
    v_cvt_pk_bf16_f32 v55, v22, v23
    v_cvt_pk_bf16_f32 v56, v24, v25
    v_cvt_pk_bf16_f32 v57, v26, v27
    v_cvt_pk_bf16_f32 v58, v28, v29
    v_cvt_pk_bf16_f32 v59, v30, v31
    v_pk_max_i16 v52, v52, 0
    v_pk_max_i16 v53, v53, 0
    v_pk_max_i16 v54, v54, 0
    v_pk_max_i16 v55, v55, 0
    v_pk_max_i16 v56, v56, 0
    v_pk_max_i16 v57, v57, 0
    v_pk_max_i16 v58, v58, 0
    v_pk_max_i16 v59, v59, 0
    ds_write_b64 v6, v[52:53] offset:0
    ds_write_b64 v6, v[54:55] offset:16
    ds_write_b64 v6, v[56:57] offset:32
    ds_write_b64 v6, v[58:59] offset:48
    s_waitcnt lgkmcnt(0)
    s_barrier
    ds_read_b128 v[32:35], v9
    ds_read_b128 v[36:39], v9 offset:1088
    s_mul_i32 s33, s26, 114688
    s_add_u32 s33, s33, s28
    s_add_u32 s34, s33, 14336
    s_waitcnt lgkmcnt(0)
    buffer_store_dwordx4 v[32:35], v10, s[20:23], s33 offen sc1
    buffer_store_dwordx4 v[36:39], v10, s[20:23], s34 offen sc1
    s_cmp_ge_u32 s31, 64
    s_cbranch_scc1 LR7_nodma
    s_waitcnt vmcnt(2)
    v_cmp_eq_u32 vcc, 0, v122
    s_and_b32 vcc_lo, vcc_lo, 0xff
    s_cselect_b32 s61, 0, 1
    s_cmp_eq_u32 s61, 1
    s_cbranch_scc0 LR7_nodma
    s_mov_b32 s57, 1
    s_lshl_b32 s33, s31, 5
    s_lshl_b32 s34, s25, 3
    s_add_u32 s33, s33, s34
    s_lshl_b32 s33, s33, 10
    s_add_u32 s33, s33, 0x7000000
    s_mul_i32 s34, s34, 1040
    s_add_u32 s34, s34, s36
    s_add_u32 m0, s34, 0
    s_nop 0
    buffer_load_dwordx4 v3, s[20:23], s33 offen sc1 lds
    s_add_u32 m0, s34, 1040
    s_add_u32 s33, s33, 1024
    buffer_load_dwordx4 v3, s[20:23], s33 offen sc1 lds
    s_add_u32 m0, s34, 2080
    s_add_u32 s33, s33, 1024
    buffer_load_dwordx4 v3, s[20:23], s33 offen sc1 lds
    s_add_u32 m0, s34, 3120
    s_add_u32 s33, s33, 1024
    buffer_load_dwordx4 v3, s[20:23], s33 offen sc1 lds
    s_add_u32 m0, s34, 4160
    s_add_u32 s33, s33, 1024
    buffer_load_dwordx4 v3, s[20:23], s33 offen sc1 lds
    s_add_u32 m0, s34, 5200
    s_add_u32 s33, s33, 1024
    buffer_load_dwordx4 v3, s[20:23], s33 offen sc1 lds
    s_add_u32 m0, s34, 6240
    s_add_u32 s33, s33, 1024
    buffer_load_dwordx4 v3, s[20:23], s33 offen sc1 lds
    s_add_u32 m0, s34, 7280
    s_add_u32 s33, s33, 1024
    buffer_load_dwordx4 v3, s[20:23], s33 offen sc1 lds
    s_waitcnt vmcnt(8)
LR7_nodma:
    s_cmp_eq_u32 s57, 1
    s_cbranch_scc1 Ls_54_w
    s_waitcnt vmcnt(0)
Ls_54_w:
    s_barrier
    s_cmp_lg_u32 s25, 0
    s_cbranch_scc1 Lf_55
    s_mov_b32 s60, s26
    s_lshl_b32 s60, s60, 11
    s_lshl_b32 s61, s59, 2
    s_add_u32 s60, s60, s61
    s_add_u32 s60, s60, 0x4102a0
    v_mov_b32 v127, 0
    v_mov_b32 v125, 1
    s_mov_b64 exec, 1
    buffer_store_dword v125, v127, s[20:23], s60 offen sc1
    s_mov_b64 exec, -1
Lf_55:
    s_mov_b32 s35, s36
    s_add_u32 s26, s26, 2
    s_cmp_lt_u32 s26, 64
    s_cbranch_scc1 LR7_loop
    s_waitcnt vmcnt(0)
LR7_exit:
    s_branch L_exit
LR8:
    s_sub_u32 s63, s62, 220
    s_branch L_exit
L_exit:
    s_endpgm
.section .rodata,"a"
.p2align 6
.amdhsa_kernel sequential_preLN__memory_aug_recurrent_mem_tr__dense_activation_relu__prompt_kernel
  .amdhsa_next_free_vgpr 512
  .amdhsa_next_free_sgpr 102
  .amdhsa_accum_offset 256
  .amdhsa_group_segment_fixed_size 0
  .amdhsa_kernarg_size 104
  .amdhsa_user_sgpr_count 2
  .amdhsa_user_sgpr_kernarg_segment_ptr 1
  .amdhsa_system_sgpr_workgroup_id_x 1
.end_amdhsa_kernel
.text
```
